```python
import torch

def _softmax(x, axis=-1):
    return torch.softmax(x, dim=axis)
def _gelu(x):
    return torch.nn.functional.gelu(x, approximate="tanh")
def _silu(x):
    return torch.nn.functional.silu(x)
def _sigmoid(x):
    return torch.sigmoid(x)
def _layernorm(x, axis=-1, eps=1e-5):
    m = x.mean(dim=axis, keepdim=True)
    v = x.var(dim=axis, keepdim=True, unbiased=False)
    return (x - m) / torch.sqrt(v + eps)
def _scatter_add(tgt, idx, src, axis=0):
    return tgt.clone().index_add_(axis, idx, src)
def _segment_sum(src, seg, n):
    out = torch.zeros((n,) + src.shape[1:], dtype=src.dtype)
    return out.index_add_(0, seg, src)
def _pad(x, pw):
    flat = tuple(v for pair in reversed(pw) for v in pair)
    return torch.nn.functional.pad(x, flat)

kernel_name = 'recurrent_scan__ssm_conv_h3__dense_activation_squared_relu__prompt'

def setup_inputs():

    _w = (lambda a: (lambda t: t.to(torch.bfloat16) if t.is_floating_point() else t)(torch.as_tensor(a)))
    def _A_setup():
        B, S, D = 1, 2048, 512
        ks = 4
        return {
            "q": _w((lambda *s: torch.randn(*s, dtype=torch.bfloat16) * 0.05)(B, S, D)),
            "k": _w((lambda *s: torch.randn(*s, dtype=torch.bfloat16) * 0.2)(B, S, D)),
            "v": _w((lambda *s: torch.randn(*s, dtype=torch.bfloat16) * 0.2)(B, S, D)),
            "shift_k": _w((lambda *s: torch.randn(*s, dtype=torch.bfloat16) * 0.2)(D, ks) * 0.5),
            "ssm_k": _w((lambda *s: torch.randn(*s, dtype=torch.bfloat16) * 0.2)(D, S) * (1.0 / S ** 0.5)),
            "ssm_D": _w((lambda *s: torch.randn(*s, dtype=torch.bfloat16) * 0.2)(D)),
        }
    _A_in = _A_setup()

    def _B_setup():
        B, S, D, F = 1, 2048, 512, 1792
        return {
            "x": _w((lambda *s: torch.randn(*s, dtype=torch.bfloat16) * 0.05)(B, S, D)),
            "w1": _w((lambda *s: torch.randn(*s, dtype=torch.bfloat16) * 0.1)(D, F)),
            "b1": _w((lambda *s: torch.randn(*s, dtype=torch.bfloat16) * 0.8)(F)),
            "w2": _w((lambda *s: torch.randn(*s, dtype=torch.bfloat16) * 0.1)(F, D)),
            "b2": _w((lambda *s: torch.randn(*s, dtype=torch.bfloat16) * 6.4)(D)),
        }
    _B_in = _B_setup()

    return {
        "A_q": _A_in["q"],
        "A_k": _A_in["k"],
        "A_v": _A_in["v"],
        "A_shift_k": _A_in["shift_k"],
        "A_ssm_k": _A_in["ssm_k"],
        "A_ssm_D": _A_in["ssm_D"],
        "B_x": _B_in["x"],
        "B_w1": _B_in["w1"],
        "B_b1": _B_in["b1"],
        "B_w2": _B_in["w2"],
        "B_b2": _B_in["b2"],
    }

def reference(A_q, A_k, A_v, A_shift_k, A_ssm_k, A_ssm_D, B_x, B_w1, B_b1, B_w2, B_b2):
    def _A_ref(q, k, v, shift_k, ssm_k, ssm_D):
        B, S, D = q.shape
        ks = shift_k.shape[-1]
        k_pad = _pad(k, ((0, 0), (ks - 1, 0), (0, 0)))
        k_shift = torch.zeros_like(k)
        for t in range(ks):
            k_shift = k_shift + k_pad[:, t:t + S, :] * shift_k[:, ks - 1 - t][None, None, :]
        kv = k_shift * v
        L = 2 * S
        kv_pad = _pad(kv, ((0, 0), (0, S), (0, 0)))
        kf_pad = _pad(ssm_k, ((0, 0), (0, S)))
        kv_f = (lambda x, axes=(-2,-1): torch.fft.rfft2(x.float(), dim=axes))(kv_pad[:, None, :, :], axes=(1, 2))
        kf_f = (lambda x, axes=(-2,-1): torch.fft.rfft2(x.float(), dim=axes))(kf_pad[:, None, :], axes=(1, 2))
        kf_f = (lambda x, *d: x.permute(*d))(kf_f, 1, 2, 0)
        y_f = kv_f * kf_f[None, :, :, :]
        y = (lambda x, s, axes=(-2,-1): torch.fft.irfft2(x, s=s, dim=axes).to(torch.bfloat16))(y_f, (1, L), axes=(1, 2))[:, 0, :S, :]
        y = y + kv * ssm_D[None, None, :]
        return q * y

    def _B_ref(x, w1, b1, w2, b2):
        h = torch.einsum("bsd,df->bsf", x, w1) + b1
        zero = torch.zeros_like(h)
        r = torch.where(h > zero, h, zero)
        h = r * r
        out = torch.einsum("bsf,fd->bsd", h, w2) + b2
        return out

    x = A_q
    xn = _layernorm(x, axis=-1)
    s = _A_ref(xn, A_k, A_v, A_shift_k, A_ssm_k, A_ssm_D)
    g = _silu(_B_ref(xn, B_w1, B_b1, B_w2, B_b2))
    return x + s * g
```

```asm
; @launch grid=(256,1,1) block=(256,1,1) lds=161536
.amdgcn_target "amdgcn-amd-amdhsa--gfx950"
.text
.globl recurrent_scan__ssm_conv_h3__dense_activation_squared_relu__prompt_kernel
.p2align 8
.type recurrent_scan__ssm_conv_h3__dense_activation_squared_relu__prompt_kernel,@function
recurrent_scan__ssm_conv_h3__dense_activation_squared_relu__prompt_kernel:
Kstart:
    s_cmp_ge_u32 s2, 256
    s_cbranch_scc1 Lend
    s_lshr_b32 s3, s2, 3
    s_and_b32 s3, s3, 7
    s_cmp_eq_u32 s3, 7
    s_cbranch_scc1 Lidle
    s_load_dwordx16 s[64:79], s[0:1], 0
    s_load_dwordx8 s[80:87], s[0:1], 64
    s_load_dwordx4 s[88:91], s[0:1], 96
    s_mov_b32 s92, s2
    v_and_b32 v1, 63, v0
    v_lshrrev_b32 v5, 6, v0
    v_lshlrev_b32 v2, 4, v1
    v_readfirstlane_b32 s44, v5
    s_and_b32 s45, s2, 7
    s_lshr_b32 s46, s2, 3
    s_lshr_b32 s54, s45, 1
    s_lshr_b32 s55, s46, 3
    s_lshl_b32 s47, s54, 2
    s_add_u32 s47, s47, s55
    s_and_b32 s51, s46, 7
    s_and_b32 s56, s45, 1
    s_mul_i32 s48, s56, 7
    s_add_u32 s48, s48, s51
    s_lshl_b32 s50, s47, 1
    s_add_u32 s50, s50, s56
    s_lshl_b32 s49, s55, 1
    s_add_u32 s49, s49, s51
    s_add_u32 s49, s49, s54
    s_and_b32 s49, s49, 7
    s_lshl_b32 s93, s44, 12
    s_lshl_b32 s94, s51, 7
    s_mul_i32 s55, s55, 3
    s_add_u32 s54, s54, s55
    s_lshl_b32 s55, s51, 1
    s_add_u32 s54, s54, s55
    s_cmp_ge_u32 s54, 14
    s_cselect_b32 s55, 14, 0
    s_sub_u32 s63, s54, s55
    v_and_b32 v3, 15, v1
    v_lshrrev_b32 v4, 4, v1
    v_lshrrev_b32 v23, 3, v1
    v_and_b32 v24, 7, v1
    v_lshlrev_b32 v5, 10, v23
    v_lshl_add_u32 v25, v24, 4, v5
    s_lshl_b32 s57, s47, 7
    s_lshl_b32 s58, s44, 5
    s_add_u32 s57, s57, s58
    v_lshrrev_b32 v7, 1, v23
    v_xor_b32 v7, v7, v24
    v_add_u32 v5, s57, v23
    v_lshlrev_b32 v5, 10, v5
    v_lshl_add_u32 v28, v7, 4, v5
    v_xor_b32 v6, 64, v28
    v_add_u32 v29, 7168, v6
    v_add_u32 v30, 14336, v28
    v_add_u32 v31, 21504, v6
    s_lshl_b32 s57, s44, 4
    v_add_u32 v5, s57, v4
    v_mul_u32_u24 v5, 0xe00, v5
    v_lshlrev_b32 v6, 1, v4
    v_xor_b32 v6, v6, v3
    v_lshl_add_u32 v5, v6, 4, v5
    s_lshl_b32 s58, s48, 8
    v_add_u32 v32, s58, v5
    v_add_u32 v33, 13312, v32
    v_add_u32 v34, 26496, v32
    v_add_u32 v35, 39808, v32
    s_mul_i32 s95, s44, 4352
    s_add_u32 s98, s93, 17408
    v_lshrrev_b32 v5, 2, v1
    v_and_b32 v5, 3, v5
    v_mul_u32_u24 v6, 2176, v4
    v_lshl_add_u32 v6, v5, 8, v6
    v_and_b32 v7, 3, v1
    v_lshl_add_u32 v6, v7, 3, v6
    v_xor_b32 v7, 0, v5
    v_lshl_add_u32 v36, v7, 5, v6
    v_add_u32 v40, 67584, v36
    v_xor_b32 v7, 1, v5
    v_lshl_add_u32 v37, v7, 5, v6
    v_add_u32 v41, 67584, v37
    v_xor_b32 v7, 2, v5
    v_lshl_add_u32 v38, v7, 5, v6
    v_add_u32 v42, 67584, v38
    v_xor_b32 v7, 3, v5
    v_lshl_add_u32 v39, v7, 5, v6
    v_add_u32 v43, 67584, v39
    v_mov_b32 v8, v5
    s_lshl_b32 s54, s44, 1
    s_and_b32 s54, s54, 3
    s_lshr_b32 s55, s44, 1
    s_lshl_b32 s55, s55, 7
    s_add_u32 s56, s54, 0
    v_xor_b32 v7, s56, v8
    v_lshl_add_u32 v44, v7, 5, v6
    v_add_u32 v44, s55, v44
    v_add_u32 v46, 67584, v44
    s_add_u32 s56, s54, 1
    v_xor_b32 v7, s56, v8
    v_lshl_add_u32 v45, v7, 5, v6
    v_add_u32 v45, s55, v45
    v_add_u32 v47, 67584, v45
    v_lshrrev_b32 v5, 1, v3
    v_xor_b32 v5, v5, v4
    v_lshlrev_b32 v5, 4, v5
    v_lshl_add_u32 v5, v3, 7, v5
    v_add_u32 v48, s98, v5
    v_xor_b32 v49, 64, v48
    v_add_u32 v50, 67584, v48
    v_add_u32 v51, 67584, v49
    v_mov_b32 v132, 0x3f803f80
    v_mov_b32 v133, 0x3f803f80
    v_mov_b32 v134, 0x3f803f80
    v_mov_b32 v135, 0x3f803f80
    s_lshl_b32 s54, s45, 8
    s_add_u32 s54, s54, 1024
    v_lshl_add_u32 v5, v1, 2, s54
    s_lshl_b32 s54, s47, 8
    s_add_u32 s54, s54, 4096
    v_lshl_add_u32 v6, v3, 2, s54
    v_cmp_gt_u32 vcc, 32, v1
    s_nop 1
    v_cndmask_b32 v26, v6, v5, vcc
    s_lshr_b32 s54, s44, 1
    s_lshl_b32 s3, s45, 6
    s_lshl_b32 s55, s46, 1
    s_add_u32 s3, s3, s55
    s_add_u32 s3, s3, s54
    s_lshl_b32 s56, s44, 3
    v_add_u32 v140, s56, v23
    v_lshrrev_b32 v6, 2, v140
    v_and_b32 v7, 3, v140
    v_lshlrev_b32 v7, 2, v7
    v_xor_b32 v8, v6, v24
    v_lshl_add_u32 v8, v8, 4, v7
    v_lshl_add_u32 v8, v24, 10, v8
    v_add_u32 v141, 143616, v8
    v_add_u32 v143, 152832, v8
    v_add_u32 v142, 1, v24
    v_and_b32 v8, 7, v142
    v_xor_b32 v8, v6, v8
    v_lshl_add_u32 v8, v8, 4, v7
    v_lshl_add_u32 v8, v142, 10, v8
    v_add_u32 v142, 143616, v8
    s_lshl_b32 s54, s45, 6
    v_lshl_add_u32 v6, v140, 1, s54
    s_movk_i32 s55, 4224
    v_mul_u32_u24 v6, s55, v6
    v_lshlrev_b32 v7, 4, v24
    v_sub_u32 v7, 4080, v7
    v_add_u32 v144, v6, v7
    v_mov_b32 v148, 0
    v_mov_b32 v149, 0
    v_mov_b32 v150, 0
    v_mov_b32 v151, 0
    v_lshlrev_b32 v5, 4, v24
    s_lshr_b32 s54, s44, 1
    s_mul_i32 s54, s54, 4224
    s_add_u32 s54, s54, 135168
    v_add_u32 v5, s54, v5
    ds_write_b128 v5, v[148:151]
    v_accvgpr_write_b32 a224, 0
    v_accvgpr_write_b32 a225, 0
    v_accvgpr_write_b32 a226, 0
    v_accvgpr_write_b32 a227, 0
    v_accvgpr_write_b32 a228, 0
    v_accvgpr_write_b32 a229, 0
    v_accvgpr_write_b32 a230, 0
    v_accvgpr_write_b32 a231, 0
    s_waitcnt lgkmcnt(0)
    s_mov_b32 s4, s64
    s_and_b32 s5, s65, 0xffff
    s_mov_b32 s6, 2097152
    s_mov_b32 s7, 0x00020000
    s_mov_b32 s8, s66
    s_and_b32 s9, s67, 0xffff
    s_mov_b32 s10, 2097152
    s_mov_b32 s11, 0x00020000
    s_mov_b32 s12, s68
    s_and_b32 s13, s69, 0xffff
    s_mov_b32 s14, 2097152
    s_mov_b32 s15, 0x00020000
    s_getpc_b64 s[56:57]
Lmpc_1:
    s_add_u32 s56, s56, Kstart-Lmpc_1
    s_addc_u32 s57, s57, -1
    s_lshl_b32 s54, s46, 2
    s_add_u32 s54, s54, s44
    s_lshl_b32 s54, s54, 10
    s_cmp_le_u32 s54, Lend-Kstart-1024
    s_cselect_b32 s54, s54, 0
    v_add_u32 v146, s54, v2
    global_load_dwordx4 v[148:151], v146, s[56:57]
    s_lshl_b32 s56, s92, 3
    s_lshl_b32 s57, s44, 1
    s_add_u32 s53, s56, s57
    s_lshl_b32 s57, s53, 10
    buffer_load_dwordx4 v[152:155], v2, s[4:7], s57 offen
    buffer_load_dwordx4 v[156:159], v2, s[4:7], s57 offen offset:1024
    s_lshl_b32 s54, s46, 16
    s_lshl_b32 s55, s45, 7
    s_add_u32 s54, s54, s55
    s_lshl_b32 s55, s44, 1
    s_add_u32 s56, s55, 0
    s_add_u32 s57, s56, 1
    s_and_b32 s58, s57, 7
    s_lshl_b32 s58, s58, 4
    v_xor_b32 v5, s58, v25
    s_lshl_b32 s57, s57, 10
    s_add_u32 m0, s57, 143616
    s_lshl_b32 s59, s56, 13
    s_add_u32 s59, s59, s54
    buffer_load_dwordx4 v5, s[8:11], s59 offen lds
    s_lshl_b32 s58, s56, 4
    v_xor_b32 v6, s58, v25
    s_lshl_b32 s57, s56, 10
    s_add_u32 m0, s57, 152832
    s_nop 0
    buffer_load_dwordx4 v6, s[12:15], s59 offen lds
    s_add_u32 s56, s55, 1
    s_add_u32 s57, s56, 1
    s_and_b32 s58, s57, 7
    s_lshl_b32 s58, s58, 4
    v_xor_b32 v5, s58, v25
    s_lshl_b32 s57, s57, 10
    s_add_u32 m0, s57, 143616
    s_lshl_b32 s59, s56, 13
    s_add_u32 s59, s59, s54
    buffer_load_dwordx4 v5, s[8:11], s59 offen lds
    s_lshl_b32 s58, s56, 4
    v_xor_b32 v6, s58, v25
    s_lshl_b32 s57, s56, 10
    s_add_u32 m0, s57, 152832
    s_nop 0
    buffer_load_dwordx4 v6, s[12:15], s59 offen lds
    s_lshl_b32 s56, s44, 11
    s_add_u32 s56, s56, s54
    s_sub_u32 s56, s56, 8192
    v_add_u32 v7, s56, v25
    s_lshl_b32 s57, s44, 8
    s_add_u32 m0, s57, 143616
    s_mov_b64 exec, 0xffff
    buffer_load_dwordx4 v7, s[8:11], 0 offen lds
    s_mov_b64 exec, -1
    s_mov_b64 s[36:37], s[70:71]
    s_lshl_b32 s57, s45, 9
    v_lshlrev_b32 v8, 4, v140
    v_add_u32 v8, s57, v8
    global_load_dwordx4 v[136:139], v8, s[36:37]
    s_mov_b32 s20, s78
    s_and_b32 s21, s79, 0xffff
    s_mov_b32 s22, 1835008
    s_mov_b32 s23, 0x00020000
    s_mov_b32 s16, s72
    s_and_b32 s17, s73, 0xffff
    s_mov_b32 s18, 2097152
    s_mov_b32 s19, 0x00020000
    s_mov_b32 s32, s90
    s_and_b32 s33, s91, 0xffff
    s_mov_b32 s34, 12058624
    s_mov_b32 s35, 0x00020000
    s_mov_b32 s24, s82
    s_and_b32 s25, s83, 0xffff
    s_mov_b32 s26, 1835008
    s_mov_b32 s27, 0x00020000
    s_mov_b32 s28, s86
    s_and_b32 s29, s87, 0xffff
    s_mov_b32 s30, 2097152
    s_mov_b32 s31, 0x00020000
    s_mov_b64 s[38:39], s[74:75]
    s_mov_b64 s[40:41], s[80:81]
    s_mov_b64 s[42:43], s[84:85]
    v_mov_b32 v5, 0
    buffer_load_dword v145, v5, s[32:35], 0 offen sc1
    s_add_u32 m0, s98, 0
    s_add_u32 s99, s49, 0
    s_and_b32 s99, s99, 7
    s_lshl_b32 s100, s99, 7
    buffer_load_dwordx4 v28, s[4:7], s100 offen lds
    buffer_load_dwordx4 v29, s[4:7], s100 offen offset:1024 lds
    buffer_load_dwordx4 v30, s[4:7], s100 offen offset:2048 lds
    buffer_load_dwordx4 v31, s[4:7], s100 offen offset:3072 lds
    s_add_u32 m0, s95, 0
    s_mul_i32 s100, s99, 229376
    buffer_load_dwordx4 v32, s[20:23], s100 offen lds
    buffer_load_dwordx4 v33, s[20:23], s100 offen offset:1024 lds
    buffer_load_dwordx4 v34, s[20:23], s100 offen offset:2176 lds
    buffer_load_dwordx4 v35, s[20:23], s100 offen offset:3200 lds
    s_waitcnt vmcnt(16)
    v_lshlrev_b32 v172, 16, v152
    v_and_b32 v173, 0xffff0000, v152
    v_lshlrev_b32 v174, 16, v153
    v_and_b32 v175, 0xffff0000, v153
    v_lshlrev_b32 v176, 16, v154
    v_and_b32 v177, 0xffff0000, v154
    v_lshlrev_b32 v178, 16, v155
    v_and_b32 v179, 0xffff0000, v155
    s_waitcnt vmcnt(15)
    v_lshlrev_b32 v180, 16, v156
    v_and_b32 v181, 0xffff0000, v156
    v_lshlrev_b32 v182, 16, v157
    v_and_b32 v183, 0xffff0000, v157
    v_lshlrev_b32 v184, 16, v158
    v_and_b32 v185, 0xffff0000, v158
    v_lshlrev_b32 v186, 16, v159
    v_and_b32 v187, 0xffff0000, v159
    v_add_f32 v162, v172, v173
    v_add_f32 v163, v180, v181
    v_add_f32 v162, v162, v174
    v_add_f32 v163, v163, v182
    v_add_f32 v162, v162, v175
    v_add_f32 v163, v163, v183
    v_add_f32 v162, v162, v176
    v_add_f32 v163, v163, v184
    v_add_f32 v162, v162, v177
    v_add_f32 v163, v163, v185
    v_add_f32 v162, v162, v178
    v_add_f32 v163, v163, v186
    v_add_f32 v162, v162, v179
    v_add_f32 v163, v163, v187
    s_nop 0
    v_add_f32_dpp v162, v162, v162 row_shr:1 row_mask:0xf bank_mask:0xf bound_ctrl:0
    v_add_f32_dpp v163, v163, v163 row_shr:1 row_mask:0xf bank_mask:0xf bound_ctrl:0
    s_nop 0
    v_add_f32_dpp v162, v162, v162 row_shr:2 row_mask:0xf bank_mask:0xf bound_ctrl:0
    v_add_f32_dpp v163, v163, v163 row_shr:2 row_mask:0xf bank_mask:0xf bound_ctrl:0
    s_nop 0
    v_add_f32_dpp v162, v162, v162 row_shr:4 row_mask:0xf bank_mask:0xf bound_ctrl:0
    v_add_f32_dpp v163, v163, v163 row_shr:4 row_mask:0xf bank_mask:0xf bound_ctrl:0
    s_nop 0
    v_add_f32_dpp v162, v162, v162 row_shr:8 row_mask:0xf bank_mask:0xf bound_ctrl:0
    v_add_f32_dpp v163, v163, v163 row_shr:8 row_mask:0xf bank_mask:0xf bound_ctrl:0
    s_nop 0
    v_add_f32_dpp v162, v162, v162 row_bcast:15 row_mask:0xa bank_mask:0xf
    v_add_f32_dpp v163, v163, v163 row_bcast:15 row_mask:0xa bank_mask:0xf
    s_nop 0
    v_add_f32_dpp v162, v162, v162 row_bcast:31 row_mask:0xc bank_mask:0xf
    v_add_f32_dpp v163, v163, v163 row_bcast:31 row_mask:0xc bank_mask:0xf
    v_readlane_b32 s54, v162, 63
    v_readlane_b32 s55, v163, 63
    v_mov_b32 v5, 0x3b000000
    v_mul_f32 v188, s54, v5
    v_mul_f32 v190, s55, v5
    v_sub_f32 v172, v172, v188
    v_sub_f32 v173, v173, v188
    v_sub_f32 v174, v174, v188
    v_sub_f32 v175, v175, v188
    v_sub_f32 v176, v176, v188
    v_sub_f32 v177, v177, v188
    v_sub_f32 v178, v178, v188
    v_sub_f32 v179, v179, v188
    v_sub_f32 v180, v180, v190
    v_sub_f32 v181, v181, v190
    v_sub_f32 v182, v182, v190
    v_sub_f32 v183, v183, v190
    v_sub_f32 v184, v184, v190
    v_sub_f32 v185, v185, v190
    v_sub_f32 v186, v186, v190
    v_sub_f32 v187, v187, v190
    v_mul_f32 v162, v172, v172
    v_mul_f32 v163, v180, v180
    v_fmac_f32 v162, v173, v173
    v_fmac_f32 v163, v181, v181
    v_fmac_f32 v162, v174, v174
    v_fmac_f32 v163, v182, v182
    v_fmac_f32 v162, v175, v175
    v_fmac_f32 v163, v183, v183
    v_fmac_f32 v162, v176, v176
    v_fmac_f32 v163, v184, v184
    v_fmac_f32 v162, v177, v177
    v_fmac_f32 v163, v185, v185
    v_fmac_f32 v162, v178, v178
    v_fmac_f32 v163, v186, v186
    v_fmac_f32 v162, v179, v179
    v_fmac_f32 v163, v187, v187
    s_nop 0
    v_add_f32_dpp v162, v162, v162 row_shr:1 row_mask:0xf bank_mask:0xf bound_ctrl:0
    v_add_f32_dpp v163, v163, v163 row_shr:1 row_mask:0xf bank_mask:0xf bound_ctrl:0
    s_nop 0
    v_add_f32_dpp v162, v162, v162 row_shr:2 row_mask:0xf bank_mask:0xf bound_ctrl:0
    v_add_f32_dpp v163, v163, v163 row_shr:2 row_mask:0xf bank_mask:0xf bound_ctrl:0
    s_nop 0
    v_add_f32_dpp v162, v162, v162 row_shr:4 row_mask:0xf bank_mask:0xf bound_ctrl:0
    v_add_f32_dpp v163, v163, v163 row_shr:4 row_mask:0xf bank_mask:0xf bound_ctrl:0
    s_nop 0
    v_add_f32_dpp v162, v162, v162 row_shr:8 row_mask:0xf bank_mask:0xf bound_ctrl:0
    v_add_f32_dpp v163, v163, v163 row_shr:8 row_mask:0xf bank_mask:0xf bound_ctrl:0
    s_nop 0
    v_add_f32_dpp v162, v162, v162 row_bcast:15 row_mask:0xa bank_mask:0xf
    v_add_f32_dpp v163, v163, v163 row_bcast:15 row_mask:0xa bank_mask:0xf
    s_nop 0
    v_add_f32_dpp v162, v162, v162 row_bcast:31 row_mask:0xc bank_mask:0xf
    v_add_f32_dpp v163, v163, v163 row_bcast:31 row_mask:0xc bank_mask:0xf
    v_readlane_b32 s54, v162, 63
    v_readlane_b32 s55, v163, 63
    s_nop 0
    v_mul_f32 v189, s54, v5
    v_mul_f32 v191, s55, v5
    v_cvt_pk_bf16_f32 v188, v188, v188
    v_and_b32 v188, 0xffff0000, v188
    v_cvt_pk_bf16_f32 v190, v190, v190
    v_and_b32 v190, 0xffff0000, v190
    v_cvt_pk_bf16_f32 v189, v189, v189
    v_and_b32 v189, 0xffff0000, v189
    v_cvt_pk_bf16_f32 v191, v191, v191
    v_and_b32 v191, 0xffff0000, v191
    v_add_f32 v189, 0x3727c5ac, v189
    v_add_f32 v191, 0x3727c5ac, v191
    v_cvt_pk_bf16_f32 v189, v189, v189
    v_and_b32 v189, 0xffff0000, v189
    v_cvt_pk_bf16_f32 v191, v191, v191
    v_and_b32 v191, 0xffff0000, v191
    v_sqrt_f32 v189, v189
    v_sqrt_f32 v191, v191
    v_cvt_pk_bf16_f32 v189, v189, v189
    v_and_b32 v189, 0xffff0000, v189
    v_cvt_pk_bf16_f32 v191, v191, v191
    v_and_b32 v191, 0xffff0000, v191
    v_rcp_f32 v189, v189
    v_rcp_f32 v191, v191
    s_lshl_b32 s54, s53, 3
    s_add_u32 s54, s54, 16384
    v_mov_b32 v6, s54
    s_mov_b64 exec, 1
    buffer_store_dwordx4 v[188:191], v6, s[32:35], 0 offen sc1
    s_mov_b64 exec, -1
    s_nop 1
    s_waitcnt vmcnt(11)
    s_waitcnt lgkmcnt(0)
    s_barrier
    ds_read_b32 v172, v141 offset:640
    s_add_u32 m0, s98, 33792
    s_add_u32 s99, s49, 1
    s_and_b32 s99, s99, 7
    s_lshl_b32 s100, s99, 7
    buffer_load_dwordx4 v28, s[4:7], s100 offen lds
    ds_read_b32 v173, v141 offset:768
    ds_read_b32 v174, v141 offset:896
    ds_read_b32 v175, v142 offset:0
    ds_read_b32 v176, v142 offset:128
    ds_read_b32 v177, v142 offset:256
    ds_read_b32 v178, v142 offset:384
    ds_read_b32 v179, v142 offset:512
    ds_read_b32 v180, v142 offset:640
    buffer_load_dwordx4 v29, s[4:7], s100 offen offset:1024 lds
    ds_read_b32 v181, v142 offset:768
    ds_read_b32 v182, v142 offset:896
    ds_read_b32 v152, v143 offset:0
    ds_read_b32 v153, v143 offset:128
    ds_read_b32 v154, v143 offset:256
    ds_read_b32 v155, v143 offset:384
    ds_read_b32 v156, v143 offset:512
    ds_read_b32 v157, v143 offset:640
    buffer_load_dwordx4 v30, s[4:7], s100 offen offset:2048 lds
    ds_read_b32 v158, v143 offset:768
    ds_read_b32 v159, v143 offset:896
    s_waitcnt vmcnt(13)
    v_lshlrev_b32 v184, 16, v136
    v_lshlrev_b32 v185, 16, v138
    v_and_b32 v186, 0xffff0000, v136
    v_and_b32 v187, 0xffff0000, v138
    v_lshlrev_b32 v188, 16, v137
    v_lshlrev_b32 v189, 16, v139
    buffer_load_dwordx4 v31, s[4:7], s100 offen offset:3072 lds
    v_and_b32 v190, 0xffff0000, v137
    v_and_b32 v191, 0xffff0000, v139
    s_waitcnt lgkmcnt(15)
    v_lshlrev_b32 v192, 16, v172
    v_and_b32 v193, 0xffff0000, v172
    v_lshlrev_b32 v194, 16, v173
    v_and_b32 v195, 0xffff0000, v173
    v_lshlrev_b32 v196, 16, v174
    v_and_b32 v197, 0xffff0000, v174
    s_add_u32 m0, s95, 33792
    s_mul_i32 s100, s99, 229376
    buffer_load_dwordx4 v32, s[20:23], s100 offen lds
    v_lshlrev_b32 v198, 16, v175
    v_and_b32 v199, 0xffff0000, v175
    s_waitcnt lgkmcnt(14)
    v_lshlrev_b32 v200, 16, v176
    v_and_b32 v201, 0xffff0000, v176
    s_waitcnt lgkmcnt(13)
    v_lshlrev_b32 v202, 16, v177
    v_and_b32 v203, 0xffff0000, v177
    s_waitcnt lgkmcnt(12)
    v_lshlrev_b32 v204, 16, v178
    v_and_b32 v205, 0xffff0000, v178
    buffer_load_dwordx4 v33, s[20:23], s100 offen offset:1024 lds
    s_waitcnt lgkmcnt(11)
    v_lshlrev_b32 v206, 16, v179
    v_and_b32 v207, 0xffff0000, v179
    s_waitcnt lgkmcnt(10)
    v_lshlrev_b32 v208, 16, v180
    v_and_b32 v209, 0xffff0000, v180
    s_waitcnt lgkmcnt(9)
    v_lshlrev_b32 v210, 16, v181
    v_and_b32 v211, 0xffff0000, v181
    s_waitcnt lgkmcnt(8)
    v_lshlrev_b32 v212, 16, v182
    v_and_b32 v213, 0xffff0000, v182
    buffer_load_dwordx4 v34, s[20:23], s100 offen offset:2176 lds
    s_waitcnt lgkmcnt(7)
    v_lshlrev_b32 v214, 16, v152
    v_and_b32 v215, 0xffff0000, v152
    s_waitcnt lgkmcnt(6)
    v_lshlrev_b32 v216, 16, v153
    v_and_b32 v217, 0xffff0000, v153
    s_waitcnt lgkmcnt(5)
    v_lshlrev_b32 v218, 16, v154
    v_and_b32 v219, 0xffff0000, v154
    s_waitcnt lgkmcnt(4)
    v_lshlrev_b32 v220, 16, v155
    v_and_b32 v221, 0xffff0000, v155
    buffer_load_dwordx4 v35, s[20:23], s100 offen offset:3200 lds
    s_waitcnt lgkmcnt(3)
    v_lshlrev_b32 v222, 16, v156
    v_and_b32 v223, 0xffff0000, v156
    s_waitcnt lgkmcnt(2)
    v_lshlrev_b32 v224, 16, v157
    v_and_b32 v225, 0xffff0000, v157
    s_waitcnt lgkmcnt(1)
    v_lshlrev_b32 v226, 16, v158
    v_and_b32 v227, 0xffff0000, v158
    s_waitcnt lgkmcnt(0)
    v_lshlrev_b32 v228, 16, v159
    v_and_b32 v229, 0xffff0000, v159
    s_add_u32 m0, s98, 67584
    s_add_u32 s99, s49, 2
    s_and_b32 s99, s99, 7
    s_lshl_b32 s100, s99, 7
    buffer_load_dwordx4 v28, s[4:7], s100 offen lds
    v_pk_mul_f32 v[230:231], v[198:199], v[184:185]
    v_pk_mul_f32 v[232:233], v[200:201], v[184:185]
    v_pk_mul_f32 v[234:235], v[202:203], v[184:185]
    v_pk_mul_f32 v[236:237], v[204:205], v[184:185]
    v_pk_mul_f32 v[238:239], v[206:207], v[184:185]
    v_pk_mul_f32 v[240:241], v[208:209], v[184:185]
    v_pk_mul_f32 v[242:243], v[210:211], v[184:185]
    v_pk_mul_f32 v[244:245], v[212:213], v[184:185]
    buffer_load_dwordx4 v29, s[4:7], s100 offen offset:1024 lds
    v_pk_fma_f32 v[230:231], v[196:197], v[186:187], v[230:231]
    v_pk_fma_f32 v[232:233], v[198:199], v[186:187], v[232:233]
    v_pk_fma_f32 v[234:235], v[200:201], v[186:187], v[234:235]
    v_pk_fma_f32 v[236:237], v[202:203], v[186:187], v[236:237]
    v_pk_fma_f32 v[238:239], v[204:205], v[186:187], v[238:239]
    v_pk_fma_f32 v[240:241], v[206:207], v[186:187], v[240:241]
    v_pk_fma_f32 v[242:243], v[208:209], v[186:187], v[242:243]
    v_pk_fma_f32 v[244:245], v[210:211], v[186:187], v[244:245]
    buffer_load_dwordx4 v30, s[4:7], s100 offen offset:2048 lds
    v_pk_fma_f32 v[230:231], v[194:195], v[188:189], v[230:231]
    v_pk_fma_f32 v[232:233], v[196:197], v[188:189], v[232:233]
    v_pk_fma_f32 v[234:235], v[198:199], v[188:189], v[234:235]
    v_pk_fma_f32 v[236:237], v[200:201], v[188:189], v[236:237]
    v_pk_fma_f32 v[238:239], v[202:203], v[188:189], v[238:239]
    v_pk_fma_f32 v[240:241], v[204:205], v[188:189], v[240:241]
    v_pk_fma_f32 v[242:243], v[206:207], v[188:189], v[242:243]
    v_pk_fma_f32 v[244:245], v[208:209], v[188:189], v[244:245]
    buffer_load_dwordx4 v31, s[4:7], s100 offen offset:3072 lds
    v_pk_fma_f32 v[230:231], v[192:193], v[190:191], v[230:231]
    v_pk_fma_f32 v[232:233], v[194:195], v[190:191], v[232:233]
    v_pk_fma_f32 v[234:235], v[196:197], v[190:191], v[234:235]
    v_pk_fma_f32 v[236:237], v[198:199], v[190:191], v[236:237]
    v_pk_fma_f32 v[238:239], v[200:201], v[190:191], v[238:239]
    v_pk_fma_f32 v[240:241], v[202:203], v[190:191], v[240:241]
    v_pk_fma_f32 v[242:243], v[204:205], v[190:191], v[242:243]
    v_pk_fma_f32 v[244:245], v[206:207], v[190:191], v[244:245]
    s_add_u32 m0, s95, 67584
    s_mul_i32 s100, s99, 229376
    buffer_load_dwordx4 v32, s[20:23], s100 offen lds
    v_pk_mul_f32 v[230:231], v[230:231], v[214:215]
    v_pk_mul_f32 v[232:233], v[232:233], v[216:217]
    v_pk_mul_f32 v[234:235], v[234:235], v[218:219]
    v_pk_mul_f32 v[236:237], v[236:237], v[220:221]
    v_pk_mul_f32 v[238:239], v[238:239], v[222:223]
    v_pk_mul_f32 v[240:241], v[240:241], v[224:225]
    v_pk_mul_f32 v[242:243], v[242:243], v[226:227]
    v_pk_mul_f32 v[244:245], v[244:245], v[228:229]
    buffer_load_dwordx4 v33, s[20:23], s100 offen offset:1024 lds
    v_cvt_pk_bf16_f32 v152, v244, v242
    v_cvt_pk_bf16_f32 v153, v240, v238
    v_cvt_pk_bf16_f32 v154, v236, v234
    v_cvt_pk_bf16_f32 v155, v232, v230
    v_cvt_pk_bf16_f32 v156, v245, v243
    v_cvt_pk_bf16_f32 v157, v241, v239
    v_cvt_pk_bf16_f32 v158, v237, v235
    v_cvt_pk_bf16_f32 v159, v233, v231
    buffer_load_dwordx4 v34, s[20:23], s100 offen offset:2176 lds
    buffer_load_dwordx4 v35, s[20:23], s100 offen offset:3200 lds
    s_lshl_b32 s56, s46, 7
    s_sub_u32 s56, 32768, s56
    buffer_store_dwordx4 v[152:155], v144, s[32:35], s56 offen sc1
    v_add_u32 v8, 4224, v144
    buffer_store_dwordx4 v[156:159], v8, s[32:35], s56 offen sc1
    s_nop 1
    s_waitcnt vmcnt(27)
    v_readfirstlane_b32 s52, v145
    s_nop 3
    s_add_u32 s52, s52, 0x9e3779b9
    s_waitcnt vmcnt(19)
    s_waitcnt lgkmcnt(0)
    s_barrier
    ds_read_b128 v[116:119], v48 offset:0
    ds_read_b128 v[120:123], v48 offset:2048
    ds_read_b64_tr_b16 a[128:129], v36 offset:0
    ds_read_b64_tr_b16 a[130:131], v36 offset:1024
    ds_read_b64_tr_b16 a[132:133], v37 offset:0
    ds_read_b64_tr_b16 a[134:135], v37 offset:1024
    ds_read_b64_tr_b16 a[136:137], v38 offset:0
    ds_read_b64_tr_b16 a[138:139], v38 offset:1024
    ds_read_b64_tr_b16 a[140:141], v39 offset:0
    ds_read_b64_tr_b16 a[142:143], v39 offset:1024
    ds_read_b64_tr_b16 a[144:145], v36 offset:128
    ds_read_b64_tr_b16 a[146:147], v36 offset:1152
    ds_read_b64_tr_b16 a[148:149], v37 offset:128
    ds_read_b64_tr_b16 a[150:151], v37 offset:1152
    ds_read_b64_tr_b16 a[152:153], v38 offset:128
    ds_read_b64_tr_b16 a[154:155], v38 offset:1152
    ds_read_b64_tr_b16 a[156:157], v39 offset:128
    ds_read_b64_tr_b16 a[158:159], v39 offset:1152
    ds_read_b64_tr_b16 a[192:193], v44 offset:0
    ds_read_b64_tr_b16 a[194:195], v44 offset:1024
    ds_read_b64_tr_b16 a[196:197], v45 offset:0
    ds_read_b64_tr_b16 a[198:199], v45 offset:1024
    s_waitcnt lgkmcnt(0)
    v_mfma_f32_16x16x32_bf16 v[52:55], a[128:131], v[116:119], 0
    ds_read_b128 v[124:127], v49 offset:0
    ds_read_b128 v[128:131], v49 offset:2048
    v_mfma_f32_16x16x32_bf16 v[56:59], a[128:131], v[120:123], 0
    ds_read_b64_tr_b16 a[160:161], v36 offset:8704
    ds_read_b64_tr_b16 a[162:163], v36 offset:9728
    v_mfma_f32_16x16x32_bf16 v[60:63], a[132:135], v[116:119], 0
    ds_read_b64_tr_b16 a[164:165], v37 offset:8704
    ds_read_b64_tr_b16 a[166:167], v37 offset:9728
    v_mfma_f32_16x16x32_bf16 v[64:67], a[132:135], v[120:123], 0
    s_add_u32 m0, s98, 101376
    s_add_u32 s99, s49, 3
    s_and_b32 s99, s99, 7
    s_lshl_b32 s100, s99, 7
    buffer_load_dwordx4 v28, s[4:7], s100 offen lds
    ds_read_b64_tr_b16 a[168:169], v38 offset:8704
    ds_read_b64_tr_b16 a[170:171], v38 offset:9728
    v_mfma_f32_16x16x32_bf16 v[68:71], a[136:139], v[116:119], 0
    ds_read_b64_tr_b16 a[172:173], v39 offset:8704
    ds_read_b64_tr_b16 a[174:175], v39 offset:9728
    v_mfma_f32_16x16x32_bf16 v[72:75], a[136:139], v[120:123], 0
    ds_read_b64_tr_b16 a[176:177], v36 offset:8832
    ds_read_b64_tr_b16 a[178:179], v36 offset:9856
    v_mfma_f32_16x16x32_bf16 v[76:79], a[140:143], v[116:119], 0
    ds_read_b64_tr_b16 a[180:181], v37 offset:8832
    ds_read_b64_tr_b16 a[182:183], v37 offset:9856
    v_mfma_f32_16x16x32_bf16 v[80:83], a[140:143], v[120:123], 0
    buffer_load_dwordx4 v29, s[4:7], s100 offen offset:1024 lds
    ds_read_b64_tr_b16 a[184:185], v38 offset:8832
    ds_read_b64_tr_b16 a[186:187], v38 offset:9856
    v_mfma_f32_16x16x32_bf16 v[84:87], a[144:147], v[116:119], 0
    ds_read_b64_tr_b16 a[188:189], v39 offset:8832
    ds_read_b64_tr_b16 a[190:191], v39 offset:9856
    v_mfma_f32_16x16x32_bf16 v[88:91], a[144:147], v[120:123], 0
    ds_read_b64_tr_b16 a[200:201], v44 offset:8704
    ds_read_b64_tr_b16 a[202:203], v44 offset:9728
    v_mfma_f32_16x16x32_bf16 v[92:95], a[148:151], v[116:119], 0
    ds_read_b64_tr_b16 a[204:205], v45 offset:8704
    ds_read_b64_tr_b16 a[206:207], v45 offset:9728
    v_mfma_f32_16x16x32_bf16 v[96:99], a[148:151], v[120:123], 0
    buffer_load_dwordx4 v30, s[4:7], s100 offen offset:2048 lds
    s_mul_i32 s53, s44, 14
    s_add_u32 s60, s53, s63
    v_mfma_f32_16x16x32_bf16 v[100:103], a[152:155], v[116:119], 0
    s_add_u32 s61, s53, 14
    s_lshl_b32 s64, s60, 15
    v_mfma_f32_16x16x32_bf16 v[104:107], a[152:155], v[120:123], 0
    s_add_u32 s64, s64, s94
    s_lshl_b32 s78, s60, 10
    v_mfma_f32_16x16x32_bf16 v[108:111], a[156:159], v[116:119], 0
    s_add_u32 s78, s78, 4456448
    s_add_u32 s60, s60, 1
    v_mfma_f32_16x16x32_bf16 v[112:115], a[156:159], v[120:123], 0
    buffer_load_dwordx4 v31, s[4:7], s100 offen offset:3072 lds
    s_cmp_eq_u32 s60, s61
    s_cselect_b32 s60, s53, s60
    s_lshl_b32 s65, s60, 15
    v_mfma_f32_16x16x32_bf16 a[224:227], v[132:135], a[192:195], a[224:227]
    s_add_u32 s65, s65, s94
    s_lshl_b32 s79, s60, 10
    v_mfma_f32_16x16x32_bf16 a[228:231], v[132:135], a[196:199], a[228:231]
    s_add_u32 s79, s79, 4456448
    s_add_u32 s60, s60, 1
    s_waitcnt vmcnt(14)
    s_waitcnt lgkmcnt(0)
    s_barrier
    s_waitcnt lgkmcnt(0)
    v_mfma_f32_16x16x32_bf16 v[52:55], a[160:163], v[124:127], v[52:55]
    ds_read_b128 v[116:119], v48 offset:33792
    ds_read_b128 v[120:123], v48 offset:35840
    v_mfma_f32_16x16x32_bf16 v[56:59], a[160:163], v[128:131], v[56:59]
    s_add_u32 m0, s95, 101376
    s_mul_i32 s100, s99, 229376
    buffer_load_dwordx4 v32, s[20:23], s100 offen lds
    ds_read_b64_tr_b16 a[128:129], v36 offset:33792
    ds_read_b64_tr_b16 a[130:131], v36 offset:34816
    v_mfma_f32_16x16x32_bf16 v[60:63], a[164:167], v[124:127], v[60:63]
    ds_read_b64_tr_b16 a[132:133], v37 offset:33792
    ds_read_b64_tr_b16 a[134:135], v37 offset:34816
    v_mfma_f32_16x16x32_bf16 v[64:67], a[164:167], v[128:131], v[64:67]
    ds_read_b64_tr_b16 a[136:137], v38 offset:33792
    ds_read_b64_tr_b16 a[138:139], v38 offset:34816
    v_mfma_f32_16x16x32_bf16 v[68:71], a[168:171], v[124:127], v[68:71]
    ds_read_b64_tr_b16 a[140:141], v39 offset:33792
    ds_read_b64_tr_b16 a[142:143], v39 offset:34816
    v_mfma_f32_16x16x32_bf16 v[72:75], a[168:171], v[128:131], v[72:75]
    buffer_load_dwordx4 v33, s[20:23], s100 offen offset:1024 lds
    ds_read_b64_tr_b16 a[144:145], v36 offset:33920
    ds_read_b64_tr_b16 a[146:147], v36 offset:34944
    v_mfma_f32_16x16x32_bf16 v[76:79], a[172:175], v[124:127], v[76:79]
    ds_read_b64_tr_b16 a[148:149], v37 offset:33920
    ds_read_b64_tr_b16 a[150:151], v37 offset:34944
    v_mfma_f32_16x16x32_bf16 v[80:83], a[172:175], v[128:131], v[80:83]
    ds_read_b64_tr_b16 a[152:153], v38 offset:33920
    ds_read_b64_tr_b16 a[154:155], v38 offset:34944
    v_mfma_f32_16x16x32_bf16 v[84:87], a[176:179], v[124:127], v[84:87]
    ds_read_b64_tr_b16 a[156:157], v39 offset:33920
    ds_read_b64_tr_b16 a[158:159], v39 offset:34944
    v_mfma_f32_16x16x32_bf16 v[88:91], a[176:179], v[128:131], v[88:91]
    buffer_load_dwordx4 v34, s[20:23], s100 offen offset:2176 lds
    ds_read_b64_tr_b16 a[192:193], v44 offset:33792
    ds_read_b64_tr_b16 a[194:195], v44 offset:34816
    v_mfma_f32_16x16x32_bf16 v[92:95], a[180:183], v[124:127], v[92:95]
    ds_read_b64_tr_b16 a[196:197], v45 offset:33792
    ds_read_b64_tr_b16 a[198:199], v45 offset:34816
    v_mfma_f32_16x16x32_bf16 v[96:99], a[180:183], v[128:131], v[96:99]
    s_cmp_eq_u32 s60, s61
    s_cselect_b32 s60, s53, s60
    s_lshl_b32 s66, s60, 15
    v_mfma_f32_16x16x32_bf16 v[100:103], a[184:187], v[124:127], v[100:103]
    s_add_u32 s66, s66, s94
    s_lshl_b32 s80, s60, 10
    v_mfma_f32_16x16x32_bf16 v[104:107], a[184:187], v[128:131], v[104:107]
    buffer_load_dwordx4 v35, s[20:23], s100 offen offset:3200 lds
    s_add_u32 s80, s80, 4456448
    s_add_u32 s60, s60, 1
    v_mfma_f32_16x16x32_bf16 v[108:111], a[188:191], v[124:127], v[108:111]
    s_cmp_eq_u32 s60, s61
    s_cselect_b32 s60, s53, s60
    s_lshl_b32 s67, s60, 15
    v_mfma_f32_16x16x32_bf16 v[112:115], a[188:191], v[128:131], v[112:115]
    s_add_u32 s67, s67, s94
    s_lshl_b32 s81, s60, 10
    v_mfma_f32_16x16x32_bf16 a[224:227], v[132:135], a[200:203], a[224:227]
    s_add_u32 s81, s81, 4456448
    s_add_u32 s60, s60, 1
    v_mfma_f32_16x16x32_bf16 a[228:231], v[132:135], a[204:207], a[228:231]
    s_add_u32 m0, s98, 0
    s_add_u32 s99, s49, 4
    s_and_b32 s99, s99, 7
    s_lshl_b32 s100, s99, 7
    buffer_load_dwordx4 v28, s[4:7], s100 offen lds
    s_cmp_eq_u32 s60, s61
    s_cselect_b32 s60, s53, s60
    s_lshl_b32 s68, s60, 15
    s_waitcnt lgkmcnt(0)
    v_mfma_f32_16x16x32_bf16 v[52:55], a[128:131], v[116:119], v[52:55]
    ds_read_b128 v[124:127], v49 offset:33792
    ds_read_b128 v[128:131], v49 offset:35840
    v_mfma_f32_16x16x32_bf16 v[56:59], a[128:131], v[120:123], v[56:59]
    ds_read_b64_tr_b16 a[160:161], v36 offset:42496
    ds_read_b64_tr_b16 a[162:163], v36 offset:43520
    v_mfma_f32_16x16x32_bf16 v[60:63], a[132:135], v[116:119], v[60:63]
    ds_read_b64_tr_b16 a[164:165], v37 offset:42496
    ds_read_b64_tr_b16 a[166:167], v37 offset:43520
    v_mfma_f32_16x16x32_bf16 v[64:67], a[132:135], v[120:123], v[64:67]
    buffer_load_dwordx4 v29, s[4:7], s100 offen offset:1024 lds
    ds_read_b64_tr_b16 a[168:169], v38 offset:42496
    ds_read_b64_tr_b16 a[170:171], v38 offset:43520
    v_mfma_f32_16x16x32_bf16 v[68:71], a[136:139], v[116:119], v[68:71]
    ds_read_b64_tr_b16 a[172:173], v39 offset:42496
    ds_read_b64_tr_b16 a[174:175], v39 offset:43520
    v_mfma_f32_16x16x32_bf16 v[72:75], a[136:139], v[120:123], v[72:75]
    ds_read_b64_tr_b16 a[176:177], v36 offset:42624
    ds_read_b64_tr_b16 a[178:179], v36 offset:43648
    v_mfma_f32_16x16x32_bf16 v[76:79], a[140:143], v[116:119], v[76:79]
    ds_read_b64_tr_b16 a[180:181], v37 offset:42624
    ds_read_b64_tr_b16 a[182:183], v37 offset:43648
    v_mfma_f32_16x16x32_bf16 v[80:83], a[140:143], v[120:123], v[80:83]
    buffer_load_dwordx4 v30, s[4:7], s100 offen offset:2048 lds
    ds_read_b64_tr_b16 a[184:185], v38 offset:42624
    ds_read_b64_tr_b16 a[186:187], v38 offset:43648
    v_mfma_f32_16x16x32_bf16 v[84:87], a[144:147], v[116:119], v[84:87]
    ds_read_b64_tr_b16 a[188:189], v39 offset:42624
    ds_read_b64_tr_b16 a[190:191], v39 offset:43648
    v_mfma_f32_16x16x32_bf16 v[88:91], a[144:147], v[120:123], v[88:91]
    ds_read_b64_tr_b16 a[200:201], v44 offset:42496
    ds_read_b64_tr_b16 a[202:203], v44 offset:43520
    v_mfma_f32_16x16x32_bf16 v[92:95], a[148:151], v[116:119], v[92:95]
    ds_read_b64_tr_b16 a[204:205], v45 offset:42496
    ds_read_b64_tr_b16 a[206:207], v45 offset:43520
    v_mfma_f32_16x16x32_bf16 v[96:99], a[148:151], v[120:123], v[96:99]
    buffer_load_dwordx4 v31, s[4:7], s100 offen offset:3072 lds
    s_add_u32 s68, s68, s94
    s_lshl_b32 s82, s60, 10
    v_mfma_f32_16x16x32_bf16 v[100:103], a[152:155], v[116:119], v[100:103]
    s_add_u32 s82, s82, 4456448
    s_add_u32 s60, s60, 1
    v_mfma_f32_16x16x32_bf16 v[104:107], a[152:155], v[120:123], v[104:107]
    s_cmp_eq_u32 s60, s61
    s_cselect_b32 s60, s53, s60
    s_lshl_b32 s69, s60, 15
    v_mfma_f32_16x16x32_bf16 v[108:111], a[156:159], v[116:119], v[108:111]
    s_add_u32 s69, s69, s94
    s_lshl_b32 s83, s60, 10
    v_mfma_f32_16x16x32_bf16 v[112:115], a[156:159], v[120:123], v[112:115]
    s_add_u32 m0, s95, 0
    s_mul_i32 s100, s99, 229376
    buffer_load_dwordx4 v32, s[20:23], s100 offen lds
    s_add_u32 s83, s83, 4456448
    s_add_u32 s60, s60, 1
    v_mfma_f32_16x16x32_bf16 a[224:227], v[132:135], a[192:195], a[224:227]
    s_cmp_eq_u32 s60, s61
    s_cselect_b32 s60, s53, s60
    s_lshl_b32 s70, s60, 15
    v_mfma_f32_16x16x32_bf16 a[228:231], v[132:135], a[196:199], a[228:231]
    s_add_u32 s70, s70, s94
    s_lshl_b32 s84, s60, 10
    s_waitcnt vmcnt(15)
    s_waitcnt vmcnt(13)
    s_waitcnt lgkmcnt(0)
    s_barrier
    s_cmp_eq_u32 s44, 0
    s_cbranch_scc0 Lmfl_2
    s_lshl_b32 s101, s45, 6
    s_add_u32 s101, s101, s46
    s_lshl_b32 s101, s101, 2
    s_add_u32 s101, s101, 1024
    v_mov_b32 v9, s101
    s_lshr_b32 s101, s92, 4
    s_lshl_b32 s101, s101, 6
    s_and_b32 s62, s92, 15
    s_add_u32 s101, s101, s62
    s_lshl_b32 s101, s101, 2
    s_add_u32 s101, s101, 4096
    v_writelane_b32 v9, s101, 1
    v_mov_b32 v10, s52
    s_mov_b64 exec, 3
    buffer_store_dword v10, v9, s[32:35], 0 offen sc1
    s_mov_b64 exec, -1
Lmfl_2:
    s_waitcnt lgkmcnt(0)
    v_mfma_f32_16x16x32_bf16 v[52:55], a[160:163], v[124:127], v[52:55]
    ds_read_b128 v[116:119], v50 offset:0
    ds_read_b128 v[120:123], v50 offset:2048
    v_mfma_f32_16x16x32_bf16 v[56:59], a[160:163], v[128:131], v[56:59]
    buffer_load_dwordx4 v33, s[20:23], s100 offen offset:1024 lds
    ds_read_b64_tr_b16 a[128:129], v40 offset:0
    ds_read_b64_tr_b16 a[130:131], v40 offset:1024
    v_mfma_f32_16x16x32_bf16 v[60:63], a[164:167], v[124:127], v[60:63]
    ds_read_b64_tr_b16 a[132:133], v41 offset:0
    ds_read_b64_tr_b16 a[134:135], v41 offset:1024
    v_mfma_f32_16x16x32_bf16 v[64:67], a[164:167], v[128:131], v[64:67]
    ds_read_b64_tr_b16 a[136:137], v42 offset:0
    ds_read_b64_tr_b16 a[138:139], v42 offset:1024
    v_mfma_f32_16x16x32_bf16 v[68:71], a[168:171], v[124:127], v[68:71]
    ds_read_b64_tr_b16 a[140:141], v43 offset:0
    ds_read_b64_tr_b16 a[142:143], v43 offset:1024
    v_mfma_f32_16x16x32_bf16 v[72:75], a[168:171], v[128:131], v[72:75]
    buffer_load_dwordx4 v34, s[20:23], s100 offen offset:2176 lds
    ds_read_b64_tr_b16 a[144:145], v40 offset:128
    ds_read_b64_tr_b16 a[146:147], v40 offset:1152
    v_mfma_f32_16x16x32_bf16 v[76:79], a[172:175], v[124:127], v[76:79]
    ds_read_b64_tr_b16 a[148:149], v41 offset:128
    ds_read_b64_tr_b16 a[150:151], v41 offset:1152
    v_mfma_f32_16x16x32_bf16 v[80:83], a[172:175], v[128:131], v[80:83]
    ds_read_b64_tr_b16 a[152:153], v42 offset:128
    ds_read_b64_tr_b16 a[154:155], v42 offset:1152
    v_mfma_f32_16x16x32_bf16 v[84:87], a[176:179], v[124:127], v[84:87]
    ds_read_b64_tr_b16 a[156:157], v43 offset:128
    ds_read_b64_tr_b16 a[158:159], v43 offset:1152
    v_mfma_f32_16x16x32_bf16 v[88:91], a[176:179], v[128:131], v[88:91]
    buffer_load_dwordx4 v35, s[20:23], s100 offen offset:3200 lds
    ds_read_b64_tr_b16 a[192:193], v46 offset:0
    ds_read_b64_tr_b16 a[194:195], v46 offset:1024
    v_mfma_f32_16x16x32_bf16 v[92:95], a[180:183], v[124:127], v[92:95]
    ds_read_b64_tr_b16 a[196:197], v47 offset:0
    ds_read_b64_tr_b16 a[198:199], v47 offset:1024
    v_mfma_f32_16x16x32_bf16 v[96:99], a[180:183], v[128:131], v[96:99]
    s_add_u32 s84, s84, 4456448
    s_add_u32 s60, s60, 1
    v_mfma_f32_16x16x32_bf16 v[100:103], a[184:187], v[124:127], v[100:103]
    s_cmp_eq_u32 s60, s61
    s_cselect_b32 s60, s53, s60
    s_lshl_b32 s71, s60, 15
    v_mfma_f32_16x16x32_bf16 v[104:107], a[184:187], v[128:131], v[104:107]
    s_add_u32 m0, s98, 33792
    s_add_u32 s99, s49, 5
    s_and_b32 s99, s99, 7
    s_lshl_b32 s100, s99, 7
    buffer_load_dwordx4 v28, s[4:7], s100 offen lds
    s_add_u32 s71, s71, s94
    s_lshl_b32 s85, s60, 10
    v_mfma_f32_16x16x32_bf16 v[108:111], a[188:191], v[124:127], v[108:111]
    s_add_u32 s85, s85, 4456448
    s_add_u32 s60, s60, 1
    v_mfma_f32_16x16x32_bf16 v[112:115], a[188:191], v[128:131], v[112:115]
    s_cmp_eq_u32 s60, s61
    s_cselect_b32 s60, s53, s60
    s_lshl_b32 s72, s60, 15
    v_mfma_f32_16x16x32_bf16 a[224:227], v[132:135], a[200:203], a[224:227]
    s_add_u32 s72, s72, s94
    s_lshl_b32 s86, s60, 10
    v_mfma_f32_16x16x32_bf16 a[228:231], v[132:135], a[204:207], a[228:231]
    buffer_load_dwordx4 v29, s[4:7], s100 offen offset:1024 lds
    s_add_u32 s86, s86, 4456448
    s_add_u32 s60, s60, 1
    s_waitcnt lgkmcnt(0)
    v_mfma_f32_16x16x32_bf16 v[52:55], a[128:131], v[116:119], v[52:55]
    ds_read_b128 v[124:127], v51 offset:0
    ds_read_b128 v[128:131], v51 offset:2048
    v_mfma_f32_16x16x32_bf16 v[56:59], a[128:131], v[120:123], v[56:59]
    ds_read_b64_tr_b16 a[160:161], v40 offset:8704
    ds_read_b64_tr_b16 a[162:163], v40 offset:9728
    v_mfma_f32_16x16x32_bf16 v[60:63], a[132:135], v[116:119], v[60:63]
    ds_read_b64_tr_b16 a[164:165], v41 offset:8704
    ds_read_b64_tr_b16 a[166:167], v41 offset:9728
    v_mfma_f32_16x16x32_bf16 v[64:67], a[132:135], v[120:123], v[64:67]
    buffer_load_dwordx4 v30, s[4:7], s100 offen offset:2048 lds
    ds_read_b64_tr_b16 a[168:169], v42 offset:8704
    ds_read_b64_tr_b16 a[170:171], v42 offset:9728
    v_mfma_f32_16x16x32_bf16 v[68:71], a[136:139], v[116:119], v[68:71]
    ds_read_b64_tr_b16 a[172:173], v43 offset:8704
    ds_read_b64_tr_b16 a[174:175], v43 offset:9728
    v_mfma_f32_16x16x32_bf16 v[72:75], a[136:139], v[120:123], v[72:75]
    ds_read_b64_tr_b16 a[176:177], v40 offset:8832
    ds_read_b64_tr_b16 a[178:179], v40 offset:9856
    v_mfma_f32_16x16x32_bf16 v[76:79], a[140:143], v[116:119], v[76:79]
    ds_read_b64_tr_b16 a[180:181], v41 offset:8832
    ds_read_b64_tr_b16 a[182:183], v41 offset:9856
    v_mfma_f32_16x16x32_bf16 v[80:83], a[140:143], v[120:123], v[80:83]
    buffer_load_dwordx4 v31, s[4:7], s100 offen offset:3072 lds
    ds_read_b64_tr_b16 a[184:185], v42 offset:8832
    ds_read_b64_tr_b16 a[186:187], v42 offset:9856
    v_mfma_f32_16x16x32_bf16 v[84:87], a[144:147], v[116:119], v[84:87]
    ds_read_b64_tr_b16 a[188:189], v43 offset:8832
    ds_read_b64_tr_b16 a[190:191], v43 offset:9856
    v_mfma_f32_16x16x32_bf16 v[88:91], a[144:147], v[120:123], v[88:91]
    ds_read_b64_tr_b16 a[200:201], v46 offset:8704
    ds_read_b64_tr_b16 a[202:203], v46 offset:9728
    v_mfma_f32_16x16x32_bf16 v[92:95], a[148:151], v[116:119], v[92:95]
    ds_read_b64_tr_b16 a[204:205], v47 offset:8704
    ds_read_b64_tr_b16 a[206:207], v47 offset:9728
    v_mfma_f32_16x16x32_bf16 v[96:99], a[148:151], v[120:123], v[96:99]
    s_add_u32 m0, s95, 33792
    s_mul_i32 s100, s99, 229376
    buffer_load_dwordx4 v32, s[20:23], s100 offen lds
    s_cmp_eq_u32 s60, s61
    s_cselect_b32 s60, s53, s60
    s_lshl_b32 s73, s60, 15
    v_mfma_f32_16x16x32_bf16 v[100:103], a[152:155], v[116:119], v[100:103]
    s_add_u32 s73, s73, s94
    s_lshl_b32 s87, s60, 10
    v_mfma_f32_16x16x32_bf16 v[104:107], a[152:155], v[120:123], v[104:107]
    s_add_u32 s87, s87, 4456448
    s_add_u32 s60, s60, 1
    v_mfma_f32_16x16x32_bf16 v[108:111], a[156:159], v[116:119], v[108:111]
    s_cmp_eq_u32 s60, s61
    s_cselect_b32 s60, s53, s60
    s_lshl_b32 s74, s60, 15
    v_mfma_f32_16x16x32_bf16 v[112:115], a[156:159], v[120:123], v[112:115]
    buffer_load_dwordx4 v33, s[20:23], s100 offen offset:1024 lds
    s_add_u32 s74, s74, s94
    s_lshl_b32 s88, s60, 10
    v_mfma_f32_16x16x32_bf16 a[224:227], v[132:135], a[192:195], a[224:227]
    s_add_u32 s88, s88, 4456448
    s_add_u32 s60, s60, 1
    v_mfma_f32_16x16x32_bf16 a[228:231], v[132:135], a[196:199], a[228:231]
    s_cmp_eq_u32 s60, s61
    s_cselect_b32 s60, s53, s60
    s_lshl_b32 s75, s60, 15
    s_waitcnt vmcnt(14)
    s_waitcnt lgkmcnt(0)
    s_barrier
    s_waitcnt lgkmcnt(0)
    v_mfma_f32_16x16x32_bf16 v[52:55], a[160:163], v[124:127], v[52:55]
    ds_read_b128 v[116:119], v50 offset:33792
    ds_read_b128 v[120:123], v50 offset:35840
    v_mfma_f32_16x16x32_bf16 v[56:59], a[160:163], v[128:131], v[56:59]
    buffer_load_dwordx4 v34, s[20:23], s100 offen offset:2176 lds
    ds_read_b64_tr_b16 a[128:129], v40 offset:33792
    ds_read_b64_tr_b16 a[130:131], v40 offset:34816
    v_mfma_f32_16x16x32_bf16 v[60:63], a[164:167], v[124:127], v[60:63]
    ds_read_b64_tr_b16 a[132:133], v41 offset:33792
    ds_read_b64_tr_b16 a[134:135], v41 offset:34816
    v_mfma_f32_16x16x32_bf16 v[64:67], a[164:167], v[128:131], v[64:67]
    ds_read_b64_tr_b16 a[136:137], v42 offset:33792
    ds_read_b64_tr_b16 a[138:139], v42 offset:34816
    v_mfma_f32_16x16x32_bf16 v[68:71], a[168:171], v[124:127], v[68:71]
    ds_read_b64_tr_b16 a[140:141], v43 offset:33792
    ds_read_b64_tr_b16 a[142:143], v43 offset:34816
    v_mfma_f32_16x16x32_bf16 v[72:75], a[168:171], v[128:131], v[72:75]
    buffer_load_dwordx4 v35, s[20:23], s100 offen offset:3200 lds
    ds_read_b64_tr_b16 a[144:145], v40 offset:33920
    ds_read_b64_tr_b16 a[146:147], v40 offset:34944
    v_mfma_f32_16x16x32_bf16 v[76:79], a[172:175], v[124:127], v[76:79]
    ds_read_b64_tr_b16 a[148:149], v41 offset:33920
    ds_read_b64_tr_b16 a[150:151], v41 offset:34944
    v_mfma_f32_16x16x32_bf16 v[80:83], a[172:175], v[128:131], v[80:83]
    ds_read_b64_tr_b16 a[152:153], v42 offset:33920
    ds_read_b64_tr_b16 a[154:155], v42 offset:34944
    v_mfma_f32_16x16x32_bf16 v[84:87], a[176:179], v[124:127], v[84:87]
    ds_read_b64_tr_b16 a[156:157], v43 offset:33920
    ds_read_b64_tr_b16 a[158:159], v43 offset:34944
    v_mfma_f32_16x16x32_bf16 v[88:91], a[176:179], v[128:131], v[88:91]
    s_add_u32 m0, s98, 67584
    s_add_u32 s99, s49, 6
    s_and_b32 s99, s99, 7
    s_lshl_b32 s100, s99, 7
    buffer_load_dwordx4 v28, s[4:7], s100 offen lds
    ds_read_b64_tr_b16 a[192:193], v46 offset:33792
    ds_read_b64_tr_b16 a[194:195], v46 offset:34816
    v_mfma_f32_16x16x32_bf16 v[92:95], a[180:183], v[124:127], v[92:95]
    ds_read_b64_tr_b16 a[196:197], v47 offset:33792
    ds_read_b64_tr_b16 a[198:199], v47 offset:34816
    v_mfma_f32_16x16x32_bf16 v[96:99], a[180:183], v[128:131], v[96:99]
    s_add_u32 s75, s75, s94
    s_lshl_b32 s89, s60, 10
    v_mfma_f32_16x16x32_bf16 v[100:103], a[184:187], v[124:127], v[100:103]
    s_add_u32 s89, s89, 4456448
    s_add_u32 s60, s60, 1
    v_mfma_f32_16x16x32_bf16 v[104:107], a[184:187], v[128:131], v[104:107]
    buffer_load_dwordx4 v29, s[4:7], s100 offen offset:1024 lds
    s_cmp_eq_u32 s60, s61
    s_cselect_b32 s60, s53, s60
    s_lshl_b32 s76, s60, 15
    v_mfma_f32_16x16x32_bf16 v[108:111], a[188:191], v[124:127], v[108:111]
    s_add_u32 s76, s76, s94
    s_lshl_b32 s90, s60, 10
    v_mfma_f32_16x16x32_bf16 v[112:115], a[188:191], v[128:131], v[112:115]
    s_add_u32 s90, s90, 4456448
    s_add_u32 s60, s60, 1
    v_mfma_f32_16x16x32_bf16 a[224:227], v[132:135], a[200:203], a[224:227]
    s_cmp_eq_u32 s60, s61
    s_cselect_b32 s60, s53, s60
    s_lshl_b32 s77, s60, 15
    v_mfma_f32_16x16x32_bf16 a[228:231], v[132:135], a[204:207], a[228:231]
    buffer_load_dwordx4 v30, s[4:7], s100 offen offset:2048 lds
    s_add_u32 s77, s77, s94
    s_lshl_b32 s91, s60, 10
    s_waitcnt lgkmcnt(0)
    v_mfma_f32_16x16x32_bf16 v[52:55], a[128:131], v[116:119], v[52:55]
    ds_read_b128 v[124:127], v51 offset:33792
    ds_read_b128 v[128:131], v51 offset:35840
    v_mfma_f32_16x16x32_bf16 v[56:59], a[128:131], v[120:123], v[56:59]
    ds_read_b64_tr_b16 a[160:161], v40 offset:42496
    ds_read_b64_tr_b16 a[162:163], v40 offset:43520
    v_mfma_f32_16x16x32_bf16 v[60:63], a[132:135], v[116:119], v[60:63]
    ds_read_b64_tr_b16 a[164:165], v41 offset:42496
    ds_read_b64_tr_b16 a[166:167], v41 offset:43520
    v_mfma_f32_16x16x32_bf16 v[64:67], a[132:135], v[120:123], v[64:67]
    buffer_load_dwordx4 v31, s[4:7], s100 offen offset:3072 lds
    ds_read_b64_tr_b16 a[168:169], v42 offset:42496
    ds_read_b64_tr_b16 a[170:171], v42 offset:43520
    v_mfma_f32_16x16x32_bf16 v[68:71], a[136:139], v[116:119], v[68:71]
    ds_read_b64_tr_b16 a[172:173], v43 offset:42496
    ds_read_b64_tr_b16 a[174:175], v43 offset:43520
    v_mfma_f32_16x16x32_bf16 v[72:75], a[136:139], v[120:123], v[72:75]
    ds_read_b64_tr_b16 a[176:177], v40 offset:42624
    ds_read_b64_tr_b16 a[178:179], v40 offset:43648
    v_mfma_f32_16x16x32_bf16 v[76:79], a[140:143], v[116:119], v[76:79]
    ds_read_b64_tr_b16 a[180:181], v41 offset:42624
    ds_read_b64_tr_b16 a[182:183], v41 offset:43648
    v_mfma_f32_16x16x32_bf16 v[80:83], a[140:143], v[120:123], v[80:83]
    s_add_u32 m0, s95, 67584
    s_mul_i32 s100, s99, 229376
    buffer_load_dwordx4 v32, s[20:23], s100 offen lds
    ds_read_b64_tr_b16 a[184:185], v42 offset:42624
    ds_read_b64_tr_b16 a[186:187], v42 offset:43648
    v_mfma_f32_16x16x32_bf16 v[84:87], a[144:147], v[116:119], v[84:87]
    ds_read_b64_tr_b16 a[188:189], v43 offset:42624
    ds_read_b64_tr_b16 a[190:191], v43 offset:43648
    v_mfma_f32_16x16x32_bf16 v[88:91], a[144:147], v[120:123], v[88:91]
    ds_read_b64_tr_b16 a[200:201], v46 offset:42496
    ds_read_b64_tr_b16 a[202:203], v46 offset:43520
    v_mfma_f32_16x16x32_bf16 v[92:95], a[148:151], v[116:119], v[92:95]
    ds_read_b64_tr_b16 a[204:205], v47 offset:42496
    ds_read_b64_tr_b16 a[206:207], v47 offset:43520
    v_mfma_f32_16x16x32_bf16 v[96:99], a[148:151], v[120:123], v[96:99]
    buffer_load_dwordx4 v33, s[20:23], s100 offen offset:1024 lds
    s_add_u32 s91, s91, 4456448
    v_lshlrev_b32 v7, 1, v4
    v_mfma_f32_16x16x32_bf16 v[100:103], a[152:155], v[116:119], v[100:103]
    v_xor_b32 v6, v24, v7
    v_lshlrev_b32 v5, 10, v23
    v_mfma_f32_16x16x32_bf16 v[104:107], a[152:155], v[120:123], v[104:107]
    v_lshl_add_u32 v11, v6, 4, v5
    v_add_u32 v12, 7168, v11
    v_mfma_f32_16x16x32_bf16 v[108:111], a[156:159], v[116:119], v[108:111]
    v_add_u32 v13, 14336, v11
    v_add_u32 v14, 21504, v11
    v_mfma_f32_16x16x32_bf16 v[112:115], a[156:159], v[120:123], v[112:115]
    buffer_load_dwordx4 v34, s[20:23], s100 offen offset:2176 lds
    v_lshrrev_b32 v5, 2, v1
    v_lshrrev_b32 v6, 1, v5
    v_mfma_f32_16x16x32_bf16 a[224:227], v[132:135], a[192:195], a[224:227]
    v_and_b32 v6, 3, v6
    v_lshlrev_b32 v5, 7, v5
    v_mfma_f32_16x16x32_bf16 a[228:231], v[132:135], a[196:199], a[228:231]
    v_and_b32 v7, 3, v1
    v_lshl_add_u32 v5, v7, 3, v5
    s_waitcnt vmcnt(15)
    s_waitcnt lgkmcnt(0)
    s_barrier
    s_waitcnt lgkmcnt(0)
    v_mfma_f32_16x16x32_bf16 v[52:55], a[160:163], v[124:127], v[52:55]
    ds_read_b128 v[116:119], v48 offset:0
    ds_read_b128 v[120:123], v48 offset:2048
    v_mfma_f32_16x16x32_bf16 v[56:59], a[160:163], v[128:131], v[56:59]
    buffer_load_dwordx4 v35, s[20:23], s100 offen offset:3200 lds
    ds_read_b64_tr_b16 a[128:129], v36 offset:0
    ds_read_b64_tr_b16 a[130:131], v36 offset:1024
    v_mfma_f32_16x16x32_bf16 v[60:63], a[164:167], v[124:127], v[60:63]
    ds_read_b64_tr_b16 a[132:133], v37 offset:0
    ds_read_b64_tr_b16 a[134:135], v37 offset:1024
    v_mfma_f32_16x16x32_bf16 v[64:67], a[164:167], v[128:131], v[64:67]
    ds_read_b64_tr_b16 a[136:137], v38 offset:0
    ds_read_b64_tr_b16 a[138:139], v38 offset:1024
    v_mfma_f32_16x16x32_bf16 v[68:71], a[168:171], v[124:127], v[68:71]
    ds_read_b64_tr_b16 a[140:141], v39 offset:0
    ds_read_b64_tr_b16 a[142:143], v39 offset:1024
    v_mfma_f32_16x16x32_bf16 v[72:75], a[168:171], v[128:131], v[72:75]
    s_add_u32 m0, s98, 101376
    s_add_u32 s99, s49, 7
    s_and_b32 s99, s99, 7
    s_lshl_b32 s100, s99, 7
    buffer_load_dwordx4 v28, s[4:7], s100 offen lds
    ds_read_b64_tr_b16 a[144:145], v36 offset:128
    ds_read_b64_tr_b16 a[146:147], v36 offset:1152
    v_mfma_f32_16x16x32_bf16 v[76:79], a[172:175], v[124:127], v[76:79]
    ds_read_b64_tr_b16 a[148:149], v37 offset:128
    ds_read_b64_tr_b16 a[150:151], v37 offset:1152
    v_mfma_f32_16x16x32_bf16 v[80:83], a[172:175], v[128:131], v[80:83]
    ds_read_b64_tr_b16 a[152:153], v38 offset:128
    ds_read_b64_tr_b16 a[154:155], v38 offset:1152
    v_mfma_f32_16x16x32_bf16 v[84:87], a[176:179], v[124:127], v[84:87]
    ds_read_b64_tr_b16 a[156:157], v39 offset:128
    ds_read_b64_tr_b16 a[158:159], v39 offset:1152
    v_mfma_f32_16x16x32_bf16 v[88:91], a[176:179], v[128:131], v[88:91]
    buffer_load_dwordx4 v29, s[4:7], s100 offen offset:1024 lds
    ds_read_b64_tr_b16 a[192:193], v44 offset:0
    ds_read_b64_tr_b16 a[194:195], v44 offset:1024
    v_mfma_f32_16x16x32_bf16 v[92:95], a[180:183], v[124:127], v[92:95]
    ds_read_b64_tr_b16 a[196:197], v45 offset:0
    ds_read_b64_tr_b16 a[198:199], v45 offset:1024
    v_mfma_f32_16x16x32_bf16 v[96:99], a[180:183], v[128:131], v[96:99]
    v_add_u32 v5, s93, v5
    v_xor_b32 v7, 0, v6
    v_mfma_f32_16x16x32_bf16 v[100:103], a[184:187], v[124:127], v[100:103]
    v_lshl_add_u32 v15, v7, 5, v5
    v_add_u32 v19, 67584, v15
    v_mfma_f32_16x16x32_bf16 v[104:107], a[184:187], v[128:131], v[104:107]
    buffer_load_dwordx4 v30, s[4:7], s100 offen offset:2048 lds
    v_xor_b32 v7, 1, v6
    v_lshl_add_u32 v16, v7, 5, v5
    v_mfma_f32_16x16x32_bf16 v[108:111], a[188:191], v[124:127], v[108:111]
    v_add_u32 v20, 67584, v16
    v_xor_b32 v7, 2, v6
    v_mfma_f32_16x16x32_bf16 v[112:115], a[188:191], v[128:131], v[112:115]
    v_lshl_add_u32 v17, v7, 5, v5
    v_add_u32 v21, 67584, v17
    v_mfma_f32_16x16x32_bf16 a[224:227], v[132:135], a[200:203], a[224:227]
    v_xor_b32 v7, 3, v6
    v_lshl_add_u32 v18, v7, 5, v5
    v_mfma_f32_16x16x32_bf16 a[228:231], v[132:135], a[204:207], a[228:231]
    buffer_load_dwordx4 v31, s[4:7], s100 offen offset:3072 lds
    v_add_u32 v22, 67584, v18
    s_waitcnt lgkmcnt(0)
    v_mfma_f32_16x16x32_bf16 v[52:55], a[128:131], v[116:119], v[52:55]
    ds_read_b128 v[124:127], v49 offset:0
    ds_read_b128 v[128:131], v49 offset:2048
    v_mfma_f32_16x16x32_bf16 v[56:59], a[128:131], v[120:123], v[56:59]
    ds_read_b64_tr_b16 a[160:161], v36 offset:8704
    ds_read_b64_tr_b16 a[162:163], v36 offset:9728
    v_mfma_f32_16x16x32_bf16 v[60:63], a[132:135], v[116:119], v[60:63]
    ds_read_b64_tr_b16 a[164:165], v37 offset:8704
    ds_read_b64_tr_b16 a[166:167], v37 offset:9728
    v_mfma_f32_16x16x32_bf16 v[64:67], a[132:135], v[120:123], v[64:67]
    s_add_u32 m0, s95, 101376
    s_mul_i32 s100, s99, 229376
    buffer_load_dwordx4 v32, s[20:23], s100 offen lds
    ds_read_b64_tr_b16 a[168:169], v38 offset:8704
    ds_read_b64_tr_b16 a[170:171], v38 offset:9728
    v_mfma_f32_16x16x32_bf16 v[68:71], a[136:139], v[116:119], v[68:71]
    ds_read_b64_tr_b16 a[172:173], v39 offset:8704
    ds_read_b64_tr_b16 a[174:175], v39 offset:9728
    v_mfma_f32_16x16x32_bf16 v[72:75], a[136:139], v[120:123], v[72:75]
    ds_read_b64_tr_b16 a[176:177], v36 offset:8832
    ds_read_b64_tr_b16 a[178:179], v36 offset:9856
    v_mfma_f32_16x16x32_bf16 v[76:79], a[140:143], v[116:119], v[76:79]
    ds_read_b64_tr_b16 a[180:181], v37 offset:8832
    ds_read_b64_tr_b16 a[182:183], v37 offset:9856
    v_mfma_f32_16x16x32_bf16 v[80:83], a[140:143], v[120:123], v[80:83]
    buffer_load_dwordx4 v33, s[20:23], s100 offen offset:1024 lds
    ds_read_b64_tr_b16 a[184:185], v38 offset:8832
    ds_read_b64_tr_b16 a[186:187], v38 offset:9856
    v_mfma_f32_16x16x32_bf16 v[84:87], a[144:147], v[116:119], v[84:87]
    ds_read_b64_tr_b16 a[188:189], v39 offset:8832
    ds_read_b64_tr_b16 a[190:191], v39 offset:9856
    v_mfma_f32_16x16x32_bf16 v[88:91], a[144:147], v[120:123], v[88:91]
    ds_read_b64_tr_b16 a[200:201], v44 offset:8704
    ds_read_b64_tr_b16 a[202:203], v44 offset:9728
    v_mfma_f32_16x16x32_bf16 v[92:95], a[148:151], v[116:119], v[92:95]
    ds_read_b64_tr_b16 a[204:205], v45 offset:8704
    ds_read_b64_tr_b16 a[206:207], v45 offset:9728
    v_mfma_f32_16x16x32_bf16 v[96:99], a[148:151], v[120:123], v[96:99]
    buffer_load_dwordx4 v34, s[20:23], s100 offen offset:2176 lds
    v_mfma_f32_16x16x32_bf16 v[100:103], a[152:155], v[116:119], v[100:103]
    v_mfma_f32_16x16x32_bf16 v[104:107], a[152:155], v[120:123], v[104:107]
    v_mfma_f32_16x16x32_bf16 v[108:111], a[156:159], v[116:119], v[108:111]
    v_mfma_f32_16x16x32_bf16 v[112:115], a[156:159], v[120:123], v[112:115]
    buffer_load_dwordx4 v35, s[20:23], s100 offen offset:3200 lds
    v_mfma_f32_16x16x32_bf16 a[224:227], v[132:135], a[192:195], a[224:227]
    v_mfma_f32_16x16x32_bf16 a[228:231], v[132:135], a[196:199], a[228:231]
    s_waitcnt vmcnt(16)
    s_waitcnt lgkmcnt(0)
    s_barrier
    s_waitcnt lgkmcnt(0)
    v_mfma_f32_16x16x32_bf16 v[52:55], a[160:163], v[124:127], v[52:55]
    ds_read_b128 v[116:119], v48 offset:33792
    ds_read_b128 v[120:123], v48 offset:35840
    v_mfma_f32_16x16x32_bf16 v[56:59], a[160:163], v[128:131], v[56:59]
    s_cmp_eq_u32 s44, 0
    s_cbranch_scc0 Lmpi_3
    buffer_load_dword v27, v26, s[32:35], 0 offen sc1
Lmpi_3:
    ds_read_b64_tr_b16 a[128:129], v36 offset:33792
    ds_read_b64_tr_b16 a[130:131], v36 offset:34816
    v_mfma_f32_16x16x32_bf16 v[60:63], a[164:167], v[124:127], v[60:63]
    ds_read_b64_tr_b16 a[132:133], v37 offset:33792
    ds_read_b64_tr_b16 a[134:135], v37 offset:34816
    v_mfma_f32_16x16x32_bf16 v[64:67], a[164:167], v[128:131], v[64:67]
    ds_read_b64_tr_b16 a[136:137], v38 offset:33792
    ds_read_b64_tr_b16 a[138:139], v38 offset:34816
    v_mfma_f32_16x16x32_bf16 v[68:71], a[168:171], v[124:127], v[68:71]
    ds_read_b64_tr_b16 a[140:141], v39 offset:33792
    ds_read_b64_tr_b16 a[142:143], v39 offset:34816
    v_mfma_f32_16x16x32_bf16 v[72:75], a[168:171], v[128:131], v[72:75]
    s_lshr_b32 s99, s44, 1
    s_mul_i32 s99, s99, 4224
    s_and_b32 s100, s44, 1
    s_lshl_b32 s100, s100, 11
    s_add_u32 s99, s99, s100
    s_add_u32 m0, s99, 135296
    s_lshl_b32 s99, s3, 12
    s_add_u32 s99, s99, s100
    buffer_load_dwordx4 v2, s[16:19], s99 offen lds
    buffer_load_dwordx4 v2, s[16:19], s99 offen offset:1024 lds
    ds_read_b64_tr_b16 a[144:145], v36 offset:33920
    ds_read_b64_tr_b16 a[146:147], v36 offset:34944
    v_mfma_f32_16x16x32_bf16 v[76:79], a[172:175], v[124:127], v[76:79]
    ds_read_b64_tr_b16 a[148:149], v37 offset:33920
    ds_read_b64_tr_b16 a[150:151], v37 offset:34944
    v_mfma_f32_16x16x32_bf16 v[80:83], a[172:175], v[128:131], v[80:83]
    ds_read_b64_tr_b16 a[152:153], v38 offset:33920
    ds_read_b64_tr_b16 a[154:155], v38 offset:34944
    v_mfma_f32_16x16x32_bf16 v[84:87], a[176:179], v[124:127], v[84:87]
    ds_read_b64_tr_b16 a[156:157], v39 offset:33920
    ds_read_b64_tr_b16 a[158:159], v39 offset:34944
    v_mfma_f32_16x16x32_bf16 v[88:91], a[176:179], v[128:131], v[88:91]
    s_lshl_b32 s99, s3, 12
    v_mov_b32 v160, s99
    buffer_load_ushort v160, v160, s[16:19], 0 offen
    s_lshl_b32 s99, s3, 1
    v_mov_b32 v161, s99
    global_load_ushort v161, v161, s[38:39]
    ds_read_b64_tr_b16 a[192:193], v44 offset:33792
    ds_read_b64_tr_b16 a[194:195], v44 offset:34816
    v_mfma_f32_16x16x32_bf16 v[92:95], a[180:183], v[124:127], v[92:95]
    ds_read_b64_tr_b16 a[196:197], v45 offset:33792
    ds_read_b64_tr_b16 a[198:199], v45 offset:34816
    v_mfma_f32_16x16x32_bf16 v[96:99], a[180:183], v[128:131], v[96:99]
    v_mfma_f32_16x16x32_bf16 v[100:103], a[184:187], v[124:127], v[100:103]
    v_mfma_f32_16x16x32_bf16 v[104:107], a[184:187], v[128:131], v[104:107]
    s_mul_i32 s99, s92, 7
    s_add_u32 s99, s99, s44
    s_add_u32 s99, s99, 0
    s_lshl_b32 s99, s99, 10
    buffer_load_dwordx4 v[164:167], v2, s[24:27], s99 offen
    v_mfma_f32_16x16x32_bf16 v[108:111], a[188:191], v[124:127], v[108:111]
    v_mfma_f32_16x16x32_bf16 v[112:115], a[188:191], v[128:131], v[112:115]
    v_mfma_f32_16x16x32_bf16 a[224:227], v[132:135], a[200:203], a[224:227]
    v_mfma_f32_16x16x32_bf16 a[228:231], v[132:135], a[204:207], a[228:231]
    s_mul_i32 s99, s92, 7
    s_add_u32 s99, s99, s44
    s_add_u32 s99, s99, 4
    s_lshl_b32 s99, s99, 10
    buffer_load_dwordx4 v[168:171], v2, s[24:27], s99 offen
    s_waitcnt lgkmcnt(0)
    v_mfma_f32_16x16x32_bf16 v[52:55], a[128:131], v[116:119], v[52:55]
    ds_read_b128 v[124:127], v49 offset:33792
    ds_read_b128 v[128:131], v49 offset:35840
    v_mfma_f32_16x16x32_bf16 v[56:59], a[128:131], v[120:123], v[56:59]
    ds_read_b64_tr_b16 a[160:161], v36 offset:42496
    ds_read_b64_tr_b16 a[162:163], v36 offset:43520
    v_mfma_f32_16x16x32_bf16 v[60:63], a[132:135], v[116:119], v[60:63]
    ds_read_b64_tr_b16 a[164:165], v37 offset:42496
    ds_read_b64_tr_b16 a[166:167], v37 offset:43520
    v_mfma_f32_16x16x32_bf16 v[64:67], a[132:135], v[120:123], v[64:67]
    s_add_u32 m0, s93, 0
    s_nop 0
    buffer_load_dwordx4 v11, s[24:27], s64 offen lds
    ds_read_b64_tr_b16 a[168:169], v38 offset:42496
    ds_read_b64_tr_b16 a[170:171], v38 offset:43520
    v_mfma_f32_16x16x32_bf16 v[68:71], a[136:139], v[116:119], v[68:71]
    ds_read_b64_tr_b16 a[172:173], v39 offset:42496
    ds_read_b64_tr_b16 a[174:175], v39 offset:43520
    v_mfma_f32_16x16x32_bf16 v[72:75], a[136:139], v[120:123], v[72:75]
    ds_read_b64_tr_b16 a[176:177], v36 offset:42624
    ds_read_b64_tr_b16 a[178:179], v36 offset:43648
    v_mfma_f32_16x16x32_bf16 v[76:79], a[140:143], v[116:119], v[76:79]
    ds_read_b64_tr_b16 a[180:181], v37 offset:42624
    ds_read_b64_tr_b16 a[182:183], v37 offset:43648
    v_mfma_f32_16x16x32_bf16 v[80:83], a[140:143], v[120:123], v[80:83]
    buffer_load_dwordx4 v12, s[24:27], s64 offen offset:1024 lds
    ds_read_b64_tr_b16 a[184:185], v38 offset:42624
    ds_read_b64_tr_b16 a[186:187], v38 offset:43648
    v_mfma_f32_16x16x32_bf16 v[84:87], a[144:147], v[116:119], v[84:87]
    ds_read_b64_tr_b16 a[188:189], v39 offset:42624
    ds_read_b64_tr_b16 a[190:191], v39 offset:43648
    v_mfma_f32_16x16x32_bf16 v[88:91], a[144:147], v[120:123], v[88:91]
    ds_read_b64_tr_b16 a[200:201], v44 offset:42496
    ds_read_b64_tr_b16 a[202:203], v44 offset:43520
    v_mfma_f32_16x16x32_bf16 v[92:95], a[148:151], v[116:119], v[92:95]
    ds_read_b64_tr_b16 a[204:205], v45 offset:42496
    ds_read_b64_tr_b16 a[206:207], v45 offset:43520
    v_mfma_f32_16x16x32_bf16 v[96:99], a[148:151], v[120:123], v[96:99]
    buffer_load_dwordx4 v13, s[24:27], s64 offen offset:2048 lds
    v_mfma_f32_16x16x32_bf16 v[100:103], a[152:155], v[116:119], v[100:103]
    v_mfma_f32_16x16x32_bf16 v[104:107], a[152:155], v[120:123], v[104:107]
    v_mfma_f32_16x16x32_bf16 v[108:111], a[156:159], v[116:119], v[108:111]
    v_mfma_f32_16x16x32_bf16 v[112:115], a[156:159], v[120:123], v[112:115]
    buffer_load_dwordx4 v14, s[24:27], s64 offen offset:3072 lds
    v_mfma_f32_16x16x32_bf16 a[224:227], v[132:135], a[192:195], a[224:227]
    v_mfma_f32_16x16x32_bf16 a[228:231], v[132:135], a[196:199], a[228:231]
    s_waitcnt vmcnt(18)
    s_waitcnt lgkmcnt(0)
    s_cmp_eq_u32 s44, 0
    s_cbranch_scc0 Lmpok_4
    s_waitcnt vmcnt(10)
    v_cmp_eq_u32 vcc, s52, v27
    s_nop 3
    s_cmp_eq_u64 vcc, exec
    s_cbranch_scc1 Lmpok_4
    s_mov_b32 s62, 0x20000
Lmprt_5:
    s_sleep 8
    buffer_load_dword v27, v26, s[32:35], 0 offen sc1
    s_waitcnt vmcnt(0)
    v_cmp_eq_u32 vcc, s52, v27
    s_nop 3
    s_cmp_eq_u64 vcc, exec
    s_cbranch_scc1 Lmpok_4
    s_sub_u32 s62, s62, 1
    s_cmp_lg_u32 s62, 0
    s_cbranch_scc1 Lmprt_5
Lmpok_4:
    s_barrier
    s_mul_i32 s60, s3, 4224
    s_and_b32 s61, s44, 1
    s_lshl_b32 s61, s61, 11
    s_add_u32 s60, s60, s61
    s_add_u32 s60, s60, 32768
    s_lshl_b32 s54, s47, 7
    s_lshl_b32 s55, s44, 5
    s_add_u32 s54, s54, s55
    v_add_u32 v25, s54, v3
    v_lshlrev_b32 v25, 3, v25
    v_add_u32 v25, 16384, v25
    s_waitcnt lgkmcnt(0)
    v_mfma_f32_16x16x32_bf16 v[52:55], a[160:163], v[124:127], v[52:55]
    ds_read_b128 v[116:119], v50 offset:0
    ds_read_b128 v[120:123], v50 offset:2048
    v_mfma_f32_16x16x32_bf16 v[56:59], a[160:163], v[128:131], v[56:59]
    s_add_u32 m0, s93, 16384
    s_nop 0
    buffer_load_dwordx4 v11, s[24:27], s65 offen lds
    ds_read_b64_tr_b16 a[128:129], v40 offset:0
    ds_read_b64_tr_b16 a[130:131], v40 offset:1024
    v_mfma_f32_16x16x32_bf16 v[60:63], a[164:167], v[124:127], v[60:63]
    ds_read_b64_tr_b16 a[132:133], v41 offset:0
    ds_read_b64_tr_b16 a[134:135], v41 offset:1024
    v_mfma_f32_16x16x32_bf16 v[64:67], a[164:167], v[128:131], v[64:67]
    ds_read_b64_tr_b16 a[136:137], v42 offset:0
    ds_read_b64_tr_b16 a[138:139], v42 offset:1024
    v_mfma_f32_16x16x32_bf16 v[68:71], a[168:171], v[124:127], v[68:71]
    ds_read_b64_tr_b16 a[140:141], v43 offset:0
    ds_read_b64_tr_b16 a[142:143], v43 offset:1024
    v_mfma_f32_16x16x32_bf16 v[72:75], a[168:171], v[128:131], v[72:75]
    buffer_load_dwordx4 v12, s[24:27], s65 offen offset:1024 lds
    ds_read_b64_tr_b16 a[144:145], v40 offset:128
    ds_read_b64_tr_b16 a[146:147], v40 offset:1152
    v_mfma_f32_16x16x32_bf16 v[76:79], a[172:175], v[124:127], v[76:79]
    ds_read_b64_tr_b16 a[148:149], v41 offset:128
    ds_read_b64_tr_b16 a[150:151], v41 offset:1152
    v_mfma_f32_16x16x32_bf16 v[80:83], a[172:175], v[128:131], v[80:83]
    ds_read_b64_tr_b16 a[152:153], v42 offset:128
    ds_read_b64_tr_b16 a[154:155], v42 offset:1152
    v_mfma_f32_16x16x32_bf16 v[84:87], a[176:179], v[124:127], v[84:87]
    ds_read_b64_tr_b16 a[156:157], v43 offset:128
    ds_read_b64_tr_b16 a[158:159], v43 offset:1152
    v_mfma_f32_16x16x32_bf16 v[88:91], a[176:179], v[128:131], v[88:91]
    buffer_load_dwordx4 v13, s[24:27], s65 offen offset:2048 lds
    ds_read_b64_tr_b16 a[192:193], v46 offset:0
    ds_read_b64_tr_b16 a[194:195], v46 offset:1024
    v_mfma_f32_16x16x32_bf16 v[92:95], a[180:183], v[124:127], v[92:95]
    ds_read_b64_tr_b16 a[196:197], v47 offset:0
    ds_read_b64_tr_b16 a[198:199], v47 offset:1024
    v_mfma_f32_16x16x32_bf16 v[96:99], a[180:183], v[128:131], v[96:99]
    s_waitcnt vmcnt(10)
    v_lshlrev_b32 v160, 16, v160
    s_waitcnt vmcnt(9)
    v_lshlrev_b32 v161, 16, v161
    v_add_f32 v160, v160, v161
    v_cvt_pk_bf16_f32 v160, v160, v160
    s_lshr_b32 s54, s44, 1
    s_mul_i32 s54, s54, 4224
    s_add_u32 s54, s54, 135296
    v_mov_b32 v161, s54
    ds_write_b16 v161, v160
    v_mfma_f32_16x16x32_bf16 v[100:103], a[184:187], v[124:127], v[100:103]
    v_mfma_f32_16x16x32_bf16 v[104:107], a[184:187], v[128:131], v[104:107]
    buffer_load_dwordx4 v14, s[24:27], s65 offen offset:3072 lds
    v_mfma_f32_16x16x32_bf16 v[108:111], a[188:191], v[124:127], v[108:111]
    v_mfma_f32_16x16x32_bf16 v[112:115], a[188:191], v[128:131], v[112:115]
    v_mfma_f32_16x16x32_bf16 a[224:227], v[132:135], a[200:203], a[224:227]
    v_mfma_f32_16x16x32_bf16 a[228:231], v[132:135], a[204:207], a[228:231]
    s_lshl_b32 s99, s48, 8
    v_lshlrev_b32 v9, 3, v4
    v_add_u32 v9, s99, v9
    global_load_dwordx2 v[136:137], v9, s[40:41] offset:0
    global_load_dwordx2 v[138:139], v9, s[40:41] offset:32
    global_load_dwordx2 v[140:141], v9, s[40:41] offset:64
    global_load_dwordx2 v[142:143], v9, s[40:41] offset:96
    global_load_dwordx2 v[144:145], v9, s[40:41] offset:128
    global_load_dwordx2 v[146:147], v9, s[40:41] offset:160
    global_load_dwordx2 v[148:149], v9, s[40:41] offset:192
    global_load_dwordx2 v[150:151], v9, s[40:41] offset:224
    s_waitcnt lgkmcnt(0)
    v_mfma_f32_16x16x32_bf16 v[52:55], a[128:131], v[116:119], v[52:55]
    ds_read_b128 v[124:127], v51 offset:0
    ds_read_b128 v[128:131], v51 offset:2048
    v_mfma_f32_16x16x32_bf16 v[56:59], a[128:131], v[120:123], v[56:59]
    ds_read_b64_tr_b16 a[160:161], v40 offset:8704
    ds_read_b64_tr_b16 a[162:163], v40 offset:9728
    v_mfma_f32_16x16x32_bf16 v[60:63], a[132:135], v[116:119], v[60:63]
    ds_read_b64_tr_b16 a[164:165], v41 offset:8704
    ds_read_b64_tr_b16 a[166:167], v41 offset:9728
    v_mfma_f32_16x16x32_bf16 v[64:67], a[132:135], v[120:123], v[64:67]
    buffer_load_dwordx4 v[152:155], v2, s[32:35], s60 offen sc1
    ds_read_b64_tr_b16 a[168:169], v42 offset:8704
    ds_read_b64_tr_b16 a[170:171], v42 offset:9728
    v_mfma_f32_16x16x32_bf16 v[68:71], a[136:139], v[116:119], v[68:71]
    ds_read_b64_tr_b16 a[172:173], v43 offset:8704
    ds_read_b64_tr_b16 a[174:175], v43 offset:9728
    v_mfma_f32_16x16x32_bf16 v[72:75], a[136:139], v[120:123], v[72:75]
    ds_read_b64_tr_b16 a[176:177], v40 offset:8832
    ds_read_b64_tr_b16 a[178:179], v40 offset:9856
    v_mfma_f32_16x16x32_bf16 v[76:79], a[140:143], v[116:119], v[76:79]
    ds_read_b64_tr_b16 a[180:181], v41 offset:8832
    ds_read_b64_tr_b16 a[182:183], v41 offset:9856
    v_mfma_f32_16x16x32_bf16 v[80:83], a[140:143], v[120:123], v[80:83]
    buffer_load_dwordx4 v[156:159], v2, s[32:35], s60 offen offset:1024 sc1
    ds_read_b64_tr_b16 a[184:185], v42 offset:8832
    ds_read_b64_tr_b16 a[186:187], v42 offset:9856
    v_mfma_f32_16x16x32_bf16 v[84:87], a[144:147], v[116:119], v[84:87]
    ds_read_b64_tr_b16 a[188:189], v43 offset:8832
    ds_read_b64_tr_b16 a[190:191], v43 offset:9856
    v_mfma_f32_16x16x32_bf16 v[88:91], a[144:147], v[120:123], v[88:91]
    ds_read_b64_tr_b16 a[200:201], v46 offset:8704
    ds_read_b64_tr_b16 a[202:203], v46 offset:9728
    v_mfma_f32_16x16x32_bf16 v[92:95], a[148:151], v[116:119], v[92:95]
    ds_read_b64_tr_b16 a[204:205], v47 offset:8704
    ds_read_b64_tr_b16 a[206:207], v47 offset:9728
    v_mfma_f32_16x16x32_bf16 v[96:99], a[148:151], v[120:123], v[96:99]
    buffer_load_dwordx2 v[172:173], v25, s[32:35], 0 offen sc1
    buffer_load_dwordx2 v[174:175], v25, s[32:35], 0 offen offset:128 sc1
    v_mfma_f32_16x16x32_bf16 v[100:103], a[152:155], v[116:119], v[100:103]
    v_mfma_f32_16x16x32_bf16 v[104:107], a[152:155], v[120:123], v[104:107]
    v_mfma_f32_16x16x32_bf16 v[108:111], a[156:159], v[116:119], v[108:111]
    v_mfma_f32_16x16x32_bf16 v[112:115], a[156:159], v[120:123], v[112:115]
    s_add_u32 m0, s93, 33792
    s_nop 0
    buffer_load_dwordx4 v11, s[24:27], s66 offen lds
    v_mfma_f32_16x16x32_bf16 a[224:227], v[132:135], a[192:195], a[224:227]
    v_mfma_f32_16x16x32_bf16 a[228:231], v[132:135], a[196:199], a[228:231]
    s_waitcnt lgkmcnt(0)
    s_barrier
    s_waitcnt lgkmcnt(0)
    v_mfma_f32_16x16x32_bf16 v[52:55], a[160:163], v[124:127], v[52:55]
    ds_read_b128 v[116:119], v50 offset:33792
    ds_read_b128 v[120:123], v50 offset:35840
    v_mfma_f32_16x16x32_bf16 v[56:59], a[160:163], v[128:131], v[56:59]
    buffer_load_dwordx4 v12, s[24:27], s66 offen offset:1024 lds
    ds_read_b64_tr_b16 a[128:129], v40 offset:33792
    ds_read_b64_tr_b16 a[130:131], v40 offset:34816
    v_mfma_f32_16x16x32_bf16 v[60:63], a[164:167], v[124:127], v[60:63]
    ds_read_b64_tr_b16 a[132:133], v41 offset:33792
    ds_read_b64_tr_b16 a[134:135], v41 offset:34816
    v_mfma_f32_16x16x32_bf16 v[64:67], a[164:167], v[128:131], v[64:67]
    ds_read_b64_tr_b16 a[136:137], v42 offset:33792
    ds_read_b64_tr_b16 a[138:139], v42 offset:34816
    v_mfma_f32_16x16x32_bf16 v[68:71], a[168:171], v[124:127], v[68:71]
    ds_read_b64_tr_b16 a[140:141], v43 offset:33792
    ds_read_b64_tr_b16 a[142:143], v43 offset:34816
    v_mfma_f32_16x16x32_bf16 v[72:75], a[168:171], v[128:131], v[72:75]
    buffer_load_dwordx4 v13, s[24:27], s66 offen offset:2048 lds
    ds_read_b64_tr_b16 a[144:145], v40 offset:33920
    ds_read_b64_tr_b16 a[146:147], v40 offset:34944
    v_mfma_f32_16x16x32_bf16 v[76:79], a[172:175], v[124:127], v[76:79]
    ds_read_b64_tr_b16 a[148:149], v41 offset:33920
    ds_read_b64_tr_b16 a[150:151], v41 offset:34944
    v_mfma_f32_16x16x32_bf16 v[80:83], a[172:175], v[128:131], v[80:83]
    ds_read_b64_tr_b16 a[152:153], v42 offset:33920
    ds_read_b64_tr_b16 a[154:155], v42 offset:34944
    v_mfma_f32_16x16x32_bf16 v[84:87], a[176:179], v[124:127], v[84:87]
    ds_read_b64_tr_b16 a[156:157], v43 offset:33920
    ds_read_b64_tr_b16 a[158:159], v43 offset:34944
    v_mfma_f32_16x16x32_bf16 v[88:91], a[176:179], v[128:131], v[88:91]
    buffer_load_dwordx4 v14, s[24:27], s66 offen offset:3072 lds
    ds_read_b64_tr_b16 a[192:193], v46 offset:33792
    ds_read_b64_tr_b16 a[194:195], v46 offset:34816
    v_mfma_f32_16x16x32_bf16 v[92:95], a[180:183], v[124:127], v[92:95]
    ds_read_b64_tr_b16 a[196:197], v47 offset:33792
    ds_read_b64_tr_b16 a[198:199], v47 offset:34816
    v_mfma_f32_16x16x32_bf16 v[96:99], a[180:183], v[128:131], v[96:99]
    v_mfma_f32_16x16x32_bf16 v[100:103], a[184:187], v[124:127], v[100:103]
    v_mfma_f32_16x16x32_bf16 v[104:107], a[184:187], v[128:131], v[104:107]
    s_add_u32 m0, s93, 50176
    s_nop 0
    buffer_load_dwordx4 v11, s[24:27], s67 offen lds
    v_mfma_f32_16x16x32_bf16 v[108:111], a[188:191], v[124:127], v[108:111]
    v_mfma_f32_16x16x32_bf16 v[112:115], a[188:191], v[128:131], v[112:115]
    v_mfma_f32_16x16x32_bf16 a[224:227], v[132:135], a[200:203], a[224:227]
    v_mfma_f32_16x16x32_bf16 a[228:231], v[132:135], a[204:207], a[228:231]
    buffer_load_dwordx4 v12, s[24:27], s67 offen offset:1024 lds
    s_waitcnt lgkmcnt(0)
    v_mfma_f32_16x16x32_bf16 v[52:55], a[128:131], v[116:119], v[52:55]
    ds_read_b128 v[124:127], v51 offset:33792
    ds_read_b128 v[128:131], v51 offset:35840
    v_mfma_f32_16x16x32_bf16 v[56:59], a[128:131], v[120:123], v[56:59]
    ds_read_b64_tr_b16 a[160:161], v40 offset:42496
    ds_read_b64_tr_b16 a[162:163], v40 offset:43520
    v_mfma_f32_16x16x32_bf16 v[60:63], a[132:135], v[116:119], v[60:63]
    ds_read_b64_tr_b16 a[164:165], v41 offset:42496
    ds_read_b64_tr_b16 a[166:167], v41 offset:43520
    v_mfma_f32_16x16x32_bf16 v[64:67], a[132:135], v[120:123], v[64:67]
    buffer_load_dwordx4 v13, s[24:27], s67 offen offset:2048 lds
    ds_read_b64_tr_b16 a[168:169], v42 offset:42496
    ds_read_b64_tr_b16 a[170:171], v42 offset:43520
    v_mfma_f32_16x16x32_bf16 v[68:71], a[136:139], v[116:119], v[68:71]
    ds_read_b64_tr_b16 a[172:173], v43 offset:42496
    ds_read_b64_tr_b16 a[174:175], v43 offset:43520
    v_mfma_f32_16x16x32_bf16 v[72:75], a[136:139], v[120:123], v[72:75]
    ds_read_b64_tr_b16 a[176:177], v40 offset:42624
    ds_read_b64_tr_b16 a[178:179], v40 offset:43648
    v_mfma_f32_16x16x32_bf16 v[76:79], a[140:143], v[116:119], v[76:79]
    ds_read_b64_tr_b16 a[180:181], v41 offset:42624
    ds_read_b64_tr_b16 a[182:183], v41 offset:43648
    v_mfma_f32_16x16x32_bf16 v[80:83], a[140:143], v[120:123], v[80:83]
    buffer_load_dwordx4 v14, s[24:27], s67 offen offset:3072 lds
    ds_read_b64_tr_b16 a[184:185], v42 offset:42624
    ds_read_b64_tr_b16 a[186:187], v42 offset:43648
    v_mfma_f32_16x16x32_bf16 v[84:87], a[144:147], v[116:119], v[84:87]
    ds_read_b64_tr_b16 a[188:189], v43 offset:42624
    ds_read_b64_tr_b16 a[190:191], v43 offset:43648
    v_mfma_f32_16x16x32_bf16 v[88:91], a[144:147], v[120:123], v[88:91]
    ds_read_b64_tr_b16 a[200:201], v46 offset:42496
    ds_read_b64_tr_b16 a[202:203], v46 offset:43520
    v_mfma_f32_16x16x32_bf16 v[92:95], a[148:151], v[116:119], v[92:95]
    ds_read_b64_tr_b16 a[204:205], v47 offset:42496
    ds_read_b64_tr_b16 a[206:207], v47 offset:43520
    v_mfma_f32_16x16x32_bf16 v[96:99], a[148:151], v[120:123], v[96:99]
    s_add_u32 m0, s93, 67584
    s_nop 0
    buffer_load_dwordx4 v11, s[24:27], s68 offen lds
    v_mfma_f32_16x16x32_bf16 v[100:103], a[152:155], v[116:119], v[100:103]
    v_mfma_f32_16x16x32_bf16 v[104:107], a[152:155], v[120:123], v[104:107]
    v_mfma_f32_16x16x32_bf16 v[108:111], a[156:159], v[116:119], v[108:111]
    v_mfma_f32_16x16x32_bf16 v[112:115], a[156:159], v[120:123], v[112:115]
    buffer_load_dwordx4 v12, s[24:27], s68 offen offset:1024 lds
    v_mfma_f32_16x16x32_bf16 a[224:227], v[132:135], a[192:195], a[224:227]
    v_mfma_f32_16x16x32_bf16 a[228:231], v[132:135], a[196:199], a[228:231]
    s_waitcnt lgkmcnt(0)
    v_mfma_f32_16x16x32_bf16 v[52:55], a[160:163], v[124:127], v[52:55]
    v_mfma_f32_16x16x32_bf16 v[56:59], a[160:163], v[128:131], v[56:59]
    buffer_load_dwordx4 v13, s[24:27], s68 offen offset:2048 lds
    v_mfma_f32_16x16x32_bf16 v[60:63], a[164:167], v[124:127], v[60:63]
    v_mfma_f32_16x16x32_bf16 v[64:67], a[164:167], v[128:131], v[64:67]
    v_mfma_f32_16x16x32_bf16 v[68:71], a[168:171], v[124:127], v[68:71]
    v_mfma_f32_16x16x32_bf16 v[72:75], a[168:171], v[128:131], v[72:75]
    buffer_load_dwordx4 v14, s[24:27], s68 offen offset:3072 lds
    v_mfma_f32_16x16x32_bf16 v[76:79], a[172:175], v[124:127], v[76:79]
    v_mfma_f32_16x16x32_bf16 v[80:83], a[172:175], v[128:131], v[80:83]
    v_mfma_f32_16x16x32_bf16 v[84:87], a[176:179], v[124:127], v[84:87]
    v_mfma_f32_16x16x32_bf16 v[88:91], a[176:179], v[128:131], v[88:91]
    s_add_u32 m0, s93, 83968
    s_nop 0
    buffer_load_dwordx4 v11, s[24:27], s69 offen lds
    v_mfma_f32_16x16x32_bf16 v[92:95], a[180:183], v[124:127], v[92:95]
    v_mfma_f32_16x16x32_bf16 v[96:99], a[180:183], v[128:131], v[96:99]
    v_mfma_f32_16x16x32_bf16 v[100:103], a[184:187], v[124:127], v[100:103]
    v_mfma_f32_16x16x32_bf16 v[104:107], a[184:187], v[128:131], v[104:107]
    buffer_load_dwordx4 v12, s[24:27], s69 offen offset:1024 lds
    v_mfma_f32_16x16x32_bf16 v[108:111], a[188:191], v[124:127], v[108:111]
    v_mfma_f32_16x16x32_bf16 v[112:115], a[188:191], v[128:131], v[112:115]
    v_mfma_f32_16x16x32_bf16 a[224:227], v[132:135], a[200:203], a[224:227]
    v_mfma_f32_16x16x32_bf16 a[228:231], v[132:135], a[204:207], a[228:231]
    buffer_load_dwordx4 v13, s[24:27], s69 offen offset:2048 lds
    s_waitcnt vmcnt(35)
    v_lshlrev_b32 v5, 2, v3
    s_lshl_b32 s54, s44, 7
    s_add_u32 s54, s54, 161024
    v_add_u32 v5, s54, v5
    s_mov_b64 exec, 0xffff
    ds_write_b32 v5, a224 offset:0
    ds_write_b32 v5, a228 offset:64
    s_mov_b64 exec, -1
    s_waitcnt lgkmcnt(0)
    s_barrier
    v_lshlrev_b32 v5, 4, v4
    v_add_u32 v5, 161024, v5
    ds_read_b128 v[176:179], v5 offset:0
    ds_read_b128 v[180:183], v5 offset:64
    ds_read_b128 v[184:187], v5 offset:128
    ds_read_b128 v[188:191], v5 offset:192
    ds_read_b128 v[192:195], v5 offset:256
    ds_read_b128 v[196:199], v5 offset:320
    ds_read_b128 v[200:203], v5 offset:384
    ds_read_b128 v[204:207], v5 offset:448
    buffer_load_dwordx4 v14, s[24:27], s69 offen offset:3072 lds
    s_waitcnt vmcnt(17)
    v_mul_f32 v26, v172, v173
    s_waitcnt vmcnt(16)
    v_mul_f32 v27, v174, v175
    s_lshl_b32 s54, s47, 3
    s_lshl_b32 s55, s44, 1
    s_add_u32 s54, s54, s55
    s_mul_i32 s54, s54, 56
    s_lshl_b32 s55, s48, 2
    s_add_u32 s54, s54, s55
    s_lshl_b32 s54, s54, 10
    s_add_u32 s58, s54, 4456448
    s_add_u32 m0, s93, 101376
    s_nop 0
    buffer_load_dwordx4 v11, s[24:27], s70 offen lds
    s_lshl_b32 s54, s47, 3
    s_lshl_b32 s55, s44, 1
    s_add_u32 s54, s54, s55
    s_add_u32 s54, s54, 1
    s_mul_i32 s54, s54, 56
    s_lshl_b32 s55, s48, 2
    s_add_u32 s54, s54, s55
    s_lshl_b32 s54, s54, 10
    s_add_u32 s59, s54, 4456448
    v_lshlrev_b32 v48, 16, v136
    buffer_load_dwordx4 v12, s[24:27], s70 offen offset:1024 lds
    v_and_b32 v49, 0xffff0000, v136
    v_lshlrev_b32 v50, 16, v137
    v_and_b32 v51, 0xffff0000, v137
    s_waitcnt lgkmcnt(7)
    v_pk_fma_f32 v[44:45], v[176:177], v[26:27], v[48:49] op_sel:[0,0,0] op_sel_hi:[1,0,1] neg_lo:[0,1,0] neg_hi:[0,1,0]
    v_pk_fma_f32 v[46:47], v[178:179], v[26:27], v[50:51] op_sel:[0,0,0] op_sel_hi:[1,0,1] neg_lo:[0,1,0] neg_hi:[0,1,0]
    v_pk_fma_f32 v[52:53], v[52:53], v[172:173], v[44:45] op_sel:[0,1,0] op_sel_hi:[1,1,1]
    v_pk_fma_f32 v[54:55], v[54:55], v[172:173], v[46:47] op_sel:[0,1,0] op_sel_hi:[1,1,1]
    v_max_f32 v52, 0, v52
    v_max_f32 v53, 0, v53
    v_max_f32 v54, 0, v54
    buffer_load_dwordx4 v13, s[24:27], s70 offen offset:2048 lds
    v_max_f32 v55, 0, v55
    v_pk_mul_f32 v[52:53], v[52:53], v[52:53]
    v_pk_mul_f32 v[54:55], v[54:55], v[54:55]
    v_cvt_pk_bf16_f32 v28, v52, v53
    v_cvt_pk_bf16_f32 v29, v54, v55
    v_pk_fma_f32 v[44:45], v[176:177], v[26:27], v[48:49] op_sel:[0,1,0] op_sel_hi:[1,1,1] neg_lo:[0,1,0] neg_hi:[0,1,0]
    v_pk_fma_f32 v[46:47], v[178:179], v[26:27], v[50:51] op_sel:[0,1,0] op_sel_hi:[1,1,1] neg_lo:[0,1,0] neg_hi:[0,1,0]
    v_pk_fma_f32 v[56:57], v[56:57], v[174:175], v[44:45] op_sel:[0,1,0] op_sel_hi:[1,1,1]
    v_pk_fma_f32 v[58:59], v[58:59], v[174:175], v[46:47] op_sel:[0,1,0] op_sel_hi:[1,1,1]
    v_max_f32 v56, 0, v56
    buffer_load_dwordx4 v14, s[24:27], s70 offen offset:3072 lds
    v_max_f32 v57, 0, v57
    v_max_f32 v58, 0, v58
    v_max_f32 v59, 0, v59
    v_pk_mul_f32 v[56:57], v[56:57], v[56:57]
    v_pk_mul_f32 v[58:59], v[58:59], v[58:59]
    v_cvt_pk_bf16_f32 v116, v56, v57
    v_cvt_pk_bf16_f32 v117, v58, v59
    v_lshlrev_b32 v48, 16, v138
    v_and_b32 v49, 0xffff0000, v138
    v_lshlrev_b32 v50, 16, v139
    s_add_u32 m0, s93, 117760
    s_nop 0
    buffer_load_dwordx4 v11, s[24:27], s71 offen lds
    v_and_b32 v51, 0xffff0000, v139
    s_waitcnt lgkmcnt(6)
    v_pk_fma_f32 v[44:45], v[180:181], v[26:27], v[48:49] op_sel:[0,0,0] op_sel_hi:[1,0,1] neg_lo:[0,1,0] neg_hi:[0,1,0]
    v_pk_fma_f32 v[46:47], v[182:183], v[26:27], v[50:51] op_sel:[0,0,0] op_sel_hi:[1,0,1] neg_lo:[0,1,0] neg_hi:[0,1,0]
    v_pk_fma_f32 v[60:61], v[60:61], v[172:173], v[44:45] op_sel:[0,1,0] op_sel_hi:[1,1,1]
    v_pk_fma_f32 v[62:63], v[62:63], v[172:173], v[46:47] op_sel:[0,1,0] op_sel_hi:[1,1,1]
    v_max_f32 v60, 0, v60
    v_max_f32 v61, 0, v61
    v_max_f32 v62, 0, v62
    v_max_f32 v63, 0, v63
    v_pk_mul_f32 v[60:61], v[60:61], v[60:61]
    buffer_load_dwordx4 v12, s[24:27], s71 offen offset:1024 lds
    v_pk_mul_f32 v[62:63], v[62:63], v[62:63]
    v_cvt_pk_bf16_f32 v30, v60, v61
    v_cvt_pk_bf16_f32 v31, v62, v63
    v_pk_fma_f32 v[44:45], v[180:181], v[26:27], v[48:49] op_sel:[0,1,0] op_sel_hi:[1,1,1] neg_lo:[0,1,0] neg_hi:[0,1,0]
    v_pk_fma_f32 v[46:47], v[182:183], v[26:27], v[50:51] op_sel:[0,1,0] op_sel_hi:[1,1,1] neg_lo:[0,1,0] neg_hi:[0,1,0]
    v_pk_fma_f32 v[64:65], v[64:65], v[174:175], v[44:45] op_sel:[0,1,0] op_sel_hi:[1,1,1]
    v_pk_fma_f32 v[66:67], v[66:67], v[174:175], v[46:47] op_sel:[0,1,0] op_sel_hi:[1,1,1]
    v_max_f32 v64, 0, v64
    v_max_f32 v65, 0, v65
    v_max_f32 v66, 0, v66
    buffer_load_dwordx4 v13, s[24:27], s71 offen offset:2048 lds
    v_max_f32 v67, 0, v67
    v_pk_mul_f32 v[64:65], v[64:65], v[64:65]
    v_pk_mul_f32 v[66:67], v[66:67], v[66:67]
    v_cvt_pk_bf16_f32 v118, v64, v65
    v_cvt_pk_bf16_f32 v119, v66, v67
    v_lshlrev_b32 v48, 16, v140
    v_and_b32 v49, 0xffff0000, v140
    v_lshlrev_b32 v50, 16, v141
    v_and_b32 v51, 0xffff0000, v141
    s_waitcnt lgkmcnt(5)
    v_pk_fma_f32 v[44:45], v[184:185], v[26:27], v[48:49] op_sel:[0,0,0] op_sel_hi:[1,0,1] neg_lo:[0,1,0] neg_hi:[0,1,0]
    buffer_load_dwordx4 v14, s[24:27], s71 offen offset:3072 lds
    v_pk_fma_f32 v[46:47], v[186:187], v[26:27], v[50:51] op_sel:[0,0,0] op_sel_hi:[1,0,1] neg_lo:[0,1,0] neg_hi:[0,1,0]
    v_pk_fma_f32 v[68:69], v[68:69], v[172:173], v[44:45] op_sel:[0,1,0] op_sel_hi:[1,1,1]
    v_pk_fma_f32 v[70:71], v[70:71], v[172:173], v[46:47] op_sel:[0,1,0] op_sel_hi:[1,1,1]
    v_max_f32 v68, 0, v68
    v_max_f32 v69, 0, v69
    v_max_f32 v70, 0, v70
    v_max_f32 v71, 0, v71
    v_pk_mul_f32 v[68:69], v[68:69], v[68:69]
    v_pk_mul_f32 v[70:71], v[70:71], v[70:71]
    v_cvt_pk_bf16_f32 v32, v68, v69
    buffer_store_dwordx4 v[28:31], v2, s[32:35], s58 offen sc1
    v_cvt_pk_bf16_f32 v33, v70, v71
    v_pk_fma_f32 v[44:45], v[184:185], v[26:27], v[48:49] op_sel:[0,1,0] op_sel_hi:[1,1,1] neg_lo:[0,1,0] neg_hi:[0,1,0]
    v_pk_fma_f32 v[46:47], v[186:187], v[26:27], v[50:51] op_sel:[0,1,0] op_sel_hi:[1,1,1] neg_lo:[0,1,0] neg_hi:[0,1,0]
    v_pk_fma_f32 v[72:73], v[72:73], v[174:175], v[44:45] op_sel:[0,1,0] op_sel_hi:[1,1,1]
    v_pk_fma_f32 v[74:75], v[74:75], v[174:175], v[46:47] op_sel:[0,1,0] op_sel_hi:[1,1,1]
    v_max_f32 v72, 0, v72
    v_max_f32 v73, 0, v73
    v_max_f32 v74, 0, v74
    v_max_f32 v75, 0, v75
    v_pk_mul_f32 v[72:73], v[72:73], v[72:73]
    buffer_store_dwordx4 v[116:119], v2, s[32:35], s59 offen sc1
    v_pk_mul_f32 v[74:75], v[74:75], v[74:75]
    v_cvt_pk_bf16_f32 v120, v72, v73
    v_cvt_pk_bf16_f32 v121, v74, v75
    v_lshlrev_b32 v48, 16, v142
    v_and_b32 v49, 0xffff0000, v142
    v_lshlrev_b32 v50, 16, v143
    v_and_b32 v51, 0xffff0000, v143
    s_waitcnt lgkmcnt(4)
    v_pk_fma_f32 v[44:45], v[188:189], v[26:27], v[48:49] op_sel:[0,0,0] op_sel_hi:[1,0,1] neg_lo:[0,1,0] neg_hi:[0,1,0]
    v_pk_fma_f32 v[46:47], v[190:191], v[26:27], v[50:51] op_sel:[0,0,0] op_sel_hi:[1,0,1] neg_lo:[0,1,0] neg_hi:[0,1,0]
    v_pk_fma_f32 v[76:77], v[76:77], v[172:173], v[44:45] op_sel:[0,1,0] op_sel_hi:[1,1,1]
    v_pk_fma_f32 v[78:79], v[78:79], v[172:173], v[46:47] op_sel:[0,1,0] op_sel_hi:[1,1,1]
    v_max_f32 v76, 0, v76
    v_max_f32 v77, 0, v77
    v_max_f32 v78, 0, v78
    v_max_f32 v79, 0, v79
    v_pk_mul_f32 v[76:77], v[76:77], v[76:77]
    v_pk_mul_f32 v[78:79], v[78:79], v[78:79]
    v_cvt_pk_bf16_f32 v34, v76, v77
    v_cvt_pk_bf16_f32 v35, v78, v79
    v_pk_fma_f32 v[44:45], v[188:189], v[26:27], v[48:49] op_sel:[0,1,0] op_sel_hi:[1,1,1] neg_lo:[0,1,0] neg_hi:[0,1,0]
    buffer_store_dwordx4 v[32:35], v2, s[32:35], s58 offen offset:1024 sc1
    v_pk_fma_f32 v[46:47], v[190:191], v[26:27], v[50:51] op_sel:[0,1,0] op_sel_hi:[1,1,1] neg_lo:[0,1,0] neg_hi:[0,1,0]
    v_pk_fma_f32 v[80:81], v[80:81], v[174:175], v[44:45] op_sel:[0,1,0] op_sel_hi:[1,1,1]
    v_pk_fma_f32 v[82:83], v[82:83], v[174:175], v[46:47] op_sel:[0,1,0] op_sel_hi:[1,1,1]
    v_max_f32 v80, 0, v80
    v_max_f32 v81, 0, v81
    v_max_f32 v82, 0, v82
    v_max_f32 v83, 0, v83
    v_pk_mul_f32 v[80:81], v[80:81], v[80:81]
    v_pk_mul_f32 v[82:83], v[82:83], v[82:83]
    v_cvt_pk_bf16_f32 v122, v80, v81
    v_cvt_pk_bf16_f32 v123, v82, v83
    v_lshlrev_b32 v48, 16, v144
    buffer_store_dwordx4 v[120:123], v2, s[32:35], s59 offen offset:1024 sc1
    v_and_b32 v49, 0xffff0000, v144
    v_lshlrev_b32 v50, 16, v145
    v_and_b32 v51, 0xffff0000, v145
    s_waitcnt lgkmcnt(3)
    v_pk_fma_f32 v[44:45], v[192:193], v[26:27], v[48:49] op_sel:[0,0,0] op_sel_hi:[1,0,1] neg_lo:[0,1,0] neg_hi:[0,1,0]
    v_pk_fma_f32 v[46:47], v[194:195], v[26:27], v[50:51] op_sel:[0,0,0] op_sel_hi:[1,0,1] neg_lo:[0,1,0] neg_hi:[0,1,0]
    v_pk_fma_f32 v[84:85], v[84:85], v[172:173], v[44:45] op_sel:[0,1,0] op_sel_hi:[1,1,1]
    v_pk_fma_f32 v[86:87], v[86:87], v[172:173], v[46:47] op_sel:[0,1,0] op_sel_hi:[1,1,1]
    v_max_f32 v84, 0, v84
    v_max_f32 v85, 0, v85
    v_max_f32 v86, 0, v86
    v_max_f32 v87, 0, v87
    v_pk_mul_f32 v[84:85], v[84:85], v[84:85]
    v_pk_mul_f32 v[86:87], v[86:87], v[86:87]
    v_cvt_pk_bf16_f32 v36, v84, v85
    v_cvt_pk_bf16_f32 v37, v86, v87
    v_pk_fma_f32 v[44:45], v[192:193], v[26:27], v[48:49] op_sel:[0,1,0] op_sel_hi:[1,1,1] neg_lo:[0,1,0] neg_hi:[0,1,0]
    v_pk_fma_f32 v[46:47], v[194:195], v[26:27], v[50:51] op_sel:[0,1,0] op_sel_hi:[1,1,1] neg_lo:[0,1,0] neg_hi:[0,1,0]
    v_pk_fma_f32 v[88:89], v[88:89], v[174:175], v[44:45] op_sel:[0,1,0] op_sel_hi:[1,1,1]
    v_pk_fma_f32 v[90:91], v[90:91], v[174:175], v[46:47] op_sel:[0,1,0] op_sel_hi:[1,1,1]
    v_max_f32 v88, 0, v88
    v_max_f32 v89, 0, v89
    v_max_f32 v90, 0, v90
    v_max_f32 v91, 0, v91
    v_pk_mul_f32 v[88:89], v[88:89], v[88:89]
    v_pk_mul_f32 v[90:91], v[90:91], v[90:91]
    v_cvt_pk_bf16_f32 v124, v88, v89
    v_cvt_pk_bf16_f32 v125, v90, v91
    v_lshlrev_b32 v48, 16, v146
    v_and_b32 v49, 0xffff0000, v146
    v_lshlrev_b32 v50, 16, v147
    v_and_b32 v51, 0xffff0000, v147
    s_waitcnt lgkmcnt(2)
    v_pk_fma_f32 v[44:45], v[196:197], v[26:27], v[48:49] op_sel:[0,0,0] op_sel_hi:[1,0,1] neg_lo:[0,1,0] neg_hi:[0,1,0]
    v_pk_fma_f32 v[46:47], v[198:199], v[26:27], v[50:51] op_sel:[0,0,0] op_sel_hi:[1,0,1] neg_lo:[0,1,0] neg_hi:[0,1,0]
    v_pk_fma_f32 v[92:93], v[92:93], v[172:173], v[44:45] op_sel:[0,1,0] op_sel_hi:[1,1,1]
    v_pk_fma_f32 v[94:95], v[94:95], v[172:173], v[46:47] op_sel:[0,1,0] op_sel_hi:[1,1,1]
    v_max_f32 v92, 0, v92
    v_max_f32 v93, 0, v93
    v_max_f32 v94, 0, v94
    v_max_f32 v95, 0, v95
    v_pk_mul_f32 v[92:93], v[92:93], v[92:93]
    v_pk_mul_f32 v[94:95], v[94:95], v[94:95]
    v_cvt_pk_bf16_f32 v38, v92, v93
    v_cvt_pk_bf16_f32 v39, v94, v95
    v_pk_fma_f32 v[44:45], v[196:197], v[26:27], v[48:49] op_sel:[0,1,0] op_sel_hi:[1,1,1] neg_lo:[0,1,0] neg_hi:[0,1,0]
    buffer_store_dwordx4 v[36:39], v2, s[32:35], s58 offen offset:2048 sc1
    v_pk_fma_f32 v[46:47], v[198:199], v[26:27], v[50:51] op_sel:[0,1,0] op_sel_hi:[1,1,1] neg_lo:[0,1,0] neg_hi:[0,1,0]
    v_pk_fma_f32 v[96:97], v[96:97], v[174:175], v[44:45] op_sel:[0,1,0] op_sel_hi:[1,1,1]
    v_pk_fma_f32 v[98:99], v[98:99], v[174:175], v[46:47] op_sel:[0,1,0] op_sel_hi:[1,1,1]
    v_max_f32 v96, 0, v96
    v_max_f32 v97, 0, v97
    v_max_f32 v98, 0, v98
    v_max_f32 v99, 0, v99
    v_pk_mul_f32 v[96:97], v[96:97], v[96:97]
    v_pk_mul_f32 v[98:99], v[98:99], v[98:99]
    v_cvt_pk_bf16_f32 v126, v96, v97
    v_cvt_pk_bf16_f32 v127, v98, v99
    v_lshlrev_b32 v48, 16, v148
    buffer_store_dwordx4 v[124:127], v2, s[32:35], s59 offen offset:2048 sc1
    v_and_b32 v49, 0xffff0000, v148
    v_lshlrev_b32 v50, 16, v149
    v_and_b32 v51, 0xffff0000, v149
    s_waitcnt lgkmcnt(1)
    v_pk_fma_f32 v[44:45], v[200:201], v[26:27], v[48:49] op_sel:[0,0,0] op_sel_hi:[1,0,1] neg_lo:[0,1,0] neg_hi:[0,1,0]
    v_pk_fma_f32 v[46:47], v[202:203], v[26:27], v[50:51] op_sel:[0,0,0] op_sel_hi:[1,0,1] neg_lo:[0,1,0] neg_hi:[0,1,0]
    v_pk_fma_f32 v[100:101], v[100:101], v[172:173], v[44:45] op_sel:[0,1,0] op_sel_hi:[1,1,1]
    v_pk_fma_f32 v[102:103], v[102:103], v[172:173], v[46:47] op_sel:[0,1,0] op_sel_hi:[1,1,1]
    v_max_f32 v100, 0, v100
    v_max_f32 v101, 0, v101
    v_max_f32 v102, 0, v102
    v_max_f32 v103, 0, v103
    v_pk_mul_f32 v[100:101], v[100:101], v[100:101]
    v_pk_mul_f32 v[102:103], v[102:103], v[102:103]
    v_cvt_pk_bf16_f32 v40, v100, v101
    v_cvt_pk_bf16_f32 v41, v102, v103
    v_pk_fma_f32 v[44:45], v[200:201], v[26:27], v[48:49] op_sel:[0,1,0] op_sel_hi:[1,1,1] neg_lo:[0,1,0] neg_hi:[0,1,0]
    v_pk_fma_f32 v[46:47], v[202:203], v[26:27], v[50:51] op_sel:[0,1,0] op_sel_hi:[1,1,1] neg_lo:[0,1,0] neg_hi:[0,1,0]
    v_pk_fma_f32 v[104:105], v[104:105], v[174:175], v[44:45] op_sel:[0,1,0] op_sel_hi:[1,1,1]
    v_pk_fma_f32 v[106:107], v[106:107], v[174:175], v[46:47] op_sel:[0,1,0] op_sel_hi:[1,1,1]
    v_max_f32 v104, 0, v104
    v_max_f32 v105, 0, v105
    v_max_f32 v106, 0, v106
    v_max_f32 v107, 0, v107
    v_pk_mul_f32 v[104:105], v[104:105], v[104:105]
    v_pk_mul_f32 v[106:107], v[106:107], v[106:107]
    v_cvt_pk_bf16_f32 v128, v104, v105
    v_cvt_pk_bf16_f32 v129, v106, v107
    v_lshlrev_b32 v48, 16, v150
    v_and_b32 v49, 0xffff0000, v150
    v_lshlrev_b32 v50, 16, v151
    v_and_b32 v51, 0xffff0000, v151
    s_waitcnt lgkmcnt(0)
    v_pk_fma_f32 v[44:45], v[204:205], v[26:27], v[48:49] op_sel:[0,0,0] op_sel_hi:[1,0,1] neg_lo:[0,1,0] neg_hi:[0,1,0]
    v_pk_fma_f32 v[46:47], v[206:207], v[26:27], v[50:51] op_sel:[0,0,0] op_sel_hi:[1,0,1] neg_lo:[0,1,0] neg_hi:[0,1,0]
    v_pk_fma_f32 v[108:109], v[108:109], v[172:173], v[44:45] op_sel:[0,1,0] op_sel_hi:[1,1,1]
    v_pk_fma_f32 v[110:111], v[110:111], v[172:173], v[46:47] op_sel:[0,1,0] op_sel_hi:[1,1,1]
    v_max_f32 v108, 0, v108
    v_max_f32 v109, 0, v109
    v_max_f32 v110, 0, v110
    v_max_f32 v111, 0, v111
    v_pk_mul_f32 v[108:109], v[108:109], v[108:109]
    v_pk_mul_f32 v[110:111], v[110:111], v[110:111]
    v_cvt_pk_bf16_f32 v42, v108, v109
    v_cvt_pk_bf16_f32 v43, v110, v111
    v_pk_fma_f32 v[44:45], v[204:205], v[26:27], v[48:49] op_sel:[0,1,0] op_sel_hi:[1,1,1] neg_lo:[0,1,0] neg_hi:[0,1,0]
    buffer_store_dwordx4 v[40:43], v2, s[32:35], s58 offen offset:3072 sc1
    v_pk_fma_f32 v[46:47], v[206:207], v[26:27], v[50:51] op_sel:[0,1,0] op_sel_hi:[1,1,1] neg_lo:[0,1,0] neg_hi:[0,1,0]
    v_pk_fma_f32 v[112:113], v[112:113], v[174:175], v[44:45] op_sel:[0,1,0] op_sel_hi:[1,1,1]
    v_pk_fma_f32 v[114:115], v[114:115], v[174:175], v[46:47] op_sel:[0,1,0] op_sel_hi:[1,1,1]
    v_max_f32 v112, 0, v112
    v_max_f32 v113, 0, v113
    v_max_f32 v114, 0, v114
    v_max_f32 v115, 0, v115
    v_pk_mul_f32 v[112:113], v[112:113], v[112:113]
    v_pk_mul_f32 v[114:115], v[114:115], v[114:115]
    v_cvt_pk_bf16_f32 v130, v112, v113
    v_cvt_pk_bf16_f32 v131, v114, v115
    s_lshr_b32 s54, s44, 1
    s_mul_i32 s54, s54, 4224
    s_add_u32 s54, s54, 143616
    s_and_b32 s55, s44, 1
    s_lshl_b32 s56, s55, 11
    s_add_u32 s56, s56, s54
    v_add_u32 v5, s56, v2
    ds_write_b128 v5, v[152:155]
    ds_write_b128 v5, v[156:159] offset:1024
    v_mov_b32 v44, 0
    v_mov_b32 v45, 0
    v_mov_b32 v46, 0
    v_mov_b32 v47, 0
    v_mov_b32 v6, s54
    ds_write_b128 v6, v[44:47] offset:4096
    s_waitcnt lgkmcnt(0)
    s_barrier
    s_lshr_b32 s54, s44, 1
    s_mul_i32 s54, s54, 4224
    s_and_b32 s55, s44, 1
    s_lshl_b32 s55, s55, 6
    s_add_u32 s54, s54, s55
    s_add_u32 s54, s54, 146688
    v_lshrrev_b32 v25, 2, v3
    v_lshlrev_b32 v25, 10, v25
    v_lshlrev_b32 v26, 4, v4
    v_sub_u32 v25, v26, v25
    v_add_u32 v25, s54, v25
    v_and_b32 v26, 2, v1
    v_cmp_eq_u32 s[60:61], 0, v26
    v_and_b32 v26, 1, v1
    v_xor_b32 v26, 1, v26
    v_lshlrev_b32 v26, 4, v26
    ds_read_b128 v[76:79], v25 offset:0
    ds_read_b64 v[80:81], v25 offset:16
    ds_read_b128 v[84:87], v25 offset:128
    ds_read_b64 v[88:89], v25 offset:144
    s_waitcnt lgkmcnt(3)
    v_cndmask_b32 v76, v76, v77, s[60:61]
    v_cndmask_b32 v77, v77, v78, s[60:61]
    v_cndmask_b32 v78, v78, v79, s[60:61]
    s_waitcnt lgkmcnt(2)
    v_cndmask_b32 v79, v79, v80, s[60:61]
    v_cndmask_b32 v80, v80, v81, s[60:61]
    v_alignbit_b32 v44, v77, v76, v26
    v_alignbit_b32 v45, v78, v77, v26
    v_alignbit_b32 v46, v79, v78, v26
    v_alignbit_b32 v47, v80, v79, v26
    s_lshr_b32 s54, s44, 1
    s_mul_i32 s54, s54, 4224
    s_and_b32 s55, s44, 1
    s_lshl_b32 s55, s55, 6
    s_add_u32 s54, s54, s55
    s_add_u32 s54, s54, 135176
    v_lshlrev_b32 v5, 3, v3
    v_lshl_add_u32 v5, v4, 4, v5
    v_add_u32 v27, s54, v5
    ds_read_b64 v[164:165], v27 offset:0
    ds_read_b64 v[166:167], v27 offset:8
    ds_read_b64 v[168:169], v27 offset:128
    ds_read_b64 v[170:171], v27 offset:136
    s_waitcnt lgkmcnt(2)
    v_mfma_f32_16x16x32_bf16 v[160:163], v[44:47], v[164:167], 0
    buffer_store_dwordx4 v[128:131], v2, s[32:35], s59 offen offset:3072 sc1
    v_cndmask_b32 v84, v84, v85, s[60:61]
    v_cndmask_b32 v85, v85, v86, s[60:61]
    v_cndmask_b32 v86, v86, v87, s[60:61]
    v_cndmask_b32 v87, v87, v88, s[60:61]
    v_cndmask_b32 v88, v88, v89, s[60:61]
    v_alignbit_b32 v48, v85, v84, v26
    v_alignbit_b32 v49, v86, v85, v26
    v_alignbit_b32 v50, v87, v86, v26
    v_alignbit_b32 v51, v88, v87, v26
    ds_read_b128 v[76:79], v25 offset:256
    ds_read_b64 v[80:81], v25 offset:272
    s_waitcnt lgkmcnt(2)
    v_mfma_f32_16x16x32_bf16 v[160:163], v[48:51], v[168:171], v[160:163]
    s_waitcnt lgkmcnt(1)
    v_cndmask_b32 v76, v76, v77, s[60:61]
    v_cndmask_b32 v77, v77, v78, s[60:61]
    v_mfma_f32_16x16x32_bf16 v[156:159], v[48:51], v[164:167], 0
    v_cndmask_b32 v78, v78, v79, s[60:61]
    s_waitcnt lgkmcnt(0)
    v_cndmask_b32 v79, v79, v80, s[60:61]
    v_cndmask_b32 v80, v80, v81, s[60:61]
    v_alignbit_b32 v52, v77, v76, v26
    v_alignbit_b32 v53, v78, v77, v26
    v_alignbit_b32 v54, v79, v78, v26
    v_alignbit_b32 v55, v80, v79, v26
    ds_read_b128 v[84:87], v25 offset:384
    ds_read_b64 v[88:89], v25 offset:400
    s_waitcnt lgkmcnt(1)
    v_cndmask_b32 v84, v84, v85, s[60:61]
    v_cndmask_b32 v85, v85, v86, s[60:61]
    v_cndmask_b32 v86, v86, v87, s[60:61]
    s_waitcnt lgkmcnt(0)
    v_cndmask_b32 v87, v87, v88, s[60:61]
    v_cndmask_b32 v88, v88, v89, s[60:61]
    v_alignbit_b32 v56, v85, v84, v26
    v_alignbit_b32 v57, v86, v85, v26
    v_alignbit_b32 v58, v87, v86, v26
    v_alignbit_b32 v59, v88, v87, v26
    ds_read_b128 v[76:79], v25 offset:512
    ds_read_b64 v[80:81], v25 offset:528
    ds_read_b64 v[172:173], v27 offset:256
    ds_read_b64 v[174:175], v27 offset:264
    s_waitcnt lgkmcnt(0)
    v_mfma_f32_16x16x32_bf16 v[160:163], v[52:55], v[172:175], v[160:163]
    ds_read_b64 v[176:177], v27 offset:384
    ds_read_b64 v[178:179], v27 offset:392
    v_mfma_f32_16x16x32_bf16 v[156:159], v[52:55], v[168:171], v[156:159]
    v_mov_b32_dpp v44, v44 row_shr:4 row_mask:0xf bank_mask:0xf bound_ctrl:0
    v_mov_b32_dpp v45, v45 row_shr:4 row_mask:0xf bank_mask:0xf bound_ctrl:0
    v_mfma_f32_16x16x32_bf16 v[152:155], v[52:55], v[164:167], 0
    v_mov_b32_dpp v46, v46 row_shr:4 row_mask:0xf bank_mask:0xf bound_ctrl:0
    v_mov_b32_dpp v47, v47 row_shr:4 row_mask:0xf bank_mask:0xf bound_ctrl:0
    s_waitcnt lgkmcnt(0)
    v_mfma_f32_16x16x32_bf16 v[160:163], v[56:59], v[176:179], v[160:163]
    v_cndmask_b32 v76, v76, v77, s[60:61]
    v_cndmask_b32 v77, v77, v78, s[60:61]
    v_mfma_f32_16x16x32_bf16 v[156:159], v[56:59], v[172:175], v[156:159]
    v_cndmask_b32 v78, v78, v79, s[60:61]
    v_cndmask_b32 v79, v79, v80, s[60:61]
    v_mfma_f32_16x16x32_bf16 v[152:155], v[56:59], v[168:171], v[152:155]
    v_cndmask_b32 v80, v80, v81, s[60:61]
    v_alignbit_b32 v60, v77, v76, v26
    v_mfma_f32_16x16x32_bf16 v[148:151], v[56:59], v[164:167], 0
    v_alignbit_b32 v61, v78, v77, v26
    v_alignbit_b32 v62, v79, v78, v26
    v_alignbit_b32 v63, v80, v79, v26
    ds_read_b128 v[84:87], v25 offset:640
    ds_read_b64 v[88:89], v25 offset:656
    s_waitcnt lgkmcnt(1)
    v_cndmask_b32 v84, v84, v85, s[60:61]
    v_cndmask_b32 v85, v85, v86, s[60:61]
    v_cndmask_b32 v86, v86, v87, s[60:61]
    s_waitcnt lgkmcnt(0)
    v_cndmask_b32 v87, v87, v88, s[60:61]
    v_cndmask_b32 v88, v88, v89, s[60:61]
    v_alignbit_b32 v64, v85, v84, v26
    v_alignbit_b32 v65, v86, v85, v26
    v_alignbit_b32 v66, v87, v86, v26
    v_alignbit_b32 v67, v88, v87, v26
    ds_read_b128 v[76:79], v25 offset:768
    ds_read_b64 v[80:81], v25 offset:784
    ds_read_b64 v[180:181], v27 offset:512
    ds_read_b64 v[182:183], v27 offset:520
    s_waitcnt lgkmcnt(0)
    v_mfma_f32_16x16x32_bf16 v[160:163], v[60:63], v[180:183], v[160:163]
    v_mov_b32_dpp v48, v48 row_shr:4 row_mask:0xf bank_mask:0xf bound_ctrl:0
    v_mov_b32_dpp v49, v49 row_shr:4 row_mask:0xf bank_mask:0xf bound_ctrl:0
    v_mfma_f32_16x16x32_bf16 v[156:159], v[60:63], v[176:179], v[156:159]
    v_mov_b32_dpp v50, v50 row_shr:4 row_mask:0xf bank_mask:0xf bound_ctrl:0
    v_mov_b32_dpp v51, v51 row_shr:4 row_mask:0xf bank_mask:0xf bound_ctrl:0
    v_mfma_f32_16x16x32_bf16 v[152:155], v[60:63], v[172:175], v[152:155]
    ds_read_b64_tr_b16 a[0:1], v15 offset:0
    v_mfma_f32_16x16x32_bf16 v[148:151], v[60:63], v[168:171], v[148:151]
    ds_read_b64_tr_b16 a[2:3], v15 offset:2048
    ds_read_b64_tr_b16 a[4:5], v16 offset:0
    v_mfma_f32_16x16x32_bf16 v[144:147], v[60:63], v[164:167], 0
    ds_read_b64_tr_b16 a[6:7], v16 offset:2048
    ds_read_b64_tr_b16 a[8:9], v17 offset:0
    v_cndmask_b32 v76, v76, v77, s[60:61]
    v_cndmask_b32 v77, v77, v78, s[60:61]
    v_cndmask_b32 v78, v78, v79, s[60:61]
    v_cndmask_b32 v79, v79, v80, s[60:61]
    v_cndmask_b32 v80, v80, v81, s[60:61]
    v_alignbit_b32 v68, v77, v76, v26
    v_alignbit_b32 v69, v78, v77, v26
    v_alignbit_b32 v70, v79, v78, v26
    v_alignbit_b32 v71, v80, v79, v26
    ds_read_b128 v[84:87], v25 offset:896
    ds_read_b64 v[88:89], v25 offset:912
    ds_read_b64_tr_b16 a[10:11], v17 offset:2048
    ds_read_b64_tr_b16 a[12:13], v18 offset:0
    ds_read_b64_tr_b16 a[14:15], v18 offset:2048
    ds_read_b64 v[184:185], v27 offset:640
    ds_read_b64 v[186:187], v27 offset:648
    s_waitcnt lgkmcnt(0)
    v_mfma_f32_16x16x32_bf16 v[160:163], v[64:67], v[184:187], v[160:163]
    s_add_u32 m0, s93, 0
    s_nop 0
    buffer_load_dwordx4 v11, s[24:27], s72 offen lds
    v_mov_b32_dpp v52, v52 row_shr:4 row_mask:0xf bank_mask:0xf bound_ctrl:0
    v_mov_b32_dpp v53, v53 row_shr:4 row_mask:0xf bank_mask:0xf bound_ctrl:0
    v_mfma_f32_16x16x32_bf16 v[156:159], v[64:67], v[180:183], v[156:159]
    v_mov_b32_dpp v54, v54 row_shr:4 row_mask:0xf bank_mask:0xf bound_ctrl:0
    v_mov_b32_dpp v55, v55 row_shr:4 row_mask:0xf bank_mask:0xf bound_ctrl:0
    v_mfma_f32_16x16x32_bf16 v[152:155], v[64:67], v[176:179], v[152:155]
    ds_read_b64 v[188:189], v27 offset:768
    ds_read_b64 v[190:191], v27 offset:776
    v_mfma_f32_16x16x32_bf16 v[148:151], v[64:67], v[172:175], v[148:151]
    v_mov_b32_dpp v56, v56 row_shr:4 row_mask:0xf bank_mask:0xf bound_ctrl:0
    v_mov_b32_dpp v57, v57 row_shr:4 row_mask:0xf bank_mask:0xf bound_ctrl:0
    v_mfma_f32_16x16x32_bf16 v[144:147], v[64:67], v[168:171], v[144:147]
    buffer_load_dwordx4 v12, s[24:27], s72 offen offset:1024 lds
    v_mov_b32_dpp v58, v58 row_shr:4 row_mask:0xf bank_mask:0xf bound_ctrl:0
    v_mov_b32_dpp v59, v59 row_shr:4 row_mask:0xf bank_mask:0xf bound_ctrl:0
    v_mfma_f32_16x16x32_bf16 v[140:143], v[64:67], v[164:167], 0
    ds_read_b64 v[192:193], v27 offset:896
    ds_read_b64 v[194:195], v27 offset:904
    s_waitcnt lgkmcnt(2)
    v_mfma_f32_16x16x32_bf16 v[160:163], v[68:71], v[188:191], v[160:163]
    v_cndmask_b32 v84, v84, v85, s[60:61]
    v_cndmask_b32 v85, v85, v86, s[60:61]
    v_mfma_f32_16x16x32_bf16 v[156:159], v[68:71], v[184:187], v[156:159]
    v_cndmask_b32 v86, v86, v87, s[60:61]
    v_cndmask_b32 v87, v87, v88, s[60:61]
    v_mfma_f32_16x16x32_bf16 v[152:155], v[68:71], v[180:183], v[152:155]
    buffer_load_dwordx4 v13, s[24:27], s72 offen offset:2048 lds
    v_cndmask_b32 v88, v88, v89, s[60:61]
    v_alignbit_b32 v72, v85, v84, v26
    v_mfma_f32_16x16x32_bf16 v[148:151], v[68:71], v[176:179], v[148:151]
    v_alignbit_b32 v73, v86, v85, v26
    v_alignbit_b32 v74, v87, v86, v26
    v_mfma_f32_16x16x32_bf16 v[144:147], v[68:71], v[172:175], v[144:147]
    v_alignbit_b32 v75, v88, v87, v26
    v_mov_b32_dpp v60, v60 row_shr:4 row_mask:0xf bank_mask:0xf bound_ctrl:0
    v_mfma_f32_16x16x32_bf16 v[140:143], v[68:71], v[168:171], v[140:143]
    v_mov_b32_dpp v61, v61 row_shr:4 row_mask:0xf bank_mask:0xf bound_ctrl:0
    v_mov_b32_dpp v62, v62 row_shr:4 row_mask:0xf bank_mask:0xf bound_ctrl:0
    v_mfma_f32_16x16x32_bf16 v[136:139], v[68:71], v[164:167], 0
    buffer_load_dwordx4 v14, s[24:27], s72 offen offset:3072 lds
    v_mov_b32_dpp v63, v63 row_shr:4 row_mask:0xf bank_mask:0xf bound_ctrl:0
    s_waitcnt lgkmcnt(0)
    v_mfma_f32_16x16x32_bf16 v[160:163], v[72:75], v[192:195], v[160:163]
    ds_read_b64_tr_b16 a[16:17], v15 offset:16384
    ds_read_b64_tr_b16 a[18:19], v15 offset:18432
    v_mfma_f32_16x16x32_bf16 v[156:159], v[72:75], v[188:191], v[156:159]
    ds_read_b64_tr_b16 a[20:21], v16 offset:16384
    ds_read_b64_tr_b16 a[22:23], v16 offset:18432
    v_mfma_f32_16x16x32_bf16 v[152:155], v[72:75], v[184:187], v[152:155]
    ds_read_b64_tr_b16 a[24:25], v17 offset:16384
    ds_read_b64_tr_b16 a[26:27], v17 offset:18432
    v_mfma_f32_16x16x32_bf16 v[148:151], v[72:75], v[180:183], v[148:151]
    ds_read_b64_tr_b16 a[28:29], v18 offset:16384
    ds_read_b64_tr_b16 a[30:31], v18 offset:18432
    v_mfma_f32_16x16x32_bf16 v[144:147], v[72:75], v[176:179], v[144:147]
    s_waitcnt lgkmcnt(0)
    s_add_u32 m0, s93, 16384
    s_nop 0
    buffer_load_dwordx4 v11, s[24:27], s73 offen lds
    ds_read_b64 v[196:197], v27 offset:1024
    ds_read_b64 v[198:199], v27 offset:1032
    v_mfma_f32_16x16x32_bf16 v[140:143], v[72:75], v[172:175], v[140:143]
    v_mov_b32_dpp v64, v64 row_shr:4 row_mask:0xf bank_mask:0xf bound_ctrl:0
    v_mov_b32_dpp v65, v65 row_shr:4 row_mask:0xf bank_mask:0xf bound_ctrl:0
    v_mfma_f32_16x16x32_bf16 v[136:139], v[72:75], v[168:171], v[136:139]
    v_mov_b32_dpp v66, v66 row_shr:4 row_mask:0xf bank_mask:0xf bound_ctrl:0
    v_mov_b32_dpp v67, v67 row_shr:4 row_mask:0xf bank_mask:0xf bound_ctrl:0
    v_mfma_f32_16x16x32_bf16 v[132:135], v[72:75], v[164:167], 0
    ds_read_b64 v[200:201], v27 offset:1152
    ds_read_b64 v[202:203], v27 offset:1160
    s_waitcnt lgkmcnt(2)
    v_mfma_f32_16x16x32_bf16 v[160:163], v[44:47], v[196:199], v[160:163]
    buffer_load_dwordx4 v12, s[24:27], s73 offen offset:1024 lds
    v_mov_b32_dpp v68, v68 row_shr:4 row_mask:0xf bank_mask:0xf bound_ctrl:0
    v_mov_b32_dpp v69, v69 row_shr:4 row_mask:0xf bank_mask:0xf bound_ctrl:0
    v_mfma_f32_16x16x32_bf16 v[156:159], v[44:47], v[192:195], v[156:159]
    v_mov_b32_dpp v70, v70 row_shr:4 row_mask:0xf bank_mask:0xf bound_ctrl:0
    v_mov_b32_dpp v71, v71 row_shr:4 row_mask:0xf bank_mask:0xf bound_ctrl:0
    v_mfma_f32_16x16x32_bf16 v[152:155], v[44:47], v[188:191], v[152:155]
    s_waitcnt vmcnt(34)
    ds_read_b64_tr_b16 a[32:33], v15 offset:33792
    v_mfma_f32_16x16x32_bf16 v[148:151], v[44:47], v[184:187], v[148:151]
    ds_read_b64_tr_b16 a[34:35], v15 offset:35840
    ds_read_b64_tr_b16 a[36:37], v16 offset:33792
    v_mfma_f32_16x16x32_bf16 v[144:147], v[44:47], v[180:183], v[144:147]
    buffer_load_dwordx4 v13, s[24:27], s73 offen offset:2048 lds
    ds_read_b64_tr_b16 a[38:39], v16 offset:35840
    ds_read_b64_tr_b16 a[40:41], v17 offset:33792
    v_mfma_f32_16x16x32_bf16 v[140:143], v[44:47], v[176:179], v[140:143]
    ds_read_b64_tr_b16 a[42:43], v17 offset:35840
    ds_read_b64_tr_b16 a[44:45], v18 offset:33792
    v_mfma_f32_16x16x32_bf16 v[136:139], v[44:47], v[172:175], v[136:139]
    ds_read_b64_tr_b16 a[46:47], v18 offset:35840
    ds_read_b64 v[164:165], v27 offset:1280
    v_mfma_f32_16x16x32_bf16 v[132:135], v[44:47], v[168:171], v[132:135]
    ds_read_b64 v[166:167], v27 offset:1288
    v_mov_b32_dpp v72, v72 row_shr:4 row_mask:0xf bank_mask:0xf bound_ctrl:0
    s_waitcnt lgkmcnt(10)
    v_mfma_f32_16x16x32_bf16 v[160:163], v[48:51], v[200:203], v[160:163]
    buffer_load_dwordx4 v14, s[24:27], s73 offen offset:3072 lds
    v_mov_b32_dpp v73, v73 row_shr:4 row_mask:0xf bank_mask:0xf bound_ctrl:0
    v_mov_b32_dpp v74, v74 row_shr:4 row_mask:0xf bank_mask:0xf bound_ctrl:0
    v_mfma_f32_16x16x32_bf16 v[156:159], v[48:51], v[196:199], v[156:159]
    v_mov_b32_dpp v75, v75 row_shr:4 row_mask:0xf bank_mask:0xf bound_ctrl:0
    ds_read_b64 v[168:169], v27 offset:1408
    v_mfma_f32_16x16x32_bf16 v[152:155], v[48:51], v[192:195], v[152:155]
    ds_read_b64 v[170:171], v27 offset:1416
    v_mov_b32_dpp v44, v44 row_shr:4 row_mask:0xf bank_mask:0xf bound_ctrl:0
    v_mfma_f32_16x16x32_bf16 v[148:151], v[48:51], v[188:191], v[148:151]
    v_mov_b32_dpp v45, v45 row_shr:4 row_mask:0xf bank_mask:0xf bound_ctrl:0
    v_mov_b32_dpp v46, v46 row_shr:4 row_mask:0xf bank_mask:0xf bound_ctrl:0
    v_mfma_f32_16x16x32_bf16 v[144:147], v[48:51], v[184:187], v[144:147]
    s_waitcnt lgkmcnt(4)
    s_add_u32 m0, s93, 33792
    s_nop 0
    buffer_load_dwordx4 v11, s[24:27], s74 offen lds
    v_mov_b32_dpp v47, v47 row_shr:4 row_mask:0xf bank_mask:0xf bound_ctrl:0
    s_waitcnt vmcnt(33)
    v_mfma_f32_16x16x32_bf16 v[140:143], v[48:51], v[180:183], v[140:143]
    ds_read_b64_tr_b16 a[48:49], v15 offset:50176
    ds_read_b64_tr_b16 a[50:51], v15 offset:52224
    v_mfma_f32_16x16x32_bf16 v[136:139], v[48:51], v[176:179], v[136:139]
    ds_read_b64_tr_b16 a[52:53], v16 offset:50176
    ds_read_b64_tr_b16 a[54:55], v16 offset:52224
    v_mfma_f32_16x16x32_bf16 v[132:135], v[48:51], v[172:175], v[132:135]
    ds_read_b64_tr_b16 a[56:57], v17 offset:50176
    ds_read_b64_tr_b16 a[58:59], v17 offset:52224
    s_waitcnt lgkmcnt(8)
    v_mfma_f32_16x16x32_bf16 v[160:163], v[52:55], v[164:167], v[160:163]
    buffer_load_dwordx4 v12, s[24:27], s74 offen offset:1024 lds
    ds_read_b64_tr_b16 a[60:61], v18 offset:50176
    ds_read_b64_tr_b16 a[62:63], v18 offset:52224
    v_mfma_f32_16x16x32_bf16 v[156:159], v[52:55], v[200:203], v[156:159]
    ds_read_b64 v[172:173], v27 offset:1536
    ds_read_b64 v[174:175], v27 offset:1544
    v_mfma_f32_16x16x32_bf16 v[152:155], v[52:55], v[196:199], v[152:155]
    v_mov_b32_dpp v48, v48 row_shr:4 row_mask:0xf bank_mask:0xf bound_ctrl:0
    v_mov_b32_dpp v49, v49 row_shr:4 row_mask:0xf bank_mask:0xf bound_ctrl:0
    v_mfma_f32_16x16x32_bf16 v[148:151], v[52:55], v[192:195], v[148:151]
    v_mov_b32_dpp v50, v50 row_shr:4 row_mask:0xf bank_mask:0xf bound_ctrl:0
    v_mov_b32_dpp v51, v51 row_shr:4 row_mask:0xf bank_mask:0xf bound_ctrl:0
    v_mfma_f32_16x16x32_bf16 v[144:147], v[52:55], v[188:191], v[144:147]
    buffer_load_dwordx4 v13, s[24:27], s74 offen offset:2048 lds
    v_mfma_f32_16x16x32_bf16 v[140:143], v[52:55], v[184:187], v[140:143]
    v_mfma_f32_16x16x32_bf16 v[136:139], v[52:55], v[180:183], v[136:139]
    v_mfma_f32_16x16x32_bf16 v[132:135], v[52:55], v[176:179], v[132:135]
    s_waitcnt lgkmcnt(10)
    v_mfma_f32_16x16x32_bf16 v[160:163], v[56:59], v[168:171], v[160:163]
    buffer_load_dwordx4 v14, s[24:27], s74 offen offset:3072 lds
    ds_read_b64 v[176:177], v27 offset:1664
    ds_read_b64 v[178:179], v27 offset:1672
    v_mfma_f32_16x16x32_bf16 v[156:159], v[56:59], v[164:167], v[156:159]
    v_mov_b32_dpp v52, v52 row_shr:4 row_mask:0xf bank_mask:0xf bound_ctrl:0
    v_mov_b32_dpp v53, v53 row_shr:4 row_mask:0xf bank_mask:0xf bound_ctrl:0
    v_mfma_f32_16x16x32_bf16 v[152:155], v[56:59], v[200:203], v[152:155]
    v_mov_b32_dpp v54, v54 row_shr:4 row_mask:0xf bank_mask:0xf bound_ctrl:0
    v_mov_b32_dpp v55, v55 row_shr:4 row_mask:0xf bank_mask:0xf bound_ctrl:0
    v_mfma_f32_16x16x32_bf16 v[148:151], v[56:59], v[196:199], v[148:151]
    s_waitcnt vmcnt(32)
    ds_read_b64_tr_b16 a[64:65], v19 offset:0
    v_mfma_f32_16x16x32_bf16 v[144:147], v[56:59], v[192:195], v[144:147]
    s_waitcnt lgkmcnt(5)
    s_add_u32 m0, s93, 50176
    s_nop 0
    buffer_load_dwordx4 v11, s[24:27], s75 offen lds
    ds_read_b64_tr_b16 a[66:67], v19 offset:2048
    ds_read_b64_tr_b16 a[68:69], v20 offset:0
    v_mfma_f32_16x16x32_bf16 v[140:143], v[56:59], v[188:191], v[140:143]
    ds_read_b64_tr_b16 a[70:71], v20 offset:2048
    ds_read_b64_tr_b16 a[72:73], v21 offset:0
    v_mfma_f32_16x16x32_bf16 v[136:139], v[56:59], v[184:187], v[136:139]
    ds_read_b64_tr_b16 a[74:75], v21 offset:2048
    ds_read_b64_tr_b16 a[76:77], v22 offset:0
    v_mfma_f32_16x16x32_bf16 v[132:135], v[56:59], v[180:183], v[132:135]
    ds_read_b64_tr_b16 a[78:79], v22 offset:2048
    s_waitcnt vmcnt(13)
    s_barrier
    s_cmp_eq_u32 s44, 0
    s_cbranch_scc0 Lmfl_6
    s_lshl_b32 s101, s47, 6
    s_add_u32 s101, s101, s48
    s_lshl_b32 s101, s101, 2
    s_add_u32 s101, s101, 8192
    v_mov_b32 v9, s101
    v_mov_b32 v10, s52
    s_mov_b64 exec, 1
    buffer_store_dword v10, v9, s[32:35], 0 offen sc1
    s_mov_b64 exec, -1
Lmfl_6:
    s_waitcnt lgkmcnt(10)
    v_mfma_f32_16x16x32_bf16 v[160:163], v[60:63], v[172:175], v[160:163]
    buffer_load_dwordx4 v12, s[24:27], s75 offen offset:1024 lds
    ds_read_b64 v[180:181], v27 offset:1792
    ds_read_b64 v[182:183], v27 offset:1800
    v_mfma_f32_16x16x32_bf16 v[156:159], v[60:63], v[168:171], v[156:159]
    v_mov_b32_dpp v56, v56 row_shr:4 row_mask:0xf bank_mask:0xf bound_ctrl:0
    v_mov_b32_dpp v57, v57 row_shr:4 row_mask:0xf bank_mask:0xf bound_ctrl:0
    v_mfma_f32_16x16x32_bf16 v[152:155], v[60:63], v[164:167], v[152:155]
    v_mov_b32_dpp v58, v58 row_shr:4 row_mask:0xf bank_mask:0xf bound_ctrl:0
    v_mov_b32_dpp v59, v59 row_shr:4 row_mask:0xf bank_mask:0xf bound_ctrl:0
    v_mfma_f32_16x16x32_bf16 v[148:151], v[60:63], v[200:203], v[148:151]
    ds_read_b64_tr_b16 a[80:81], v19 offset:16384
    v_mfma_f32_16x16x32_bf16 v[144:147], v[60:63], v[196:199], v[144:147]
    buffer_load_dwordx4 v13, s[24:27], s75 offen offset:2048 lds
    ds_read_b64_tr_b16 a[82:83], v19 offset:18432
    ds_read_b64_tr_b16 a[84:85], v20 offset:16384
    v_mfma_f32_16x16x32_bf16 v[140:143], v[60:63], v[192:195], v[140:143]
    ds_read_b64_tr_b16 a[86:87], v20 offset:18432
    ds_read_b64_tr_b16 a[88:89], v21 offset:16384
    v_mfma_f32_16x16x32_bf16 v[136:139], v[60:63], v[188:191], v[136:139]
    ds_read_b64_tr_b16 a[90:91], v21 offset:18432
    ds_read_b64_tr_b16 a[92:93], v22 offset:16384
    v_mfma_f32_16x16x32_bf16 v[132:135], v[60:63], v[184:187], v[132:135]
    ds_read_b64_tr_b16 a[94:95], v22 offset:18432
    s_waitcnt lgkmcnt(15)
    v_mfma_f32_16x16x32_bf16 v[160:163], v[64:67], v[176:179], v[160:163]
    buffer_load_dwordx4 v14, s[24:27], s75 offen offset:3072 lds
    ds_read_b64 v[184:185], v27 offset:1920
    ds_read_b64 v[186:187], v27 offset:1928
    v_mfma_f32_16x16x32_bf16 v[156:159], v[64:67], v[172:175], v[156:159]
    v_mov_b32_dpp v60, v60 row_shr:4 row_mask:0xf bank_mask:0xf bound_ctrl:0
    v_mov_b32_dpp v61, v61 row_shr:4 row_mask:0xf bank_mask:0xf bound_ctrl:0
    v_mfma_f32_16x16x32_bf16 v[152:155], v[64:67], v[168:171], v[152:155]
    v_mov_b32_dpp v62, v62 row_shr:4 row_mask:0xf bank_mask:0xf bound_ctrl:0
    v_mov_b32_dpp v63, v63 row_shr:4 row_mask:0xf bank_mask:0xf bound_ctrl:0
    v_mfma_f32_16x16x32_bf16 v[148:151], v[64:67], v[164:167], v[148:151]
    v_mfma_f32_16x16x32_bf16 v[144:147], v[64:67], v[200:203], v[144:147]
    s_waitcnt lgkmcnt(12)
    s_add_u32 m0, s93, 67584
    s_nop 0
    buffer_load_dwordx4 v11, s[24:27], s76 offen lds
    v_mfma_f32_16x16x32_bf16 v[140:143], v[64:67], v[196:199], v[140:143]
    v_mfma_f32_16x16x32_bf16 v[136:139], v[64:67], v[192:195], v[136:139]
    v_mfma_f32_16x16x32_bf16 v[132:135], v[64:67], v[188:191], v[132:135]
    s_waitcnt lgkmcnt(10)
    v_mfma_f32_16x16x32_bf16 v[160:163], v[68:71], v[180:183], v[160:163]
    buffer_load_dwordx4 v12, s[24:27], s76 offen offset:1024 lds
    ds_read_b64 v[188:189], v27 offset:2048
    ds_read_b64 v[190:191], v27 offset:2056
    v_mfma_f32_16x16x32_bf16 v[156:159], v[68:71], v[176:179], v[156:159]
    v_mov_b32_dpp v64, v64 row_shr:4 row_mask:0xf bank_mask:0xf bound_ctrl:0
    v_mov_b32_dpp v65, v65 row_shr:4 row_mask:0xf bank_mask:0xf bound_ctrl:0
    v_mfma_f32_16x16x32_bf16 v[152:155], v[68:71], v[172:175], v[152:155]
    v_mov_b32_dpp v66, v66 row_shr:4 row_mask:0xf bank_mask:0xf bound_ctrl:0
    v_mov_b32_dpp v67, v67 row_shr:4 row_mask:0xf bank_mask:0xf bound_ctrl:0
    v_mfma_f32_16x16x32_bf16 v[148:151], v[68:71], v[168:171], v[148:151]
    ds_read_b64_tr_b16 a[96:97], v19 offset:33792
    v_mfma_f32_16x16x32_bf16 v[144:147], v[68:71], v[164:167], v[144:147]
    buffer_load_dwordx4 v13, s[24:27], s76 offen offset:2048 lds
    ds_read_b64_tr_b16 a[98:99], v19 offset:35840
    ds_read_b64_tr_b16 a[100:101], v20 offset:33792
    v_mfma_f32_16x16x32_bf16 v[140:143], v[68:71], v[200:203], v[140:143]
    ds_read_b64_tr_b16 a[102:103], v20 offset:35840
    ds_read_b64_tr_b16 a[104:105], v21 offset:33792
    v_mfma_f32_16x16x32_bf16 v[136:139], v[68:71], v[196:199], v[136:139]
    ds_read_b64_tr_b16 a[106:107], v21 offset:35840
    ds_read_b64_tr_b16 a[108:109], v22 offset:33792
    v_mfma_f32_16x16x32_bf16 v[132:135], v[68:71], v[192:195], v[132:135]
    ds_read_b64_tr_b16 a[110:111], v22 offset:35840
    ds_read_b64 v[192:193], v27 offset:2176
    ds_read_b64 v[194:195], v27 offset:2184
    v_mov_b32_dpp v68, v68 row_shr:4 row_mask:0xf bank_mask:0xf bound_ctrl:0
    v_mov_b32_dpp v69, v69 row_shr:4 row_mask:0xf bank_mask:0xf bound_ctrl:0
    v_mov_b32_dpp v70, v70 row_shr:4 row_mask:0xf bank_mask:0xf bound_ctrl:0
    v_mov_b32_dpp v71, v71 row_shr:4 row_mask:0xf bank_mask:0xf bound_ctrl:0
    s_waitcnt lgkmcnt(12)
    v_mfma_f32_16x16x32_bf16 v[160:163], v[72:75], v[184:187], v[160:163]
    buffer_load_dwordx4 v14, s[24:27], s76 offen offset:3072 lds
    v_min_u32 v5, 13, v3
    s_lshl_b32 s54, s47, 8
    s_add_u32 s54, s54, 8192
    v_lshl_add_u32 v96, v5, 2, s54
    s_add_u32 s54, s44, 0
    s_and_b32 s54, s54, 3
    s_lshl_b32 s55, s50, 2
    s_add_u32 s54, s54, s55
    s_mul_i32 s54, s54, 57344
    v_add_u32 v92, s54, v2
    s_add_u32 s54, s44, 1
    s_and_b32 s54, s54, 3
    s_lshl_b32 s55, s50, 2
    s_add_u32 s54, s54, s55
    s_mul_i32 s54, s54, 57344
    v_add_u32 v93, s54, v2
    s_add_u32 s54, s44, 2
    s_and_b32 s54, s54, 3
    s_lshl_b32 s55, s50, 2
    s_add_u32 s54, s54, s55
    s_mul_i32 s54, s54, 57344
    v_add_u32 v94, s54, v2
    s_add_u32 s54, s44, 3
    s_and_b32 s54, s54, 3
    s_lshl_b32 s55, s50, 2
    s_add_u32 s54, s54, s55
    s_mul_i32 s54, s54, 57344
    v_add_u32 v95, s54, v2
    v_mfma_f32_16x16x32_bf16 v[156:159], v[72:75], v[180:183], v[156:159]
    v_mfma_f32_16x16x32_bf16 v[152:155], v[72:75], v[176:179], v[152:155]
    v_mfma_f32_16x16x32_bf16 v[148:151], v[72:75], v[172:175], v[148:151]
    v_mfma_f32_16x16x32_bf16 v[144:147], v[72:75], v[168:171], v[144:147]
    s_add_u32 m0, s93, 83968
    s_nop 0
    buffer_load_dwordx4 v11, s[24:27], s77 offen lds
    v_mfma_f32_16x16x32_bf16 v[140:143], v[72:75], v[164:167], v[140:143]
    v_mfma_f32_16x16x32_bf16 v[136:139], v[72:75], v[200:203], v[136:139]
    v_mfma_f32_16x16x32_bf16 v[132:135], v[72:75], v[196:199], v[132:135]
    s_waitcnt lgkmcnt(10)
    v_mfma_f32_16x16x32_bf16 v[160:163], v[44:47], v[188:191], v[160:163]
    buffer_load_dwordx4 v12, s[24:27], s77 offen offset:1024 lds
    ds_read_b64 v[196:197], v27 offset:2304
    ds_read_b64 v[198:199], v27 offset:2312
    v_mfma_f32_16x16x32_bf16 v[156:159], v[44:47], v[184:187], v[156:159]
    v_mov_b32_dpp v72, v72 row_shr:4 row_mask:0xf bank_mask:0xf bound_ctrl:0
    v_mov_b32_dpp v73, v73 row_shr:4 row_mask:0xf bank_mask:0xf bound_ctrl:0
    v_mfma_f32_16x16x32_bf16 v[152:155], v[44:47], v[180:183], v[152:155]
    v_mov_b32_dpp v74, v74 row_shr:4 row_mask:0xf bank_mask:0xf bound_ctrl:0
    v_mov_b32_dpp v75, v75 row_shr:4 row_mask:0xf bank_mask:0xf bound_ctrl:0
    v_mfma_f32_16x16x32_bf16 v[148:151], v[44:47], v[176:179], v[148:151]
    ds_read_b64_tr_b16 a[112:113], v19 offset:50176
    v_mfma_f32_16x16x32_bf16 v[144:147], v[44:47], v[172:175], v[144:147]
    buffer_load_dwordx4 v13, s[24:27], s77 offen offset:2048 lds
    ds_read_b64_tr_b16 a[114:115], v19 offset:52224
    ds_read_b64_tr_b16 a[116:117], v20 offset:50176
    v_mfma_f32_16x16x32_bf16 v[140:143], v[44:47], v[168:171], v[140:143]
    ds_read_b64_tr_b16 a[118:119], v20 offset:52224
    ds_read_b64_tr_b16 a[120:121], v21 offset:50176
    v_mfma_f32_16x16x32_bf16 v[136:139], v[44:47], v[164:167], v[136:139]
    ds_read_b64_tr_b16 a[122:123], v21 offset:52224
    ds_read_b64_tr_b16 a[124:125], v22 offset:50176
    v_mfma_f32_16x16x32_bf16 v[132:135], v[44:47], v[200:203], v[132:135]
    ds_read_b64_tr_b16 a[126:127], v22 offset:52224
    s_waitcnt lgkmcnt(10)
    v_mfma_f32_16x16x32_bf16 v[160:163], v[48:51], v[192:195], v[160:163]
    buffer_load_dwordx4 v14, s[24:27], s77 offen offset:3072 lds
    ds_read_b64 v[200:201], v27 offset:2432
    ds_read_b64 v[202:203], v27 offset:2440
    v_mfma_f32_16x16x32_bf16 v[156:159], v[48:51], v[188:191], v[156:159]
    v_mov_b32_dpp v44, v44 row_shr:4 row_mask:0xf bank_mask:0xf bound_ctrl:0
    v_mov_b32_dpp v45, v45 row_shr:4 row_mask:0xf bank_mask:0xf bound_ctrl:0
    v_mfma_f32_16x16x32_bf16 v[152:155], v[48:51], v[184:187], v[152:155]
    v_mov_b32_dpp v46, v46 row_shr:4 row_mask:0xf bank_mask:0xf bound_ctrl:0
    v_mov_b32_dpp v47, v47 row_shr:4 row_mask:0xf bank_mask:0xf bound_ctrl:0
    v_mfma_f32_16x16x32_bf16 v[148:151], v[48:51], v[180:183], v[148:151]
    s_waitcnt vmcnt(20)
    ds_read_b64_tr_b16 a[128:129], v15 offset:0
    v_mfma_f32_16x16x32_bf16 v[144:147], v[48:51], v[176:179], v[144:147]
    s_cmp_eq_u32 s44, 0
    s_cbranch_scc0 Lmpi_7
    buffer_load_dword v97, v96, s[32:35], 0 offen sc1
Lmpi_7:
    ds_read_b64_tr_b16 a[130:131], v15 offset:2048
    ds_read_b64_tr_b16 a[132:133], v16 offset:0
    v_mfma_f32_16x16x32_bf16 v[140:143], v[48:51], v[172:175], v[140:143]
    ds_read_b64_tr_b16 a[134:135], v16 offset:2048
    ds_read_b64_tr_b16 a[136:137], v17 offset:0
    v_mfma_f32_16x16x32_bf16 v[136:139], v[48:51], v[168:171], v[136:139]
    ds_read_b64_tr_b16 a[138:139], v17 offset:2048
    ds_read_b64_tr_b16 a[140:141], v18 offset:0
    v_mfma_f32_16x16x32_bf16 v[132:135], v[48:51], v[164:167], v[132:135]
    ds_read_b64_tr_b16 a[142:143], v18 offset:2048
    s_waitcnt lgkmcnt(15)
    v_mfma_f32_16x16x32_bf16 v[160:163], v[52:55], v[196:199], v[160:163]
    ds_read_b64 v[164:165], v27 offset:2560
    ds_read_b64 v[166:167], v27 offset:2568
    v_mfma_f32_16x16x32_bf16 v[156:159], v[52:55], v[192:195], v[156:159]
    v_mov_b32_dpp v48, v48 row_shr:4 row_mask:0xf bank_mask:0xf bound_ctrl:0
    v_mov_b32_dpp v49, v49 row_shr:4 row_mask:0xf bank_mask:0xf bound_ctrl:0
    v_mfma_f32_16x16x32_bf16 v[152:155], v[52:55], v[188:191], v[152:155]
    v_mov_b32_dpp v50, v50 row_shr:4 row_mask:0xf bank_mask:0xf bound_ctrl:0
    v_mov_b32_dpp v51, v51 row_shr:4 row_mask:0xf bank_mask:0xf bound_ctrl:0
    v_mfma_f32_16x16x32_bf16 v[148:151], v[52:55], v[184:187], v[148:151]
    v_mfma_f32_16x16x32_bf16 v[144:147], v[52:55], v[180:183], v[144:147]
    v_mfma_f32_16x16x32_bf16 v[140:143], v[52:55], v[176:179], v[140:143]
    v_mfma_f32_16x16x32_bf16 v[136:139], v[52:55], v[172:175], v[136:139]
    v_mfma_f32_16x16x32_bf16 v[132:135], v[52:55], v[168:171], v[132:135]
    s_waitcnt lgkmcnt(10)
    v_mfma_f32_16x16x32_bf16 v[160:163], v[56:59], v[200:203], v[160:163]
    ds_read_b64 v[168:169], v27 offset:2688
    ds_read_b64 v[170:171], v27 offset:2696
    v_mfma_f32_16x16x32_bf16 v[156:159], v[56:59], v[196:199], v[156:159]
    v_mov_b32_dpp v52, v52 row_shr:4 row_mask:0xf bank_mask:0xf bound_ctrl:0
    v_mov_b32_dpp v53, v53 row_shr:4 row_mask:0xf bank_mask:0xf bound_ctrl:0
    v_mfma_f32_16x16x32_bf16 v[152:155], v[56:59], v[192:195], v[152:155]
    v_mov_b32_dpp v54, v54 row_shr:4 row_mask:0xf bank_mask:0xf bound_ctrl:0
    v_mov_b32_dpp v55, v55 row_shr:4 row_mask:0xf bank_mask:0xf bound_ctrl:0
    v_mfma_f32_16x16x32_bf16 v[148:151], v[56:59], v[188:191], v[148:151]
    s_waitcnt vmcnt(16)
    ds_read_b64_tr_b16 a[144:145], v15 offset:16384
    v_mfma_f32_16x16x32_bf16 v[144:147], v[56:59], v[184:187], v[144:147]
    ds_read_b64_tr_b16 a[146:147], v15 offset:18432
    ds_read_b64_tr_b16 a[148:149], v16 offset:16384
    v_mfma_f32_16x16x32_bf16 v[140:143], v[56:59], v[180:183], v[140:143]
    ds_read_b64_tr_b16 a[150:151], v16 offset:18432
    ds_read_b64_tr_b16 a[152:153], v17 offset:16384
    v_mfma_f32_16x16x32_bf16 v[136:139], v[56:59], v[176:179], v[136:139]
    ds_read_b64_tr_b16 a[154:155], v17 offset:18432
    ds_read_b64_tr_b16 a[156:157], v18 offset:16384
    v_mfma_f32_16x16x32_bf16 v[132:135], v[56:59], v[172:175], v[132:135]
    ds_read_b64_tr_b16 a[158:159], v18 offset:18432
    s_waitcnt lgkmcnt(10)
    v_mfma_f32_16x16x32_bf16 v[160:163], v[60:63], v[164:167], v[160:163]
    ds_read_b64 v[172:173], v27 offset:2816
    ds_read_b64 v[174:175], v27 offset:2824
    v_mfma_f32_16x16x32_bf16 v[156:159], v[60:63], v[200:203], v[156:159]
    v_mov_b32_dpp v56, v56 row_shr:4 row_mask:0xf bank_mask:0xf bound_ctrl:0
    v_mov_b32_dpp v57, v57 row_shr:4 row_mask:0xf bank_mask:0xf bound_ctrl:0
    v_mfma_f32_16x16x32_bf16 v[152:155], v[60:63], v[196:199], v[152:155]
    v_mov_b32_dpp v58, v58 row_shr:4 row_mask:0xf bank_mask:0xf bound_ctrl:0
    v_mov_b32_dpp v59, v59 row_shr:4 row_mask:0xf bank_mask:0xf bound_ctrl:0
    v_mfma_f32_16x16x32_bf16 v[148:151], v[60:63], v[192:195], v[148:151]
    s_waitcnt vmcnt(12)
    ds_read_b64_tr_b16 a[160:161], v15 offset:33792
    v_mfma_f32_16x16x32_bf16 v[144:147], v[60:63], v[188:191], v[144:147]
    ds_read_b64_tr_b16 a[162:163], v15 offset:35840
    ds_read_b64_tr_b16 a[164:165], v16 offset:33792
    v_mfma_f32_16x16x32_bf16 v[140:143], v[60:63], v[184:187], v[140:143]
    ds_read_b64_tr_b16 a[166:167], v16 offset:35840
    ds_read_b64_tr_b16 a[168:169], v17 offset:33792
    v_mfma_f32_16x16x32_bf16 v[136:139], v[60:63], v[180:183], v[136:139]
    ds_read_b64_tr_b16 a[170:171], v17 offset:35840
    ds_read_b64_tr_b16 a[172:173], v18 offset:33792
    v_mfma_f32_16x16x32_bf16 v[132:135], v[60:63], v[176:179], v[132:135]
    ds_read_b64_tr_b16 a[174:175], v18 offset:35840
    s_waitcnt lgkmcnt(15)
    v_mfma_f32_16x16x32_bf16 v[160:163], v[64:67], v[168:171], v[160:163]
    ds_read_b64 v[176:177], v27 offset:2944
    ds_read_b64 v[178:179], v27 offset:2952
    v_mfma_f32_16x16x32_bf16 v[156:159], v[64:67], v[164:167], v[156:159]
    v_mov_b32_dpp v60, v60 row_shr:4 row_mask:0xf bank_mask:0xf bound_ctrl:0
    v_mov_b32_dpp v61, v61 row_shr:4 row_mask:0xf bank_mask:0xf bound_ctrl:0
    v_mfma_f32_16x16x32_bf16 v[152:155], v[64:67], v[200:203], v[152:155]
    v_mov_b32_dpp v62, v62 row_shr:4 row_mask:0xf bank_mask:0xf bound_ctrl:0
    v_mov_b32_dpp v63, v63 row_shr:4 row_mask:0xf bank_mask:0xf bound_ctrl:0
    v_mfma_f32_16x16x32_bf16 v[148:151], v[64:67], v[196:199], v[148:151]
    v_mfma_f32_16x16x32_bf16 v[144:147], v[64:67], v[192:195], v[144:147]
    v_mfma_f32_16x16x32_bf16 v[140:143], v[64:67], v[188:191], v[140:143]
    v_mfma_f32_16x16x32_bf16 v[136:139], v[64:67], v[184:187], v[136:139]
    v_mfma_f32_16x16x32_bf16 v[132:135], v[64:67], v[180:183], v[132:135]
    s_waitcnt lgkmcnt(10)
    v_mfma_f32_16x16x32_bf16 v[160:163], v[68:71], v[172:175], v[160:163]
    ds_read_b64 v[180:181], v27 offset:3072
    ds_read_b64 v[182:183], v27 offset:3080
    v_mfma_f32_16x16x32_bf16 v[156:159], v[68:71], v[168:171], v[156:159]
    v_mov_b32_dpp v64, v64 row_shr:4 row_mask:0xf bank_mask:0xf bound_ctrl:0
    v_mov_b32_dpp v65, v65 row_shr:4 row_mask:0xf bank_mask:0xf bound_ctrl:0
    v_mfma_f32_16x16x32_bf16 v[152:155], v[68:71], v[164:167], v[152:155]
    v_mov_b32_dpp v66, v66 row_shr:4 row_mask:0xf bank_mask:0xf bound_ctrl:0
    v_mov_b32_dpp v67, v67 row_shr:4 row_mask:0xf bank_mask:0xf bound_ctrl:0
    v_mfma_f32_16x16x32_bf16 v[148:151], v[68:71], v[200:203], v[148:151]
    s_waitcnt vmcnt(8)
    ds_read_b64_tr_b16 a[176:177], v15 offset:50176
    v_mfma_f32_16x16x32_bf16 v[144:147], v[68:71], v[196:199], v[144:147]
    ds_read_b64_tr_b16 a[178:179], v15 offset:52224
    ds_read_b64_tr_b16 a[180:181], v16 offset:50176
    v_mfma_f32_16x16x32_bf16 v[140:143], v[68:71], v[192:195], v[140:143]
    ds_read_b64_tr_b16 a[182:183], v16 offset:52224
    ds_read_b64_tr_b16 a[184:185], v17 offset:50176
    v_mfma_f32_16x16x32_bf16 v[136:139], v[68:71], v[188:191], v[136:139]
    ds_read_b64_tr_b16 a[186:187], v17 offset:52224
    ds_read_b64_tr_b16 a[188:189], v18 offset:50176
    v_mfma_f32_16x16x32_bf16 v[132:135], v[68:71], v[184:187], v[132:135]
    ds_read_b64_tr_b16 a[190:191], v18 offset:52224
    s_waitcnt lgkmcnt(10)
    v_mfma_f32_16x16x32_bf16 v[160:163], v[72:75], v[176:179], v[160:163]
    ds_read_b64 v[184:185], v27 offset:3200
    ds_read_b64 v[186:187], v27 offset:3208
    v_mfma_f32_16x16x32_bf16 v[156:159], v[72:75], v[172:175], v[156:159]
    v_mov_b32_dpp v68, v68 row_shr:4 row_mask:0xf bank_mask:0xf bound_ctrl:0
    v_mov_b32_dpp v69, v69 row_shr:4 row_mask:0xf bank_mask:0xf bound_ctrl:0
    v_mfma_f32_16x16x32_bf16 v[152:155], v[72:75], v[168:171], v[152:155]
    v_mov_b32_dpp v70, v70 row_shr:4 row_mask:0xf bank_mask:0xf bound_ctrl:0
    v_mov_b32_dpp v71, v71 row_shr:4 row_mask:0xf bank_mask:0xf bound_ctrl:0
    v_mfma_f32_16x16x32_bf16 v[148:151], v[72:75], v[164:167], v[148:151]
    v_mfma_f32_16x16x32_bf16 v[144:147], v[72:75], v[200:203], v[144:147]
    v_mfma_f32_16x16x32_bf16 v[140:143], v[72:75], v[196:199], v[140:143]
    v_mfma_f32_16x16x32_bf16 v[136:139], v[72:75], v[192:195], v[136:139]
    v_mfma_f32_16x16x32_bf16 v[132:135], v[72:75], v[188:191], v[132:135]
    s_waitcnt lgkmcnt(10)
    v_mfma_f32_16x16x32_bf16 v[160:163], v[44:47], v[180:183], v[160:163]
    ds_read_b64 v[188:189], v27 offset:3328
    ds_read_b64 v[190:191], v27 offset:3336
    v_mfma_f32_16x16x32_bf16 v[156:159], v[44:47], v[176:179], v[156:159]
    v_mov_b32_dpp v72, v72 row_shr:4 row_mask:0xf bank_mask:0xf bound_ctrl:0
    v_mov_b32_dpp v73, v73 row_shr:4 row_mask:0xf bank_mask:0xf bound_ctrl:0
    v_mfma_f32_16x16x32_bf16 v[152:155], v[44:47], v[172:175], v[152:155]
    v_mov_b32_dpp v74, v74 row_shr:4 row_mask:0xf bank_mask:0xf bound_ctrl:0
    v_mov_b32_dpp v75, v75 row_shr:4 row_mask:0xf bank_mask:0xf bound_ctrl:0
    v_mfma_f32_16x16x32_bf16 v[148:151], v[44:47], v[168:171], v[148:151]
    s_waitcnt vmcnt(4)
    ds_read_b64_tr_b16 a[192:193], v19 offset:0
    v_mfma_f32_16x16x32_bf16 v[144:147], v[44:47], v[164:167], v[144:147]
    ds_read_b64_tr_b16 a[194:195], v19 offset:2048
    ds_read_b64_tr_b16 a[196:197], v20 offset:0
    v_mfma_f32_16x16x32_bf16 v[140:143], v[44:47], v[200:203], v[140:143]
    ds_read_b64_tr_b16 a[198:199], v20 offset:2048
    ds_read_b64_tr_b16 a[200:201], v21 offset:0
    v_mfma_f32_16x16x32_bf16 v[136:139], v[44:47], v[196:199], v[136:139]
    ds_read_b64_tr_b16 a[202:203], v21 offset:2048
    ds_read_b64_tr_b16 a[204:205], v22 offset:0
    v_mfma_f32_16x16x32_bf16 v[132:135], v[44:47], v[192:195], v[132:135]
    ds_read_b64_tr_b16 a[206:207], v22 offset:2048
    s_waitcnt lgkmcnt(10)
    v_mfma_f32_16x16x32_bf16 v[160:163], v[48:51], v[184:187], v[160:163]
    ds_read_b64 v[192:193], v27 offset:3456
    ds_read_b64 v[194:195], v27 offset:3464
    v_mfma_f32_16x16x32_bf16 v[156:159], v[48:51], v[180:183], v[156:159]
    s_waitcnt vmcnt(0)
    ds_read_b64_tr_b16 a[208:209], v19 offset:16384
    v_mfma_f32_16x16x32_bf16 v[152:155], v[48:51], v[176:179], v[152:155]
    ds_read_b64_tr_b16 a[210:211], v19 offset:18432
    ds_read_b64_tr_b16 a[212:213], v20 offset:16384
    v_mfma_f32_16x16x32_bf16 v[148:151], v[48:51], v[172:175], v[148:151]
    ds_read_b64_tr_b16 a[214:215], v20 offset:18432
    ds_read_b64_tr_b16 a[216:217], v21 offset:16384
    v_mfma_f32_16x16x32_bf16 v[144:147], v[48:51], v[168:171], v[144:147]
    ds_read_b64_tr_b16 a[218:219], v21 offset:18432
    ds_read_b64_tr_b16 a[220:221], v22 offset:16384
    v_mfma_f32_16x16x32_bf16 v[140:143], v[48:51], v[164:167], v[140:143]
    ds_read_b64_tr_b16 a[222:223], v22 offset:18432
    s_cmp_eq_u32 s44, 0
    s_cbranch_scc0 Lmpok_8
    v_cmp_eq_u32 vcc, s52, v97
    s_nop 3
    s_cmp_eq_u64 vcc, exec
    s_cbranch_scc1 Lmpok_8
    s_mov_b32 s62, 0x20000
Lmprt_9:
    s_sleep 8
    buffer_load_dword v97, v96, s[32:35], 0 offen sc1
    s_waitcnt vmcnt(0)
    v_cmp_eq_u32 vcc, s52, v97
    s_nop 3
    s_cmp_eq_u64 vcc, exec
    s_cbranch_scc1 Lmpok_8
    s_sub_u32 s62, s62, 1
    s_cmp_lg_u32 s62, 0
    s_cbranch_scc1 Lmprt_9
Lmpok_8:
    s_barrier
    v_mfma_f32_16x16x32_bf16 v[136:139], v[48:51], v[200:203], v[136:139]
    buffer_load_dwordx4 v[28:31], v92, s[32:35], s78 offen sc1
    v_mfma_f32_16x16x32_bf16 v[132:135], v[48:51], v[196:199], v[132:135]
    s_waitcnt lgkmcnt(15)
    v_mfma_f32_16x16x32_bf16 v[160:163], v[52:55], v[188:191], v[160:163]
    ds_read_b64 v[196:197], v27 offset:3584
    ds_read_b64 v[198:199], v27 offset:3592
    v_mfma_f32_16x16x32_bf16 v[156:159], v[52:55], v[184:187], v[156:159]
    v_mfma_f32_16x16x32_bf16 v[152:155], v[52:55], v[180:183], v[152:155]
    buffer_load_dwordx4 v[32:35], v93, s[32:35], s78 offen sc1
    v_mfma_f32_16x16x32_bf16 v[148:151], v[52:55], v[176:179], v[148:151]
    v_mfma_f32_16x16x32_bf16 v[144:147], v[52:55], v[172:175], v[144:147]
    v_mfma_f32_16x16x32_bf16 v[140:143], v[52:55], v[168:171], v[140:143]
    v_mfma_f32_16x16x32_bf16 v[136:139], v[52:55], v[164:167], v[136:139]
    buffer_load_dwordx4 v[36:39], v94, s[32:35], s78 offen sc1
    v_mfma_f32_16x16x32_bf16 v[132:135], v[52:55], v[200:203], v[132:135]
    s_waitcnt lgkmcnt(10)
    v_mfma_f32_16x16x32_bf16 v[160:163], v[56:59], v[192:195], v[160:163]
    ds_read_b64 v[200:201], v27 offset:3712
    ds_read_b64 v[202:203], v27 offset:3720
    v_mfma_f32_16x16x32_bf16 v[156:159], v[56:59], v[188:191], v[156:159]
    v_mfma_f32_16x16x32_bf16 v[152:155], v[56:59], v[184:187], v[152:155]
    buffer_load_dwordx4 v[40:43], v95, s[32:35], s78 offen sc1
    v_mfma_f32_16x16x32_bf16 v[148:151], v[56:59], v[180:183], v[148:151]
    v_mfma_f32_16x16x32_bf16 v[144:147], v[56:59], v[176:179], v[144:147]
    v_mfma_f32_16x16x32_bf16 v[140:143], v[56:59], v[172:175], v[140:143]
    v_mfma_f32_16x16x32_bf16 v[136:139], v[56:59], v[168:171], v[136:139]
    buffer_load_dwordx4 v[76:79], v92, s[32:35], s79 offen sc1
    v_mfma_f32_16x16x32_bf16 v[132:135], v[56:59], v[164:167], v[132:135]
    s_waitcnt lgkmcnt(2)
    v_mfma_f32_16x16x32_bf16 v[160:163], v[60:63], v[196:199], v[160:163]
    ds_read_b64 v[164:165], v27 offset:3840
    ds_read_b64 v[166:167], v27 offset:3848
    v_mfma_f32_16x16x32_bf16 v[156:159], v[60:63], v[192:195], v[156:159]
    v_mfma_f32_16x16x32_bf16 v[152:155], v[60:63], v[188:191], v[152:155]
    buffer_load_dwordx4 v[80:83], v93, s[32:35], s79 offen sc1
    v_mfma_f32_16x16x32_bf16 v[148:151], v[60:63], v[184:187], v[148:151]
    v_mfma_f32_16x16x32_bf16 v[144:147], v[60:63], v[180:183], v[144:147]
    v_mfma_f32_16x16x32_bf16 v[140:143], v[60:63], v[176:179], v[140:143]
    v_mfma_f32_16x16x32_bf16 v[136:139], v[60:63], v[172:175], v[136:139]
    buffer_load_dwordx4 v[84:87], v94, s[32:35], s79 offen sc1
    v_mfma_f32_16x16x32_bf16 v[132:135], v[60:63], v[168:171], v[132:135]
    s_waitcnt lgkmcnt(2)
    v_mfma_f32_16x16x32_bf16 v[160:163], v[64:67], v[200:203], v[160:163]
    ds_read_b64 v[168:169], v27 offset:3968
    ds_read_b64 v[170:171], v27 offset:3976
    v_mfma_f32_16x16x32_bf16 v[156:159], v[64:67], v[196:199], v[156:159]
    v_mfma_f32_16x16x32_bf16 v[152:155], v[64:67], v[192:195], v[152:155]
    buffer_load_dwordx4 v[88:91], v95, s[32:35], s79 offen sc1
    v_mfma_f32_16x16x32_bf16 v[148:151], v[64:67], v[188:191], v[148:151]
    v_mfma_f32_16x16x32_bf16 v[144:147], v[64:67], v[184:187], v[144:147]
    v_mfma_f32_16x16x32_bf16 v[140:143], v[64:67], v[180:183], v[140:143]
    v_mfma_f32_16x16x32_bf16 v[136:139], v[64:67], v[176:179], v[136:139]
    buffer_load_dwordx4 v[100:103], v92, s[32:35], s80 offen sc1
    v_mfma_f32_16x16x32_bf16 v[132:135], v[64:67], v[172:175], v[132:135]
    s_waitcnt lgkmcnt(2)
    v_mfma_f32_16x16x32_bf16 v[160:163], v[68:71], v[164:167], v[160:163]
    v_mfma_f32_16x16x32_bf16 v[156:159], v[68:71], v[200:203], v[156:159]
    v_mfma_f32_16x16x32_bf16 v[152:155], v[68:71], v[196:199], v[152:155]
    buffer_load_dwordx4 v[104:107], v93, s[32:35], s80 offen sc1
    v_mfma_f32_16x16x32_bf16 v[148:151], v[68:71], v[192:195], v[148:151]
    v_mfma_f32_16x16x32_bf16 v[144:147], v[68:71], v[188:191], v[144:147]
    v_mfma_f32_16x16x32_bf16 v[140:143], v[68:71], v[184:187], v[140:143]
    v_mfma_f32_16x16x32_bf16 v[136:139], v[68:71], v[180:183], v[136:139]
    buffer_load_dwordx4 v[108:111], v94, s[32:35], s80 offen sc1
    v_mfma_f32_16x16x32_bf16 v[132:135], v[68:71], v[176:179], v[132:135]
    s_waitcnt lgkmcnt(0)
    v_mfma_f32_16x16x32_bf16 v[160:163], v[72:75], v[168:171], v[160:163]
    v_mfma_f32_16x16x32_bf16 v[156:159], v[72:75], v[164:167], v[156:159]
    v_mfma_f32_16x16x32_bf16 v[152:155], v[72:75], v[200:203], v[152:155]
    buffer_load_dwordx4 v[112:115], v95, s[32:35], s80 offen sc1
    v_mfma_f32_16x16x32_bf16 v[148:151], v[72:75], v[196:199], v[148:151]
    v_mfma_f32_16x16x32_bf16 v[144:147], v[72:75], v[192:195], v[144:147]
    v_mfma_f32_16x16x32_bf16 v[140:143], v[72:75], v[188:191], v[140:143]
    v_mfma_f32_16x16x32_bf16 v[136:139], v[72:75], v[184:187], v[136:139]
    buffer_load_dwordx4 v[116:119], v92, s[32:35], s81 offen sc1
    v_mfma_f32_16x16x32_bf16 v[132:135], v[72:75], v[180:183], v[132:135]
    s_add_u32 s54, s93, 143616
    v_add_u32 v5, s54, v2
    s_xor_b32 s55, s93, 4096
    s_add_u32 s55, s55, 143616
    v_add_u32 v6, s55, v2
    v_lshlrev_b32 v7, 3, v3
    v_lshl_add_u32 v7, v4, 10, v7
    s_lshl_b32 s56, s3, 12
    s_add_u32 s56, s56, 2228224
    s_and_b32 s57, s44, 1
    s_cmp_eq_u32 s57, 0
    s_cbranch_scc0 Lmcvo_10
    ds_write_b128 v5, v[148:151] offset:0
    ds_write_b128 v5, v[152:155] offset:1024
    ds_write_b128 v5, v[156:159] offset:2048
    ds_write_b128 v5, v[160:163] offset:3072
    s_waitcnt lgkmcnt(0)
    s_barrier
    ds_read_b128 v[44:47], v6 offset:0
    ds_read_b128 v[48:51], v6 offset:1024
    ds_read_b128 v[52:55], v6 offset:2048
    ds_read_b128 v[56:59], v6 offset:3072
    s_waitcnt lgkmcnt(3)
    v_add_f32 v44, v44, v132
    v_add_f32 v45, v45, v133
    v_add_f32 v46, v46, v134
    v_add_f32 v47, v47, v135
    v_cvt_pk_bf16_f32 v12, v44, v45
    v_cvt_pk_bf16_f32 v13, v46, v47
    buffer_store_dwordx2 v[12:13], v7, s[32:35], s56 offen offset:0 sc1
    s_waitcnt lgkmcnt(2)
    v_add_f32 v48, v48, v136
    v_add_f32 v49, v49, v137
    v_add_f32 v50, v50, v138
    v_add_f32 v51, v51, v139
    v_cvt_pk_bf16_f32 v14, v48, v49
    v_cvt_pk_bf16_f32 v15, v50, v51
    buffer_store_dwordx2 v[14:15], v7, s[32:35], s56 offen offset:128 sc1
    s_waitcnt lgkmcnt(1)
    v_add_f32 v52, v52, v140
    v_add_f32 v53, v53, v141
    v_add_f32 v54, v54, v142
    v_add_f32 v55, v55, v143
    v_cvt_pk_bf16_f32 v16, v52, v53
    v_cvt_pk_bf16_f32 v17, v54, v55
    buffer_store_dwordx2 v[16:17], v7, s[32:35], s56 offen offset:256 sc1
    s_waitcnt lgkmcnt(0)
    v_add_f32 v56, v56, v144
    v_add_f32 v57, v57, v145
    v_add_f32 v58, v58, v146
    v_add_f32 v59, v59, v147
    v_cvt_pk_bf16_f32 v18, v56, v57
    v_cvt_pk_bf16_f32 v19, v58, v59
    buffer_store_dwordx2 v[18:19], v7, s[32:35], s56 offen offset:384 sc1
    s_branch Lmcve_11
Lmcvo_10:
    ds_write_b128 v5, v[132:135] offset:0
    ds_write_b128 v5, v[136:139] offset:1024
    ds_write_b128 v5, v[140:143] offset:2048
    ds_write_b128 v5, v[144:147] offset:3072
    s_waitcnt lgkmcnt(0)
    s_barrier
    ds_read_b128 v[44:47], v6 offset:0
    ds_read_b128 v[48:51], v6 offset:1024
    ds_read_b128 v[52:55], v6 offset:2048
    ds_read_b128 v[56:59], v6 offset:3072
    s_waitcnt lgkmcnt(3)
    v_add_f32 v44, v44, v148
    v_add_f32 v45, v45, v149
    v_add_f32 v46, v46, v150
    v_add_f32 v47, v47, v151
    v_cvt_pk_bf16_f32 v12, v44, v45
    v_cvt_pk_bf16_f32 v13, v46, v47
    buffer_store_dwordx2 v[12:13], v7, s[32:35], s56 offen offset:512 sc1
    s_waitcnt lgkmcnt(2)
    v_add_f32 v48, v48, v152
    v_add_f32 v49, v49, v153
    v_add_f32 v50, v50, v154
    v_add_f32 v51, v51, v155
    v_cvt_pk_bf16_f32 v14, v48, v49
    v_cvt_pk_bf16_f32 v15, v50, v51
    buffer_store_dwordx2 v[14:15], v7, s[32:35], s56 offen offset:640 sc1
    s_waitcnt lgkmcnt(1)
    v_add_f32 v52, v52, v156
    v_add_f32 v53, v53, v157
    v_add_f32 v54, v54, v158
    v_add_f32 v55, v55, v159
    v_cvt_pk_bf16_f32 v16, v52, v53
    v_cvt_pk_bf16_f32 v17, v54, v55
    buffer_store_dwordx2 v[16:17], v7, s[32:35], s56 offen offset:768 sc1
    s_waitcnt lgkmcnt(0)
    v_add_f32 v56, v56, v160
    v_add_f32 v57, v57, v161
    v_add_f32 v58, v58, v162
    v_add_f32 v59, v59, v163
    v_cvt_pk_bf16_f32 v18, v56, v57
    v_cvt_pk_bf16_f32 v19, v58, v59
    buffer_store_dwordx2 v[18:19], v7, s[32:35], s56 offen offset:896 sc1
Lmcve_11:
    s_waitcnt vmcnt(16)
    v_mfma_f32_16x16x32_bf16 v[132:135], a[0:3], v[28:31], 0
    s_lshl_b32 s54, s50, 6
    s_lshl_b32 s55, s44, 4
    s_add_u32 s54, s54, s55
    v_add_u32 v5, s54, v3
    v_lshlrev_b32 v8, 3, v5
    v_lshrrev_b32 v6, 1, v23
    v_xor_b32 v6, v6, v24
    v_add_u32 v5, s54, v23
    v_lshlrev_b32 v5, 10, v5
    v_lshl_add_u32 v5, v6, 4, v5
    v_add_u32 v13, s94, v5
    v_xor_b32 v7, 64, v13
    v_add_u32 v7, 7168, v7
    v_and_b32 v5, 31, v1
    s_lshl_b32 s55, s51, 8
    s_add_u32 s55, s55, 12288
    v_lshl_add_u32 v11, v5, 2, s55
    v_lshlrev_b32 v6, 3, v4
    v_add_u32 v6, s94, v6
    s_lshl_b32 s55, s44, 11
    s_add_u32 s59, s55, 101376
    s_mov_b32 s58, 16384
    v_mfma_f32_16x16x32_bf16 v[148:151], a[4:7], v[28:31], 0
    v_mfma_f32_16x16x32_bf16 v[164:167], a[8:11], v[28:31], 0
    buffer_load_dwordx4 v[120:123], v93, s[32:35], s81 offen sc1
    v_mfma_f32_16x16x32_bf16 v[180:183], a[12:15], v[28:31], 0
    s_waitcnt vmcnt(16)
    v_mfma_f32_16x16x32_bf16 v[136:139], a[0:3], v[32:35], 0
    v_mfma_f32_16x16x32_bf16 v[152:155], a[4:7], v[32:35], 0
    v_mfma_f32_16x16x32_bf16 v[168:171], a[8:11], v[32:35], 0
    buffer_load_dwordx4 v[124:127], v94, s[32:35], s81 offen sc1
    v_mfma_f32_16x16x32_bf16 v[184:187], a[12:15], v[32:35], 0
    s_waitcnt vmcnt(16)
    v_mfma_f32_16x16x32_bf16 v[140:143], a[0:3], v[36:39], 0
    v_mfma_f32_16x16x32_bf16 v[156:159], a[4:7], v[36:39], 0
    v_mfma_f32_16x16x32_bf16 v[172:175], a[8:11], v[36:39], 0
    buffer_load_dwordx4 v[128:131], v95, s[32:35], s81 offen sc1
    v_mfma_f32_16x16x32_bf16 v[188:191], a[12:15], v[36:39], 0
    s_waitcnt vmcnt(16)
    v_mfma_f32_16x16x32_bf16 v[144:147], a[0:3], v[40:43], 0
    v_mfma_f32_16x16x32_bf16 v[160:163], a[4:7], v[40:43], 0
    v_mfma_f32_16x16x32_bf16 v[176:179], a[8:11], v[40:43], 0
    buffer_load_dwordx4 v[204:207], v92, s[32:35], s82 offen sc1
    v_mfma_f32_16x16x32_bf16 v[192:195], a[12:15], v[40:43], 0
    s_waitcnt vmcnt(16)
    v_mfma_f32_16x16x32_bf16 v[132:135], a[16:19], v[76:79], v[132:135]
    v_mfma_f32_16x16x32_bf16 v[148:151], a[20:23], v[76:79], v[148:151]
    v_mfma_f32_16x16x32_bf16 v[164:167], a[24:27], v[76:79], v[164:167]
    buffer_load_dwordx4 v[208:211], v93, s[32:35], s82 offen sc1
    v_mfma_f32_16x16x32_bf16 v[180:183], a[28:31], v[76:79], v[180:183]
    s_waitcnt vmcnt(16)
    v_mfma_f32_16x16x32_bf16 v[136:139], a[16:19], v[80:83], v[136:139]
    v_mfma_f32_16x16x32_bf16 v[152:155], a[20:23], v[80:83], v[152:155]
    v_mfma_f32_16x16x32_bf16 v[168:171], a[24:27], v[80:83], v[168:171]
    buffer_load_dwordx4 v[212:215], v94, s[32:35], s82 offen sc1
    v_mfma_f32_16x16x32_bf16 v[184:187], a[28:31], v[80:83], v[184:187]
    s_waitcnt vmcnt(16)
    v_mfma_f32_16x16x32_bf16 v[140:143], a[16:19], v[84:87], v[140:143]
    v_mfma_f32_16x16x32_bf16 v[156:159], a[20:23], v[84:87], v[156:159]
    v_mfma_f32_16x16x32_bf16 v[172:175], a[24:27], v[84:87], v[172:175]
    buffer_load_dwordx4 v[216:219], v95, s[32:35], s82 offen sc1
    v_mfma_f32_16x16x32_bf16 v[188:191], a[28:31], v[84:87], v[188:191]
    s_waitcnt vmcnt(16)
    v_mfma_f32_16x16x32_bf16 v[144:147], a[16:19], v[88:91], v[144:147]
    v_mfma_f32_16x16x32_bf16 v[160:163], a[20:23], v[88:91], v[160:163]
    v_mfma_f32_16x16x32_bf16 v[176:179], a[24:27], v[88:91], v[176:179]
    buffer_load_dwordx2 v[26:27], v8, s[32:35], s58 offen sc1
    v_mfma_f32_16x16x32_bf16 v[192:195], a[28:31], v[88:91], v[192:195]
    s_waitcnt vmcnt(16)
    v_mfma_f32_16x16x32_bf16 v[132:135], a[32:35], v[100:103], v[132:135]
    v_mfma_f32_16x16x32_bf16 v[148:151], a[36:39], v[100:103], v[148:151]
    v_mfma_f32_16x16x32_bf16 v[164:167], a[40:43], v[100:103], v[164:167]
    s_mov_b32 m0, s59
    s_nop 0
    buffer_load_dwordx4 v13, s[4:7], 0 offen lds
    v_mfma_f32_16x16x32_bf16 v[180:183], a[44:47], v[100:103], v[180:183]
    s_waitcnt vmcnt(16)
    v_mfma_f32_16x16x32_bf16 v[136:139], a[32:35], v[104:107], v[136:139]
    v_mfma_f32_16x16x32_bf16 v[152:155], a[36:39], v[104:107], v[152:155]
    v_mfma_f32_16x16x32_bf16 v[168:171], a[40:43], v[104:107], v[168:171]
    s_mov_b32 m0, s59
    s_nop 0
    buffer_load_dwordx4 v7, s[4:7], 0 offen offset:1024 lds
    v_mfma_f32_16x16x32_bf16 v[184:187], a[44:47], v[104:107], v[184:187]
    s_waitcnt vmcnt(16)
    v_mfma_f32_16x16x32_bf16 v[140:143], a[32:35], v[108:111], v[140:143]
    v_mfma_f32_16x16x32_bf16 v[156:159], a[36:39], v[108:111], v[156:159]
    v_mfma_f32_16x16x32_bf16 v[172:175], a[40:43], v[108:111], v[172:175]
    global_load_dwordx2 v[52:53], v6, s[42:43] offset:0
    global_load_dwordx2 v[54:55], v6, s[42:43] offset:32
    global_load_dwordx2 v[56:57], v6, s[42:43] offset:64
    global_load_dwordx2 v[58:59], v6, s[42:43] offset:96
    v_mfma_f32_16x16x32_bf16 v[188:191], a[44:47], v[108:111], v[188:191]
    s_waitcnt vmcnt(19)
    v_mfma_f32_16x16x32_bf16 v[144:147], a[32:35], v[112:115], v[144:147]
    v_mfma_f32_16x16x32_bf16 v[160:163], a[36:39], v[112:115], v[160:163]
    v_mfma_f32_16x16x32_bf16 v[176:179], a[40:43], v[112:115], v[176:179]
    buffer_load_dwordx4 v[28:31], v92, s[32:35], s83 offen sc1
    v_mfma_f32_16x16x32_bf16 v[192:195], a[44:47], v[112:115], v[192:195]
    s_waitcnt vmcnt(19)
    v_mfma_f32_16x16x32_bf16 v[132:135], a[48:51], v[116:119], v[132:135]
    v_mfma_f32_16x16x32_bf16 v[148:151], a[52:55], v[116:119], v[148:151]
    v_mfma_f32_16x16x32_bf16 v[164:167], a[56:59], v[116:119], v[164:167]
    buffer_load_dwordx4 v[32:35], v93, s[32:35], s83 offen sc1
    v_mfma_f32_16x16x32_bf16 v[180:183], a[60:63], v[116:119], v[180:183]
    s_waitcnt vmcnt(15)
    v_mfma_f32_16x16x32_bf16 v[136:139], a[48:51], v[120:123], v[136:139]
    v_mfma_f32_16x16x32_bf16 v[152:155], a[52:55], v[120:123], v[152:155]
    v_mfma_f32_16x16x32_bf16 v[168:171], a[56:59], v[120:123], v[168:171]
    buffer_load_dwordx4 v[36:39], v94, s[32:35], s83 offen sc1
    v_mfma_f32_16x16x32_bf16 v[184:187], a[60:63], v[120:123], v[184:187]
    s_waitcnt vmcnt(15)
    v_mfma_f32_16x16x32_bf16 v[140:143], a[48:51], v[124:127], v[140:143]
    v_mfma_f32_16x16x32_bf16 v[156:159], a[52:55], v[124:127], v[156:159]
    v_mfma_f32_16x16x32_bf16 v[172:175], a[56:59], v[124:127], v[172:175]
    buffer_load_dwordx4 v[40:43], v95, s[32:35], s83 offen sc1
    v_mfma_f32_16x16x32_bf16 v[188:191], a[60:63], v[124:127], v[188:191]
    s_waitcnt vmcnt(15)
    v_mfma_f32_16x16x32_bf16 v[144:147], a[48:51], v[128:131], v[144:147]
    v_mfma_f32_16x16x32_bf16 v[160:163], a[52:55], v[128:131], v[160:163]
    v_mfma_f32_16x16x32_bf16 v[176:179], a[56:59], v[128:131], v[176:179]
    buffer_load_dwordx4 v[76:79], v92, s[32:35], s84 offen sc1
    v_mfma_f32_16x16x32_bf16 v[192:195], a[60:63], v[128:131], v[192:195]
    s_waitcnt vmcnt(15)
    v_mfma_f32_16x16x32_bf16 v[132:135], a[64:67], v[204:207], v[132:135]
    s_barrier
    s_cmp_eq_u32 s44, 0
    s_cbranch_scc0 Lmfl_12
    s_lshl_b32 s101, s45, 6
    s_add_u32 s101, s101, s46
    s_lshl_b32 s101, s101, 2
    s_add_u32 s101, s101, 12288
    v_mov_b32 v9, s101
    v_mov_b32 v10, s52
    s_mov_b64 exec, 1
    buffer_store_dword v10, v9, s[32:35], 0 offen sc1
    s_mov_b64 exec, -1
Lmfl_12:
    v_mfma_f32_16x16x32_bf16 v[148:151], a[68:71], v[204:207], v[148:151]
    v_mfma_f32_16x16x32_bf16 v[164:167], a[72:75], v[204:207], v[164:167]
    buffer_load_dwordx4 v[80:83], v93, s[32:35], s84 offen sc1
    v_mfma_f32_16x16x32_bf16 v[180:183], a[76:79], v[204:207], v[180:183]
    s_waitcnt vmcnt(15)
    v_mfma_f32_16x16x32_bf16 v[136:139], a[64:67], v[208:211], v[136:139]
    v_mfma_f32_16x16x32_bf16 v[152:155], a[68:71], v[208:211], v[152:155]
    v_mfma_f32_16x16x32_bf16 v[168:171], a[72:75], v[208:211], v[168:171]
    buffer_load_dwordx4 v[84:87], v94, s[32:35], s84 offen sc1
    v_mfma_f32_16x16x32_bf16 v[184:187], a[76:79], v[208:211], v[184:187]
    s_waitcnt vmcnt(15)
    v_mfma_f32_16x16x32_bf16 v[140:143], a[64:67], v[212:215], v[140:143]
    v_mfma_f32_16x16x32_bf16 v[156:159], a[68:71], v[212:215], v[156:159]
    v_mfma_f32_16x16x32_bf16 v[172:175], a[72:75], v[212:215], v[172:175]
    buffer_load_dwordx4 v[88:91], v95, s[32:35], s84 offen sc1
    v_mfma_f32_16x16x32_bf16 v[188:191], a[76:79], v[212:215], v[188:191]
    s_waitcnt vmcnt(15)
    v_mfma_f32_16x16x32_bf16 v[144:147], a[64:67], v[216:219], v[144:147]
    v_mfma_f32_16x16x32_bf16 v[160:163], a[68:71], v[216:219], v[160:163]
    v_mfma_f32_16x16x32_bf16 v[176:179], a[72:75], v[216:219], v[176:179]
    buffer_load_dwordx4 v[100:103], v92, s[32:35], s85 offen sc1
    v_mfma_f32_16x16x32_bf16 v[192:195], a[76:79], v[216:219], v[192:195]
    s_waitcnt vmcnt(8)
    v_mfma_f32_16x16x32_bf16 v[132:135], a[80:83], v[28:31], v[132:135]
    v_mfma_f32_16x16x32_bf16 v[148:151], a[84:87], v[28:31], v[148:151]
    v_mfma_f32_16x16x32_bf16 v[164:167], a[88:91], v[28:31], v[164:167]
    buffer_load_dwordx4 v[104:107], v93, s[32:35], s85 offen sc1
    v_mfma_f32_16x16x32_bf16 v[180:183], a[92:95], v[28:31], v[180:183]
    s_waitcnt vmcnt(8)
    v_mfma_f32_16x16x32_bf16 v[136:139], a[80:83], v[32:35], v[136:139]
    v_mfma_f32_16x16x32_bf16 v[152:155], a[84:87], v[32:35], v[152:155]
    v_mfma_f32_16x16x32_bf16 v[168:171], a[88:91], v[32:35], v[168:171]
    buffer_load_dwordx4 v[108:111], v94, s[32:35], s85 offen sc1
    v_mfma_f32_16x16x32_bf16 v[184:187], a[92:95], v[32:35], v[184:187]
    s_waitcnt vmcnt(8)
    v_mfma_f32_16x16x32_bf16 v[140:143], a[80:83], v[36:39], v[140:143]
    v_mfma_f32_16x16x32_bf16 v[156:159], a[84:87], v[36:39], v[156:159]
    v_mfma_f32_16x16x32_bf16 v[172:175], a[88:91], v[36:39], v[172:175]
    buffer_load_dwordx4 v[112:115], v95, s[32:35], s85 offen sc1
    v_mfma_f32_16x16x32_bf16 v[188:191], a[92:95], v[36:39], v[188:191]
    s_waitcnt vmcnt(8)
    v_mfma_f32_16x16x32_bf16 v[144:147], a[80:83], v[40:43], v[144:147]
    v_mfma_f32_16x16x32_bf16 v[160:163], a[84:87], v[40:43], v[160:163]
    v_mfma_f32_16x16x32_bf16 v[176:179], a[88:91], v[40:43], v[176:179]
    buffer_load_dwordx4 v[116:119], v92, s[32:35], s86 offen sc1
    v_mfma_f32_16x16x32_bf16 v[192:195], a[92:95], v[40:43], v[192:195]
    s_waitcnt vmcnt(8)
    v_mfma_f32_16x16x32_bf16 v[132:135], a[96:99], v[76:79], v[132:135]
    v_mfma_f32_16x16x32_bf16 v[148:151], a[100:103], v[76:79], v[148:151]
    v_mfma_f32_16x16x32_bf16 v[164:167], a[104:107], v[76:79], v[164:167]
    buffer_load_dwordx4 v[120:123], v93, s[32:35], s86 offen sc1
    v_mfma_f32_16x16x32_bf16 v[180:183], a[108:111], v[76:79], v[180:183]
    s_waitcnt vmcnt(8)
    v_mfma_f32_16x16x32_bf16 v[136:139], a[96:99], v[80:83], v[136:139]
    v_mfma_f32_16x16x32_bf16 v[152:155], a[100:103], v[80:83], v[152:155]
    v_mfma_f32_16x16x32_bf16 v[168:171], a[104:107], v[80:83], v[168:171]
    buffer_load_dwordx4 v[124:127], v94, s[32:35], s86 offen sc1
    v_mfma_f32_16x16x32_bf16 v[184:187], a[108:111], v[80:83], v[184:187]
    s_waitcnt vmcnt(8)
    v_mfma_f32_16x16x32_bf16 v[140:143], a[96:99], v[84:87], v[140:143]
    v_mfma_f32_16x16x32_bf16 v[156:159], a[100:103], v[84:87], v[156:159]
    v_mfma_f32_16x16x32_bf16 v[172:175], a[104:107], v[84:87], v[172:175]
    buffer_load_dwordx4 v[128:131], v95, s[32:35], s86 offen sc1
    v_mfma_f32_16x16x32_bf16 v[188:191], a[108:111], v[84:87], v[188:191]
    s_waitcnt vmcnt(8)
    v_mfma_f32_16x16x32_bf16 v[144:147], a[96:99], v[88:91], v[144:147]
    v_mfma_f32_16x16x32_bf16 v[160:163], a[100:103], v[88:91], v[160:163]
    v_mfma_f32_16x16x32_bf16 v[176:179], a[104:107], v[88:91], v[176:179]
    buffer_load_dwordx4 v[204:207], v92, s[32:35], s87 offen sc1
    v_mfma_f32_16x16x32_bf16 v[192:195], a[108:111], v[88:91], v[192:195]
    s_waitcnt vmcnt(8)
    v_mfma_f32_16x16x32_bf16 v[132:135], a[112:115], v[100:103], v[132:135]
    v_mfma_f32_16x16x32_bf16 v[148:151], a[116:119], v[100:103], v[148:151]
    v_mfma_f32_16x16x32_bf16 v[164:167], a[120:123], v[100:103], v[164:167]
    buffer_load_dwordx4 v[208:211], v93, s[32:35], s87 offen sc1
    v_mfma_f32_16x16x32_bf16 v[180:183], a[124:127], v[100:103], v[180:183]
    s_waitcnt vmcnt(8)
    v_mfma_f32_16x16x32_bf16 v[136:139], a[112:115], v[104:107], v[136:139]
    v_mfma_f32_16x16x32_bf16 v[152:155], a[116:119], v[104:107], v[152:155]
    v_mfma_f32_16x16x32_bf16 v[168:171], a[120:123], v[104:107], v[168:171]
    buffer_load_dwordx4 v[212:215], v94, s[32:35], s87 offen sc1
    v_mfma_f32_16x16x32_bf16 v[184:187], a[124:127], v[104:107], v[184:187]
    s_waitcnt vmcnt(8)
    v_mfma_f32_16x16x32_bf16 v[140:143], a[112:115], v[108:111], v[140:143]
    v_mfma_f32_16x16x32_bf16 v[156:159], a[116:119], v[108:111], v[156:159]
    v_mfma_f32_16x16x32_bf16 v[172:175], a[120:123], v[108:111], v[172:175]
    buffer_load_dwordx4 v[216:219], v95, s[32:35], s87 offen sc1
    v_mfma_f32_16x16x32_bf16 v[188:191], a[124:127], v[108:111], v[188:191]
    s_waitcnt vmcnt(8)
    v_mfma_f32_16x16x32_bf16 v[144:147], a[112:115], v[112:115], v[144:147]
    v_mfma_f32_16x16x32_bf16 v[160:163], a[116:119], v[112:115], v[160:163]
    v_mfma_f32_16x16x32_bf16 v[176:179], a[120:123], v[112:115], v[176:179]
    buffer_load_dwordx4 v[28:31], v92, s[32:35], s88 offen sc1
    v_mfma_f32_16x16x32_bf16 v[192:195], a[124:127], v[112:115], v[192:195]
    s_waitcnt vmcnt(8)
    v_mfma_f32_16x16x32_bf16 v[132:135], a[128:131], v[116:119], v[132:135]
    v_lshrrev_b32 v7, 1, v3
    v_lshrrev_b32 v8, 1, v4
    v_xor_b32 v7, v7, v8
    v_lshlrev_b32 v7, 4, v7
    v_and_b32 v8, 1, v4
    v_lshl_add_u32 v7, v8, 3, v7
    v_lshl_add_u32 v22, v3, 7, v7
    v_xor_b32 v7, 0, v22
    v_add_u32 v7, s59, v7
    ds_read_b64 v[14:15], v7
    v_xor_b32 v7, 32, v22
    v_add_u32 v7, s59, v7
    ds_read_b64 v[16:17], v7
    v_xor_b32 v7, 64, v22
    v_add_u32 v7, s59, v7
    ds_read_b64 v[18:19], v7
    v_xor_b32 v7, 96, v22
    v_add_u32 v7, s59, v7
    ds_read_b64 v[20:21], v7
    s_waitcnt lgkmcnt(3)
    v_lshlrev_b32 v60, 16, v14
    v_mfma_f32_16x16x32_bf16 v[148:151], a[132:135], v[116:119], v[148:151]
    v_and_b32 v61, 0xffff0000, v14
    v_lshlrev_b32 v96, 16, v52
    v_mfma_f32_16x16x32_bf16 v[164:167], a[136:139], v[116:119], v[164:167]
    buffer_load_dwordx4 v[32:35], v93, s[32:35], s88 offen sc1
    v_and_b32 v97, 0xffff0000, v52
    v_lshlrev_b32 v62, 16, v15
    v_mfma_f32_16x16x32_bf16 v[180:183], a[140:143], v[116:119], v[180:183]
    v_and_b32 v63, 0xffff0000, v15
    v_lshlrev_b32 v98, 16, v53
    s_waitcnt vmcnt(8)
    v_mfma_f32_16x16x32_bf16 v[136:139], a[128:131], v[120:123], v[136:139]
    v_and_b32 v99, 0xffff0000, v53
    s_waitcnt lgkmcnt(2)
    v_lshlrev_b32 v64, 16, v16
    v_mfma_f32_16x16x32_bf16 v[152:155], a[132:135], v[120:123], v[152:155]
    v_and_b32 v65, 0xffff0000, v16
    v_lshlrev_b32 v196, 16, v54
    v_mfma_f32_16x16x32_bf16 v[168:171], a[136:139], v[120:123], v[168:171]
    buffer_load_dwordx4 v[36:39], v94, s[32:35], s88 offen sc1
    v_and_b32 v197, 0xffff0000, v54
    v_lshlrev_b32 v66, 16, v17
    v_mfma_f32_16x16x32_bf16 v[184:187], a[140:143], v[120:123], v[184:187]
    v_and_b32 v67, 0xffff0000, v17
    v_lshlrev_b32 v198, 16, v55
    s_waitcnt vmcnt(8)
    v_mfma_f32_16x16x32_bf16 v[140:143], a[128:131], v[124:127], v[140:143]
    v_and_b32 v199, 0xffff0000, v55
    s_waitcnt lgkmcnt(1)
    v_lshlrev_b32 v68, 16, v18
    v_mfma_f32_16x16x32_bf16 v[156:159], a[132:135], v[124:127], v[156:159]
    v_and_b32 v69, 0xffff0000, v18
    v_lshlrev_b32 v200, 16, v56
    v_mfma_f32_16x16x32_bf16 v[172:175], a[136:139], v[124:127], v[172:175]
    buffer_load_dwordx4 v[40:43], v95, s[32:35], s88 offen sc1
    v_and_b32 v201, 0xffff0000, v56
    v_lshlrev_b32 v70, 16, v19
    v_mfma_f32_16x16x32_bf16 v[188:191], a[140:143], v[124:127], v[188:191]
    v_and_b32 v71, 0xffff0000, v19
    v_lshlrev_b32 v202, 16, v57
    s_waitcnt vmcnt(8)
    v_mfma_f32_16x16x32_bf16 v[144:147], a[128:131], v[128:131], v[144:147]
    v_and_b32 v203, 0xffff0000, v57
    s_waitcnt lgkmcnt(0)
    v_lshlrev_b32 v72, 16, v20
    v_mfma_f32_16x16x32_bf16 v[160:163], a[132:135], v[128:131], v[160:163]
    v_and_b32 v73, 0xffff0000, v20
    v_lshlrev_b32 v236, 16, v58
    v_mfma_f32_16x16x32_bf16 v[176:179], a[136:139], v[128:131], v[176:179]
    buffer_load_dwordx4 v[76:79], v92, s[32:35], s89 offen sc1
    v_and_b32 v237, 0xffff0000, v58
    v_lshlrev_b32 v74, 16, v21
    v_mfma_f32_16x16x32_bf16 v[192:195], a[140:143], v[128:131], v[192:195]
    v_and_b32 v75, 0xffff0000, v21
    v_lshlrev_b32 v238, 16, v59
    s_waitcnt vmcnt(8)
    v_mfma_f32_16x16x32_bf16 v[132:135], a[144:147], v[204:207], v[132:135]
    v_and_b32 v239, 0xffff0000, v59
    v_sub_f32 v220, v60, v26
    v_mfma_f32_16x16x32_bf16 v[148:151], a[148:151], v[204:207], v[148:151]
    v_mul_f32 v220, v220, v27
    v_sub_f32 v221, v61, v26
    v_mfma_f32_16x16x32_bf16 v[164:167], a[152:155], v[204:207], v[164:167]
    buffer_load_dwordx4 v[80:83], v93, s[32:35], s89 offen sc1
    v_mul_f32 v221, v221, v27
    v_sub_f32 v222, v62, v26
    v_mfma_f32_16x16x32_bf16 v[180:183], a[156:159], v[204:207], v[180:183]
    v_mul_f32 v222, v222, v27
    v_sub_f32 v223, v63, v26
    s_waitcnt vmcnt(8)
    v_mfma_f32_16x16x32_bf16 v[136:139], a[144:147], v[208:211], v[136:139]
    v_mul_f32 v223, v223, v27
    v_sub_f32 v224, v64, v26
    v_mfma_f32_16x16x32_bf16 v[152:155], a[148:151], v[208:211], v[152:155]
    v_mul_f32 v224, v224, v27
    v_sub_f32 v225, v65, v26
    v_mfma_f32_16x16x32_bf16 v[168:171], a[152:155], v[208:211], v[168:171]
    buffer_load_dwordx4 v[84:87], v94, s[32:35], s89 offen sc1
    v_mul_f32 v225, v225, v27
    v_sub_f32 v226, v66, v26
    v_mfma_f32_16x16x32_bf16 v[184:187], a[156:159], v[208:211], v[184:187]
    v_mul_f32 v226, v226, v27
    v_sub_f32 v227, v67, v26
    s_waitcnt vmcnt(8)
    v_mfma_f32_16x16x32_bf16 v[140:143], a[144:147], v[212:215], v[140:143]
    v_mul_f32 v227, v227, v27
    v_sub_f32 v228, v68, v26
    v_mfma_f32_16x16x32_bf16 v[156:159], a[148:151], v[212:215], v[156:159]
    v_mul_f32 v228, v228, v27
    v_sub_f32 v229, v69, v26
    v_mfma_f32_16x16x32_bf16 v[172:175], a[152:155], v[212:215], v[172:175]
    buffer_load_dwordx4 v[88:91], v95, s[32:35], s89 offen sc1
    v_mul_f32 v229, v229, v27
    v_sub_f32 v230, v70, v26
    v_mfma_f32_16x16x32_bf16 v[188:191], a[156:159], v[212:215], v[188:191]
    v_mul_f32 v230, v230, v27
    v_sub_f32 v231, v71, v26
    s_waitcnt vmcnt(8)
    v_mfma_f32_16x16x32_bf16 v[144:147], a[144:147], v[216:219], v[144:147]
    v_mul_f32 v231, v231, v27
    v_sub_f32 v232, v72, v26
    v_mfma_f32_16x16x32_bf16 v[160:163], a[148:151], v[216:219], v[160:163]
    v_mul_f32 v232, v232, v27
    v_sub_f32 v233, v73, v26
    v_mfma_f32_16x16x32_bf16 v[176:179], a[152:155], v[216:219], v[176:179]
    buffer_load_dwordx4 v[100:103], v92, s[32:35], s90 offen sc1
    v_mul_f32 v233, v233, v27
    v_sub_f32 v234, v74, v26
    v_mfma_f32_16x16x32_bf16 v[192:195], a[156:159], v[216:219], v[192:195]
    v_mul_f32 v234, v234, v27
    v_sub_f32 v235, v75, v26
    s_waitcnt vmcnt(8)
    v_mfma_f32_16x16x32_bf16 v[132:135], a[160:163], v[28:31], v[132:135]
    v_mul_f32 v235, v235, v27
    s_lshl_b32 s54, s51, 6
    s_lshl_b32 s55, s44, 4
    s_add_u32 s54, s54, s55
    v_add_u32 v248, s54, v23
    v_lshlrev_b32 v248, 12, v248
    v_lshl_add_u32 v248, v24, 4, v248
    v_add_u32 v249, 0x8000, v248
    s_lshl_b32 s55, s50, 7
    s_add_u32 s58, s55, 2228224
    s_lshl_b32 s55, s44, 4
    v_add_u32 v250, s55, v23
    v_mul_u32_u24 v250, 144, v250
    v_lshl_add_u32 v250, v24, 4, v250
    v_add_u32 v250, 143616, v250
    v_lshrrev_b32 v5, 2, v1
    v_mul_u32_u24 v5, 144, v5
    v_and_b32 v6, 3, v1
    v_lshl_add_u32 v5, v6, 3, v5
    s_lshl_b32 s55, s44, 5
    s_add_u32 s55, s55, 143616
    v_add_u32 v251, s55, v5
    v_mfma_f32_16x16x32_bf16 v[148:151], a[164:167], v[28:31], v[148:151]
    v_mfma_f32_16x16x32_bf16 v[164:167], a[168:171], v[28:31], v[164:167]
    buffer_load_dwordx4 v[104:107], v93, s[32:35], s90 offen sc1
    v_mfma_f32_16x16x32_bf16 v[180:183], a[172:175], v[28:31], v[180:183]
    s_waitcnt vmcnt(8)
    v_mfma_f32_16x16x32_bf16 v[136:139], a[160:163], v[32:35], v[136:139]
    v_mfma_f32_16x16x32_bf16 v[152:155], a[164:167], v[32:35], v[152:155]
    v_mfma_f32_16x16x32_bf16 v[168:171], a[168:171], v[32:35], v[168:171]
    buffer_load_dwordx4 v[108:111], v94, s[32:35], s90 offen sc1
    v_mfma_f32_16x16x32_bf16 v[184:187], a[172:175], v[32:35], v[184:187]
    s_waitcnt vmcnt(8)
    v_mfma_f32_16x16x32_bf16 v[140:143], a[160:163], v[36:39], v[140:143]
    v_mfma_f32_16x16x32_bf16 v[156:159], a[164:167], v[36:39], v[156:159]
    v_mfma_f32_16x16x32_bf16 v[172:175], a[168:171], v[36:39], v[172:175]
    buffer_load_dwordx4 v[112:115], v95, s[32:35], s90 offen sc1
    v_mfma_f32_16x16x32_bf16 v[188:191], a[172:175], v[36:39], v[188:191]
    s_waitcnt vmcnt(8)
    v_mfma_f32_16x16x32_bf16 v[144:147], a[160:163], v[40:43], v[144:147]
    v_mfma_f32_16x16x32_bf16 v[160:163], a[164:167], v[40:43], v[160:163]
    v_mfma_f32_16x16x32_bf16 v[176:179], a[168:171], v[40:43], v[176:179]
    buffer_load_dwordx4 v[116:119], v92, s[32:35], s91 offen sc1
    v_mfma_f32_16x16x32_bf16 v[192:195], a[172:175], v[40:43], v[192:195]
    s_waitcnt vmcnt(8)
    v_mfma_f32_16x16x32_bf16 v[132:135], a[176:179], v[76:79], v[132:135]
    v_mfma_f32_16x16x32_bf16 v[148:151], a[180:183], v[76:79], v[148:151]
    v_mfma_f32_16x16x32_bf16 v[164:167], a[184:187], v[76:79], v[164:167]
    buffer_load_dwordx4 v[120:123], v93, s[32:35], s91 offen sc1
    v_mfma_f32_16x16x32_bf16 v[180:183], a[188:191], v[76:79], v[180:183]
    s_waitcnt vmcnt(8)
    v_mfma_f32_16x16x32_bf16 v[136:139], a[176:179], v[80:83], v[136:139]
    v_mfma_f32_16x16x32_bf16 v[152:155], a[180:183], v[80:83], v[152:155]
    v_mfma_f32_16x16x32_bf16 v[168:171], a[184:187], v[80:83], v[168:171]
    buffer_load_dwordx4 v[124:127], v94, s[32:35], s91 offen sc1
    v_mfma_f32_16x16x32_bf16 v[184:187], a[188:191], v[80:83], v[184:187]
    s_waitcnt vmcnt(8)
    v_mfma_f32_16x16x32_bf16 v[140:143], a[176:179], v[84:87], v[140:143]
    v_mfma_f32_16x16x32_bf16 v[156:159], a[180:183], v[84:87], v[156:159]
    v_mfma_f32_16x16x32_bf16 v[172:175], a[184:187], v[84:87], v[172:175]
    buffer_load_dwordx4 v[128:131], v95, s[32:35], s91 offen sc1
    v_mfma_f32_16x16x32_bf16 v[188:191], a[188:191], v[84:87], v[188:191]
    s_waitcnt vmcnt(8)
    v_mfma_f32_16x16x32_bf16 v[144:147], a[176:179], v[88:91], v[144:147]
    v_mfma_f32_16x16x32_bf16 v[160:163], a[180:183], v[88:91], v[160:163]
    v_mfma_f32_16x16x32_bf16 v[176:179], a[184:187], v[88:91], v[176:179]
    s_cmp_eq_u32 s44, 0
    s_cbranch_scc0 Lmpi_13
    buffer_load_dword v12, v11, s[32:35], 0 offen sc1
Lmpi_13:
    v_mfma_f32_16x16x32_bf16 v[192:195], a[188:191], v[88:91], v[192:195]
    s_waitcnt vmcnt(7)
    v_mfma_f32_16x16x32_bf16 v[132:135], a[192:195], v[100:103], v[132:135]
    v_mfma_f32_16x16x32_bf16 v[148:151], a[196:199], v[100:103], v[148:151]
    v_mfma_f32_16x16x32_bf16 v[164:167], a[200:203], v[100:103], v[164:167]
    v_mfma_f32_16x16x32_bf16 v[180:183], a[204:207], v[100:103], v[180:183]
    s_waitcnt vmcnt(6)
    v_mfma_f32_16x16x32_bf16 v[136:139], a[192:195], v[104:107], v[136:139]
    v_mfma_f32_16x16x32_bf16 v[152:155], a[196:199], v[104:107], v[152:155]
    v_mfma_f32_16x16x32_bf16 v[168:171], a[200:203], v[104:107], v[168:171]
    v_mfma_f32_16x16x32_bf16 v[184:187], a[204:207], v[104:107], v[184:187]
    s_waitcnt vmcnt(5)
    v_mfma_f32_16x16x32_bf16 v[140:143], a[192:195], v[108:111], v[140:143]
    v_mfma_f32_16x16x32_bf16 v[156:159], a[196:199], v[108:111], v[156:159]
    v_mfma_f32_16x16x32_bf16 v[172:175], a[200:203], v[108:111], v[172:175]
    v_mfma_f32_16x16x32_bf16 v[188:191], a[204:207], v[108:111], v[188:191]
    s_waitcnt vmcnt(4)
    v_mfma_f32_16x16x32_bf16 v[144:147], a[192:195], v[112:115], v[144:147]
    v_mfma_f32_16x16x32_bf16 v[160:163], a[196:199], v[112:115], v[160:163]
    v_mfma_f32_16x16x32_bf16 v[176:179], a[200:203], v[112:115], v[176:179]
    v_mfma_f32_16x16x32_bf16 v[192:195], a[204:207], v[112:115], v[192:195]
    s_waitcnt vmcnt(3)
    v_mfma_f32_16x16x32_bf16 v[132:135], a[208:211], v[116:119], v[132:135]
    v_mfma_f32_16x16x32_bf16 v[148:151], a[212:215], v[116:119], v[148:151]
    v_mfma_f32_16x16x32_bf16 v[164:167], a[216:219], v[116:119], v[164:167]
    v_mfma_f32_16x16x32_bf16 v[180:183], a[220:223], v[116:119], v[180:183]
    s_waitcnt vmcnt(2)
    v_mfma_f32_16x16x32_bf16 v[136:139], a[208:211], v[120:123], v[136:139]
    v_mfma_f32_16x16x32_bf16 v[152:155], a[212:215], v[120:123], v[152:155]
    v_mfma_f32_16x16x32_bf16 v[168:171], a[216:219], v[120:123], v[168:171]
    v_mfma_f32_16x16x32_bf16 v[184:187], a[220:223], v[120:123], v[184:187]
    s_waitcnt vmcnt(1)
    v_mfma_f32_16x16x32_bf16 v[140:143], a[208:211], v[124:127], v[140:143]
    v_mfma_f32_16x16x32_bf16 v[156:159], a[212:215], v[124:127], v[156:159]
    v_mfma_f32_16x16x32_bf16 v[172:175], a[216:219], v[124:127], v[172:175]
    v_mfma_f32_16x16x32_bf16 v[188:191], a[220:223], v[124:127], v[188:191]
    s_waitcnt vmcnt(0)
    v_mfma_f32_16x16x32_bf16 v[144:147], a[208:211], v[128:131], v[144:147]
    v_mfma_f32_16x16x32_bf16 v[160:163], a[212:215], v[128:131], v[160:163]
    v_mfma_f32_16x16x32_bf16 v[176:179], a[216:219], v[128:131], v[176:179]
    v_mfma_f32_16x16x32_bf16 v[192:195], a[220:223], v[128:131], v[192:195]
    s_add_u32 s54, s44, 1
    s_and_b32 s54, s54, 3
    s_mul_i32 s54, s54, 12288
    s_add_u32 s54, s54, 0
    v_add_u32 v14, s54, v2
    s_add_u32 s54, s44, 2
    s_and_b32 s54, s54, 3
    s_mul_i32 s54, s54, 12288
    s_add_u32 s54, s54, 4096
    v_add_u32 v15, s54, v2
    s_add_u32 s54, s44, 3
    s_and_b32 s54, s54, 3
    s_mul_i32 s54, s54, 12288
    s_add_u32 s54, s54, 8192
    v_add_u32 v16, s54, v2
    ds_write_b128 v14, v[136:139] offset:0
    ds_write_b128 v14, v[152:155] offset:1024
    ds_write_b128 v14, v[168:171] offset:2048
    ds_write_b128 v14, v[184:187] offset:3072
    ds_write_b128 v15, v[140:143] offset:0
    ds_write_b128 v15, v[156:159] offset:1024
    ds_write_b128 v15, v[172:175] offset:2048
    ds_write_b128 v15, v[188:191] offset:3072
    ds_write_b128 v16, v[144:147] offset:0
    ds_write_b128 v16, v[160:163] offset:1024
    ds_write_b128 v16, v[176:179] offset:2048
    ds_write_b128 v16, v[192:195] offset:3072
    s_mul_i32 s54, s44, 12288
    v_add_u32 v5, s54, v2
    v_add_f32 v26, v132, v96
    v_add_f32 v27, v133, v97
    v_add_f32 v28, v134, v98
    v_add_f32 v29, v135, v99
    v_add_f32 v30, v148, v196
    v_add_f32 v31, v149, v197
    v_add_f32 v32, v150, v198
    v_add_f32 v33, v151, v199
    v_add_f32 v34, v164, v200
    v_add_f32 v35, v165, v201
    v_add_f32 v36, v166, v202
    v_add_f32 v37, v167, v203
    v_add_f32 v38, v180, v236
    v_add_f32 v39, v181, v237
    v_add_f32 v40, v182, v238
    v_add_f32 v41, v183, v239
    s_cmp_eq_u32 s44, 0
    s_cbranch_scc0 Lmpok_14
    v_cmp_eq_u32 vcc, s52, v12
    s_nop 3
    s_cmp_eq_u64 vcc, exec
    s_cbranch_scc1 Lmpok_14
    s_mov_b32 s62, 0x20000
Lmprt_15:
    s_sleep 8
    buffer_load_dword v12, v11, s[32:35], 0 offen sc1
    s_waitcnt vmcnt(0)
    v_cmp_eq_u32 vcc, s52, v12
    s_nop 3
    s_cmp_eq_u64 vcc, exec
    s_cbranch_scc1 Lmpok_14
    s_sub_u32 s62, s62, 1
    s_cmp_lg_u32 s62, 0
    s_cbranch_scc1 Lmprt_15
Lmpok_14:
    s_waitcnt lgkmcnt(0)
    s_barrier
    buffer_load_dwordx4 v[44:47], v248, s[32:35], s58 offen sc1
    buffer_load_dwordx4 v[48:51], v249, s[32:35], s58 offen sc1
    ds_read_b128 v[136:139], v5 offset:0
    ds_read_b128 v[140:143], v5 offset:4096
    ds_read_b128 v[144:147], v5 offset:8192
    ds_read_b128 v[152:155], v5 offset:1024
    ds_read_b128 v[156:159], v5 offset:5120
    ds_read_b128 v[160:163], v5 offset:9216
    ds_read_b128 v[168:171], v5 offset:2048
    ds_read_b128 v[172:175], v5 offset:6144
    ds_read_b128 v[176:179], v5 offset:10240
    ds_read_b128 v[184:187], v5 offset:3072
    ds_read_b128 v[188:191], v5 offset:7168
    ds_read_b128 v[192:195], v5 offset:11264
    s_mov_b32 s56, 0xbfb8aa3b
    s_mov_b32 s57, 0xbfb8aa3b
    s_waitcnt lgkmcnt(10)
    v_pk_add_f32 v[136:137], v[136:137], v[140:141]
    s_waitcnt lgkmcnt(9)
    v_pk_add_f32 v[26:27], v[26:27], v[144:145]
    v_pk_add_f32 v[26:27], v[26:27], v[136:137]
    v_pk_add_f32 v[138:139], v[138:139], v[142:143]
    v_pk_add_f32 v[28:29], v[28:29], v[146:147]
    v_pk_add_f32 v[28:29], v[28:29], v[138:139]
    v_pk_mul_f32 v[76:77], v[26:27], s[56:57]
    v_pk_mul_f32 v[78:79], v[28:29], s[56:57]
    v_exp_f32 v76, v76
    v_exp_f32 v77, v77
    v_exp_f32 v78, v78
    v_exp_f32 v79, v79
    v_mul_f32 v26, v26, v220
    v_mul_f32 v27, v27, v221
    v_mul_f32 v28, v28, v222
    v_mul_f32 v29, v29, v223
    v_add_f32 v76, 1.0, v76
    v_add_f32 v77, 1.0, v77
    v_add_f32 v78, 1.0, v78
    v_add_f32 v79, 1.0, v79
    v_rcp_f32 v76, v76
    v_rcp_f32 v77, v77
    v_rcp_f32 v78, v78
    v_rcp_f32 v79, v79
    s_waitcnt lgkmcnt(7)
    v_pk_add_f32 v[152:153], v[152:153], v[156:157]
    s_waitcnt lgkmcnt(6)
    v_pk_add_f32 v[30:31], v[30:31], v[160:161]
    v_pk_add_f32 v[30:31], v[30:31], v[152:153]
    v_pk_add_f32 v[154:155], v[154:155], v[158:159]
    v_pk_add_f32 v[32:33], v[32:33], v[162:163]
    v_pk_add_f32 v[32:33], v[32:33], v[154:155]
    v_pk_mul_f32 v[80:81], v[30:31], s[56:57]
    v_pk_mul_f32 v[82:83], v[32:33], s[56:57]
    v_exp_f32 v80, v80
    v_exp_f32 v81, v81
    v_exp_f32 v82, v82
    v_exp_f32 v83, v83
    v_mul_f32 v30, v30, v224
    v_mul_f32 v31, v31, v225
    v_mul_f32 v32, v32, v226
    v_mul_f32 v33, v33, v227
    v_add_f32 v80, 1.0, v80
    v_add_f32 v81, 1.0, v81
    v_add_f32 v82, 1.0, v82
    v_add_f32 v83, 1.0, v83
    v_rcp_f32 v80, v80
    v_rcp_f32 v81, v81
    v_rcp_f32 v82, v82
    v_rcp_f32 v83, v83
    s_waitcnt lgkmcnt(4)
    v_pk_add_f32 v[168:169], v[168:169], v[172:173]
    s_waitcnt lgkmcnt(3)
    v_pk_add_f32 v[34:35], v[34:35], v[176:177]
    v_pk_add_f32 v[34:35], v[34:35], v[168:169]
    v_pk_add_f32 v[170:171], v[170:171], v[174:175]
    v_pk_add_f32 v[36:37], v[36:37], v[178:179]
    v_pk_add_f32 v[36:37], v[36:37], v[170:171]
    v_pk_mul_f32 v[84:85], v[34:35], s[56:57]
    v_pk_mul_f32 v[86:87], v[36:37], s[56:57]
    v_exp_f32 v84, v84
    v_exp_f32 v85, v85
    v_exp_f32 v86, v86
    v_exp_f32 v87, v87
    v_mul_f32 v34, v34, v228
    v_mul_f32 v35, v35, v229
    v_mul_f32 v36, v36, v230
    v_mul_f32 v37, v37, v231
    v_add_f32 v84, 1.0, v84
    v_add_f32 v85, 1.0, v85
    v_add_f32 v86, 1.0, v86
    v_add_f32 v87, 1.0, v87
    v_rcp_f32 v84, v84
    v_rcp_f32 v85, v85
    v_rcp_f32 v86, v86
    v_rcp_f32 v87, v87
    s_waitcnt lgkmcnt(1)
    v_pk_add_f32 v[184:185], v[184:185], v[188:189]
    s_waitcnt lgkmcnt(0)
    v_pk_add_f32 v[38:39], v[38:39], v[192:193]
    v_pk_add_f32 v[38:39], v[38:39], v[184:185]
    v_pk_add_f32 v[186:187], v[186:187], v[190:191]
    v_pk_add_f32 v[40:41], v[40:41], v[194:195]
    v_pk_add_f32 v[40:41], v[40:41], v[186:187]
    v_pk_mul_f32 v[88:89], v[38:39], s[56:57]
    v_pk_mul_f32 v[90:91], v[40:41], s[56:57]
    v_exp_f32 v88, v88
    v_exp_f32 v89, v89
    v_exp_f32 v90, v90
    v_exp_f32 v91, v91
    v_mul_f32 v38, v38, v232
    v_mul_f32 v39, v39, v233
    v_mul_f32 v40, v40, v234
    v_mul_f32 v41, v41, v235
    v_add_f32 v88, 1.0, v88
    v_add_f32 v89, 1.0, v89
    v_add_f32 v90, 1.0, v90
    v_add_f32 v91, 1.0, v91
    v_rcp_f32 v88, v88
    v_rcp_f32 v89, v89
    v_rcp_f32 v90, v90
    v_rcp_f32 v91, v91
    v_mul_f32 v26, v26, v76
    v_mul_f32 v27, v27, v77
    v_mul_f32 v28, v28, v78
    v_mul_f32 v29, v29, v79
    v_mul_f32 v30, v30, v80
    v_mul_f32 v31, v31, v81
    v_mul_f32 v32, v32, v82
    v_mul_f32 v33, v33, v83
    v_mul_f32 v34, v34, v84
    v_mul_f32 v35, v35, v85
    v_mul_f32 v36, v36, v86
    v_mul_f32 v37, v37, v87
    v_mul_f32 v38, v38, v88
    v_mul_f32 v39, v39, v89
    v_mul_f32 v40, v40, v90
    v_mul_f32 v41, v41, v91
    s_waitcnt vmcnt(1)
    ds_write_b128 v250, v[44:47]
    s_waitcnt vmcnt(0)
    ds_write_b128 v250, v[48:51] offset:1152
    s_waitcnt lgkmcnt(0)
    s_barrier
    ds_read_b64_tr_b16 v[240:241], v251 offset:0
    ds_read_b64_tr_b16 v[242:243], v251 offset:2304
    ds_read_b64_tr_b16 v[244:245], v251 offset:4608
    ds_read_b64_tr_b16 v[246:247], v251 offset:6912
    s_lshl_b32 s55, s44, 11
    s_add_u32 s56, s55, 135168
    s_waitcnt lgkmcnt(3)
    v_lshlrev_b32 v76, 16, v240
    v_and_b32 v77, 0xffff0000, v240
    v_lshlrev_b32 v78, 16, v241
    v_and_b32 v79, 0xffff0000, v241
    v_fma_f32 v26, v26, v76, v60
    v_fma_f32 v27, v27, v77, v61
    v_fma_f32 v28, v28, v78, v62
    v_fma_f32 v29, v29, v79, v63
    v_cvt_pk_bf16_f32 v52, v26, v27
    v_cvt_pk_bf16_f32 v53, v28, v29
    v_xor_b32 v5, 0, v22
    v_add_u32 v5, s56, v5
    ds_write_b64 v5, v[52:53]
    s_waitcnt lgkmcnt(3)
    v_lshlrev_b32 v80, 16, v242
    v_and_b32 v81, 0xffff0000, v242
    v_lshlrev_b32 v82, 16, v243
    v_and_b32 v83, 0xffff0000, v243
    v_fma_f32 v30, v30, v80, v64
    v_fma_f32 v31, v31, v81, v65
    v_fma_f32 v32, v32, v82, v66
    v_fma_f32 v33, v33, v83, v67
    v_cvt_pk_bf16_f32 v54, v30, v31
    v_cvt_pk_bf16_f32 v55, v32, v33
    v_xor_b32 v5, 32, v22
    v_add_u32 v5, s56, v5
    ds_write_b64 v5, v[54:55]
    s_waitcnt lgkmcnt(3)
    v_lshlrev_b32 v84, 16, v244
    v_and_b32 v85, 0xffff0000, v244
    v_lshlrev_b32 v86, 16, v245
    v_and_b32 v87, 0xffff0000, v245
    v_fma_f32 v34, v34, v84, v68
    v_fma_f32 v35, v35, v85, v69
    v_fma_f32 v36, v36, v86, v70
    v_fma_f32 v37, v37, v87, v71
    v_cvt_pk_bf16_f32 v56, v34, v35
    v_cvt_pk_bf16_f32 v57, v36, v37
    v_xor_b32 v5, 64, v22
    v_add_u32 v5, s56, v5
    ds_write_b64 v5, v[56:57]
    s_waitcnt lgkmcnt(3)
    v_lshlrev_b32 v88, 16, v246
    v_and_b32 v89, 0xffff0000, v246
    v_lshlrev_b32 v90, 16, v247
    v_and_b32 v91, 0xffff0000, v247
    v_fma_f32 v38, v38, v88, v72
    v_fma_f32 v39, v39, v89, v73
    v_fma_f32 v40, v40, v90, v74
    v_fma_f32 v41, v41, v91, v75
    v_cvt_pk_bf16_f32 v58, v38, v39
    v_cvt_pk_bf16_f32 v59, v40, v41
    v_xor_b32 v5, 96, v22
    v_add_u32 v5, s56, v5
    ds_write_b64 v5, v[58:59]
    v_add_u32 v6, s56, v2
    s_waitcnt lgkmcnt(0)
    ds_read_b128 v[76:79], v6
    ds_read_b128 v[80:83], v6 offset:1024
    s_waitcnt lgkmcnt(1)
    buffer_store_dwordx4 v[76:79], v13, s[28:31], 0 offen
    v_xor_b32 v5, 64, v13
    s_movk_i32 s57, 0x2000
    s_waitcnt lgkmcnt(0)
    buffer_store_dwordx4 v[80:83], v5, s[28:31], s57 offen
    s_endpgm
Lidle:
    s_load_dwordx16 s[64:79], s[0:1], 0
    s_load_dwordx8 s[80:87], s[0:1], 64
    s_load_dwordx4 s[88:91], s[0:1], 96
    s_mov_b32 s92, s2
    v_and_b32 v1, 63, v0
    v_lshrrev_b32 v5, 6, v0
    v_lshlrev_b32 v2, 4, v1
    v_readfirstlane_b32 s44, v5
    s_and_b32 s45, s2, 7
    s_lshr_b32 s46, s2, 3
    s_lshr_b32 s54, s45, 1
    s_lshr_b32 s55, s46, 3
    s_lshl_b32 s47, s54, 2
    s_add_u32 s47, s47, s55
    s_and_b32 s51, s46, 7
    s_and_b32 s56, s45, 1
    s_mul_i32 s48, s56, 7
    s_add_u32 s48, s48, s51
    s_lshl_b32 s50, s47, 1
    s_add_u32 s50, s50, s56
    s_lshl_b32 s49, s55, 1
    s_add_u32 s49, s49, s51
    s_add_u32 s49, s49, s54
    s_and_b32 s49, s49, 7
    s_lshl_b32 s93, s44, 12
    s_lshl_b32 s94, s51, 7
    s_mul_i32 s55, s55, 3
    s_add_u32 s54, s54, s55
    s_lshl_b32 s55, s51, 1
    s_add_u32 s54, s54, s55
    s_cmp_ge_u32 s54, 14
    s_cselect_b32 s55, 14, 0
    s_sub_u32 s63, s54, s55
    v_and_b32 v3, 15, v1
    v_lshrrev_b32 v4, 4, v1
    v_lshrrev_b32 v23, 3, v1
    v_and_b32 v24, 7, v1
    v_lshlrev_b32 v5, 10, v23
    v_lshl_add_u32 v25, v24, 4, v5
    s_lshr_b32 s54, s44, 1
    s_lshl_b32 s3, s45, 6
    s_lshl_b32 s55, s46, 1
    s_add_u32 s3, s3, s55
    s_add_u32 s3, s3, s54
    s_lshl_b32 s56, s44, 3
    v_add_u32 v26, s56, v23
    v_lshrrev_b32 v6, 2, v26
    v_and_b32 v7, 3, v26
    v_lshlrev_b32 v7, 2, v7
    v_xor_b32 v8, v6, v24
    v_lshl_add_u32 v8, v8, 4, v7
    v_lshl_add_u32 v8, v24, 10, v8
    v_add_u32 v27, 143616, v8
    v_add_u32 v33, 152832, v8
    v_add_u32 v32, 1, v24
    v_and_b32 v8, 7, v32
    v_xor_b32 v8, v6, v8
    v_lshl_add_u32 v8, v8, 4, v7
    v_lshl_add_u32 v8, v32, 10, v8
    v_add_u32 v32, 143616, v8
    s_lshl_b32 s54, s45, 6
    v_lshl_add_u32 v6, v26, 1, s54
    s_movk_i32 s55, 4224
    v_mul_u32_u24 v6, s55, v6
    v_lshlrev_b32 v7, 4, v24
    v_sub_u32 v7, 4080, v7
    v_add_u32 v34, v6, v7
    v_mov_b32 v36, 0
    v_mov_b32 v37, 0
    v_mov_b32 v38, 0
    v_mov_b32 v39, 0
    v_lshlrev_b32 v5, 4, v24
    s_lshr_b32 s54, s44, 1
    s_mul_i32 s54, s54, 4224
    s_add_u32 s54, s54, 135168
    v_add_u32 v5, s54, v5
    ds_write_b128 v5, v[36:39]
    s_waitcnt lgkmcnt(0)
    s_mov_b32 s4, s64
    s_and_b32 s5, s65, 0xffff
    s_mov_b32 s6, 2097152
    s_mov_b32 s7, 0x00020000
    s_mov_b32 s8, s66
    s_and_b32 s9, s67, 0xffff
    s_mov_b32 s10, 2097152
    s_mov_b32 s11, 0x00020000
    s_mov_b32 s12, s68
    s_and_b32 s13, s69, 0xffff
    s_mov_b32 s14, 2097152
    s_mov_b32 s15, 0x00020000
    s_getpc_b64 s[56:57]
Lipc_1:
    s_add_u32 s56, s56, Kstart-Lipc_1
    s_addc_u32 s57, s57, -1
    s_lshl_b32 s54, s46, 2
    s_add_u32 s54, s54, s44
    s_lshl_b32 s54, s54, 10
    s_cmp_le_u32 s54, Lend-Kstart-1024
    s_cselect_b32 s54, s54, 0
    v_add_u32 v36, s54, v2
    global_load_dwordx4 v[40:43], v36, s[56:57]
    s_lshl_b32 s56, s92, 3
    s_lshl_b32 s57, s44, 1
    s_add_u32 s53, s56, s57
    s_lshl_b32 s57, s53, 10
    buffer_load_dwordx4 v[44:47], v2, s[4:7], s57 offen
    buffer_load_dwordx4 v[48:51], v2, s[4:7], s57 offen offset:1024
    s_lshl_b32 s54, s46, 16
    s_lshl_b32 s55, s45, 7
    s_add_u32 s54, s54, s55
    s_lshl_b32 s55, s44, 1
    s_add_u32 s56, s55, 0
    s_add_u32 s57, s56, 1
    s_and_b32 s58, s57, 7
    s_lshl_b32 s58, s58, 4
    v_xor_b32 v5, s58, v25
    s_lshl_b32 s57, s57, 10
    s_add_u32 m0, s57, 143616
    s_lshl_b32 s59, s56, 13
    s_add_u32 s59, s59, s54
    buffer_load_dwordx4 v5, s[8:11], s59 offen lds
    s_lshl_b32 s58, s56, 4
    v_xor_b32 v6, s58, v25
    s_lshl_b32 s57, s56, 10
    s_add_u32 m0, s57, 152832
    s_nop 0
    buffer_load_dwordx4 v6, s[12:15], s59 offen lds
    s_add_u32 s56, s55, 1
    s_add_u32 s57, s56, 1
    s_and_b32 s58, s57, 7
    s_lshl_b32 s58, s58, 4
    v_xor_b32 v5, s58, v25
    s_lshl_b32 s57, s57, 10
    s_add_u32 m0, s57, 143616
    s_lshl_b32 s59, s56, 13
    s_add_u32 s59, s59, s54
    buffer_load_dwordx4 v5, s[8:11], s59 offen lds
    s_lshl_b32 s58, s56, 4
    v_xor_b32 v6, s58, v25
    s_lshl_b32 s57, s56, 10
    s_add_u32 m0, s57, 152832
    s_nop 0
    buffer_load_dwordx4 v6, s[12:15], s59 offen lds
    s_lshl_b32 s56, s44, 11
    s_add_u32 s56, s56, s54
    s_sub_u32 s56, s56, 8192
    v_add_u32 v7, s56, v25
    s_lshl_b32 s57, s44, 8
    s_add_u32 m0, s57, 143616
    s_mov_b64 exec, 0xffff
    buffer_load_dwordx4 v7, s[8:11], 0 offen lds
    s_mov_b64 exec, -1
    s_mov_b64 s[36:37], s[70:71]
    s_lshl_b32 s57, s45, 9
    v_lshlrev_b32 v8, 4, v26
    v_add_u32 v8, s57, v8
    global_load_dwordx4 v[28:31], v8, s[36:37]
    s_mov_b32 s20, s78
    s_and_b32 s21, s79, 0xffff
    s_mov_b32 s22, 1835008
    s_mov_b32 s23, 0x00020000
    s_mov_b32 s16, s72
    s_and_b32 s17, s73, 0xffff
    s_mov_b32 s18, 2097152
    s_mov_b32 s19, 0x00020000
    s_mov_b32 s32, s90
    s_and_b32 s33, s91, 0xffff
    s_mov_b32 s34, 12058624
    s_mov_b32 s35, 0x00020000
    s_mov_b32 s24, s82
    s_and_b32 s25, s83, 0xffff
    s_mov_b32 s26, 1835008
    s_mov_b32 s27, 0x00020000
    s_mov_b32 s28, s86
    s_and_b32 s29, s87, 0xffff
    s_mov_b32 s30, 2097152
    s_mov_b32 s31, 0x00020000
    s_mov_b64 s[38:39], s[74:75]
    s_mov_b64 s[40:41], s[80:81]
    s_mov_b64 s[42:43], s[84:85]
    v_mov_b32 v5, 0
    buffer_load_dword v35, v5, s[32:35], 0 offen sc1
    s_waitcnt vmcnt(8)
    v_lshlrev_b32 v60, 16, v44
    v_and_b32 v61, 0xffff0000, v44
    v_lshlrev_b32 v62, 16, v45
    v_and_b32 v63, 0xffff0000, v45
    v_lshlrev_b32 v64, 16, v46
    v_and_b32 v65, 0xffff0000, v46
    v_lshlrev_b32 v66, 16, v47
    v_and_b32 v67, 0xffff0000, v47
    s_waitcnt vmcnt(7)
    v_lshlrev_b32 v68, 16, v48
    v_and_b32 v69, 0xffff0000, v48
    v_lshlrev_b32 v70, 16, v49
    v_and_b32 v71, 0xffff0000, v49
    v_lshlrev_b32 v72, 16, v50
    v_and_b32 v73, 0xffff0000, v50
    v_lshlrev_b32 v74, 16, v51
    v_and_b32 v75, 0xffff0000, v51
    v_add_f32 v76, v60, v61
    v_add_f32 v77, v68, v69
    v_add_f32 v76, v76, v62
    v_add_f32 v77, v77, v70
    v_add_f32 v76, v76, v63
    v_add_f32 v77, v77, v71
    v_add_f32 v76, v76, v64
    v_add_f32 v77, v77, v72
    v_add_f32 v76, v76, v65
    v_add_f32 v77, v77, v73
    v_add_f32 v76, v76, v66
    v_add_f32 v77, v77, v74
    v_add_f32 v76, v76, v67
    v_add_f32 v77, v77, v75
    s_nop 0
    v_add_f32_dpp v76, v76, v76 row_shr:1 row_mask:0xf bank_mask:0xf bound_ctrl:0
    v_add_f32_dpp v77, v77, v77 row_shr:1 row_mask:0xf bank_mask:0xf bound_ctrl:0
    s_nop 0
    v_add_f32_dpp v76, v76, v76 row_shr:2 row_mask:0xf bank_mask:0xf bound_ctrl:0
    v_add_f32_dpp v77, v77, v77 row_shr:2 row_mask:0xf bank_mask:0xf bound_ctrl:0
    s_nop 0
    v_add_f32_dpp v76, v76, v76 row_shr:4 row_mask:0xf bank_mask:0xf bound_ctrl:0
    v_add_f32_dpp v77, v77, v77 row_shr:4 row_mask:0xf bank_mask:0xf bound_ctrl:0
    s_nop 0
    v_add_f32_dpp v76, v76, v76 row_shr:8 row_mask:0xf bank_mask:0xf bound_ctrl:0
    v_add_f32_dpp v77, v77, v77 row_shr:8 row_mask:0xf bank_mask:0xf bound_ctrl:0
    s_nop 0
    v_add_f32_dpp v76, v76, v76 row_bcast:15 row_mask:0xa bank_mask:0xf
    v_add_f32_dpp v77, v77, v77 row_bcast:15 row_mask:0xa bank_mask:0xf
    s_nop 0
    v_add_f32_dpp v76, v76, v76 row_bcast:31 row_mask:0xc bank_mask:0xf
    v_add_f32_dpp v77, v77, v77 row_bcast:31 row_mask:0xc bank_mask:0xf
    v_readlane_b32 s54, v76, 63
    v_readlane_b32 s55, v77, 63
    v_mov_b32 v5, 0x3b000000
    v_mul_f32 v80, s54, v5
    v_mul_f32 v82, s55, v5
    v_sub_f32 v60, v60, v80
    v_sub_f32 v61, v61, v80
    v_sub_f32 v62, v62, v80
    v_sub_f32 v63, v63, v80
    v_sub_f32 v64, v64, v80
    v_sub_f32 v65, v65, v80
    v_sub_f32 v66, v66, v80
    v_sub_f32 v67, v67, v80
    v_sub_f32 v68, v68, v82
    v_sub_f32 v69, v69, v82
    v_sub_f32 v70, v70, v82
    v_sub_f32 v71, v71, v82
    v_sub_f32 v72, v72, v82
    v_sub_f32 v73, v73, v82
    v_sub_f32 v74, v74, v82
    v_sub_f32 v75, v75, v82
    v_mul_f32 v76, v60, v60
    v_mul_f32 v77, v68, v68
    v_fmac_f32 v76, v61, v61
    v_fmac_f32 v77, v69, v69
    v_fmac_f32 v76, v62, v62
    v_fmac_f32 v77, v70, v70
    v_fmac_f32 v76, v63, v63
    v_fmac_f32 v77, v71, v71
    v_fmac_f32 v76, v64, v64
    v_fmac_f32 v77, v72, v72
    v_fmac_f32 v76, v65, v65
    v_fmac_f32 v77, v73, v73
    v_fmac_f32 v76, v66, v66
    v_fmac_f32 v77, v74, v74
    v_fmac_f32 v76, v67, v67
    v_fmac_f32 v77, v75, v75
    s_nop 0
    v_add_f32_dpp v76, v76, v76 row_shr:1 row_mask:0xf bank_mask:0xf bound_ctrl:0
    v_add_f32_dpp v77, v77, v77 row_shr:1 row_mask:0xf bank_mask:0xf bound_ctrl:0
    s_nop 0
    v_add_f32_dpp v76, v76, v76 row_shr:2 row_mask:0xf bank_mask:0xf bound_ctrl:0
    v_add_f32_dpp v77, v77, v77 row_shr:2 row_mask:0xf bank_mask:0xf bound_ctrl:0
    s_nop 0
    v_add_f32_dpp v76, v76, v76 row_shr:4 row_mask:0xf bank_mask:0xf bound_ctrl:0
    v_add_f32_dpp v77, v77, v77 row_shr:4 row_mask:0xf bank_mask:0xf bound_ctrl:0
    s_nop 0
    v_add_f32_dpp v76, v76, v76 row_shr:8 row_mask:0xf bank_mask:0xf bound_ctrl:0
    v_add_f32_dpp v77, v77, v77 row_shr:8 row_mask:0xf bank_mask:0xf bound_ctrl:0
    s_nop 0
    v_add_f32_dpp v76, v76, v76 row_bcast:15 row_mask:0xa bank_mask:0xf
    v_add_f32_dpp v77, v77, v77 row_bcast:15 row_mask:0xa bank_mask:0xf
    s_nop 0
    v_add_f32_dpp v76, v76, v76 row_bcast:31 row_mask:0xc bank_mask:0xf
    v_add_f32_dpp v77, v77, v77 row_bcast:31 row_mask:0xc bank_mask:0xf
    v_readlane_b32 s54, v76, 63
    v_readlane_b32 s55, v77, 63
    s_nop 0
    v_mul_f32 v81, s54, v5
    v_mul_f32 v83, s55, v5
    v_cvt_pk_bf16_f32 v80, v80, v80
    v_and_b32 v80, 0xffff0000, v80
    v_cvt_pk_bf16_f32 v82, v82, v82
    v_and_b32 v82, 0xffff0000, v82
    v_cvt_pk_bf16_f32 v81, v81, v81
    v_and_b32 v81, 0xffff0000, v81
    v_cvt_pk_bf16_f32 v83, v83, v83
    v_and_b32 v83, 0xffff0000, v83
    v_add_f32 v81, 0x3727c5ac, v81
    v_add_f32 v83, 0x3727c5ac, v83
    v_cvt_pk_bf16_f32 v81, v81, v81
    v_and_b32 v81, 0xffff0000, v81
    v_cvt_pk_bf16_f32 v83, v83, v83
    v_and_b32 v83, 0xffff0000, v83
    v_sqrt_f32 v81, v81
    v_sqrt_f32 v83, v83
    v_cvt_pk_bf16_f32 v81, v81, v81
    v_and_b32 v81, 0xffff0000, v81
    v_cvt_pk_bf16_f32 v83, v83, v83
    v_and_b32 v83, 0xffff0000, v83
    v_rcp_f32 v81, v81
    v_rcp_f32 v83, v83
    s_lshl_b32 s54, s53, 3
    s_add_u32 s54, s54, 16384
    v_mov_b32 v6, s54
    s_mov_b64 exec, 1
    buffer_store_dwordx4 v[80:83], v6, s[32:35], 0 offen sc1
    s_mov_b64 exec, -1
    s_nop 1
    s_waitcnt vmcnt(3)
    s_waitcnt lgkmcnt(0)
    s_barrier
    ds_read_b32 v60, v27 offset:640
    ds_read_b32 v61, v27 offset:768
    ds_read_b32 v62, v27 offset:896
    ds_read_b32 v63, v32 offset:0
    ds_read_b32 v64, v32 offset:128
    ds_read_b32 v65, v32 offset:256
    ds_read_b32 v66, v32 offset:384
    ds_read_b32 v67, v32 offset:512
    ds_read_b32 v68, v32 offset:640
    ds_read_b32 v69, v32 offset:768
    ds_read_b32 v70, v32 offset:896
    ds_read_b32 v44, v33 offset:0
    ds_read_b32 v45, v33 offset:128
    ds_read_b32 v46, v33 offset:256
    ds_read_b32 v47, v33 offset:384
    ds_read_b32 v48, v33 offset:512
    ds_read_b32 v49, v33 offset:640
    ds_read_b32 v50, v33 offset:768
    ds_read_b32 v51, v33 offset:896
    s_waitcnt vmcnt(2)
    v_lshlrev_b32 v72, 16, v28
    v_lshlrev_b32 v73, 16, v30
    v_and_b32 v74, 0xffff0000, v28
    v_and_b32 v75, 0xffff0000, v30
    v_lshlrev_b32 v76, 16, v29
    v_lshlrev_b32 v77, 16, v31
    v_and_b32 v78, 0xffff0000, v29
    v_and_b32 v79, 0xffff0000, v31
    s_waitcnt lgkmcnt(15)
    v_lshlrev_b32 v80, 16, v60
    v_and_b32 v81, 0xffff0000, v60
    v_lshlrev_b32 v82, 16, v61
    v_and_b32 v83, 0xffff0000, v61
    v_lshlrev_b32 v84, 16, v62
    v_and_b32 v85, 0xffff0000, v62
    v_lshlrev_b32 v86, 16, v63
    v_and_b32 v87, 0xffff0000, v63
    s_waitcnt lgkmcnt(14)
    v_lshlrev_b32 v88, 16, v64
    v_and_b32 v89, 0xffff0000, v64
    s_waitcnt lgkmcnt(13)
    v_lshlrev_b32 v90, 16, v65
    v_and_b32 v91, 0xffff0000, v65
    s_waitcnt lgkmcnt(12)
    v_lshlrev_b32 v92, 16, v66
    v_and_b32 v93, 0xffff0000, v66
    s_waitcnt lgkmcnt(11)
    v_lshlrev_b32 v94, 16, v67
    v_and_b32 v95, 0xffff0000, v67
    s_waitcnt lgkmcnt(10)
    v_lshlrev_b32 v96, 16, v68
    v_and_b32 v97, 0xffff0000, v68
    s_waitcnt lgkmcnt(9)
    v_lshlrev_b32 v98, 16, v69
    v_and_b32 v99, 0xffff0000, v69
    s_waitcnt lgkmcnt(8)
    v_lshlrev_b32 v100, 16, v70
    v_and_b32 v101, 0xffff0000, v70
    s_waitcnt lgkmcnt(7)
    v_lshlrev_b32 v102, 16, v44
    v_and_b32 v103, 0xffff0000, v44
    s_waitcnt lgkmcnt(6)
    v_lshlrev_b32 v104, 16, v45
    v_and_b32 v105, 0xffff0000, v45
    s_waitcnt lgkmcnt(5)
    v_lshlrev_b32 v106, 16, v46
    v_and_b32 v107, 0xffff0000, v46
    s_waitcnt lgkmcnt(4)
    v_lshlrev_b32 v108, 16, v47
    v_and_b32 v109, 0xffff0000, v47
    s_waitcnt lgkmcnt(3)
    v_lshlrev_b32 v110, 16, v48
    v_and_b32 v111, 0xffff0000, v48
    s_waitcnt lgkmcnt(2)
    v_lshlrev_b32 v112, 16, v49
    v_and_b32 v113, 0xffff0000, v49
    s_waitcnt lgkmcnt(1)
    v_lshlrev_b32 v114, 16, v50
    v_and_b32 v115, 0xffff0000, v50
    s_waitcnt lgkmcnt(0)
    v_lshlrev_b32 v116, 16, v51
    v_and_b32 v117, 0xffff0000, v51
    v_pk_mul_f32 v[118:119], v[86:87], v[72:73]
    v_pk_mul_f32 v[120:121], v[88:89], v[72:73]
    v_pk_mul_f32 v[122:123], v[90:91], v[72:73]
    v_pk_mul_f32 v[124:125], v[92:93], v[72:73]
    v_pk_mul_f32 v[126:127], v[94:95], v[72:73]
    v_pk_mul_f32 v[128:129], v[96:97], v[72:73]
    v_pk_mul_f32 v[130:131], v[98:99], v[72:73]
    v_pk_mul_f32 v[132:133], v[100:101], v[72:73]
    v_pk_fma_f32 v[118:119], v[84:85], v[74:75], v[118:119]
    v_pk_fma_f32 v[120:121], v[86:87], v[74:75], v[120:121]
    v_pk_fma_f32 v[122:123], v[88:89], v[74:75], v[122:123]
    v_pk_fma_f32 v[124:125], v[90:91], v[74:75], v[124:125]
    v_pk_fma_f32 v[126:127], v[92:93], v[74:75], v[126:127]
    v_pk_fma_f32 v[128:129], v[94:95], v[74:75], v[128:129]
    v_pk_fma_f32 v[130:131], v[96:97], v[74:75], v[130:131]
    v_pk_fma_f32 v[132:133], v[98:99], v[74:75], v[132:133]
    v_pk_fma_f32 v[118:119], v[82:83], v[76:77], v[118:119]
    v_pk_fma_f32 v[120:121], v[84:85], v[76:77], v[120:121]
    v_pk_fma_f32 v[122:123], v[86:87], v[76:77], v[122:123]
    v_pk_fma_f32 v[124:125], v[88:89], v[76:77], v[124:125]
    v_pk_fma_f32 v[126:127], v[90:91], v[76:77], v[126:127]
    v_pk_fma_f32 v[128:129], v[92:93], v[76:77], v[128:129]
    v_pk_fma_f32 v[130:131], v[94:95], v[76:77], v[130:131]
    v_pk_fma_f32 v[132:133], v[96:97], v[76:77], v[132:133]
    v_pk_fma_f32 v[118:119], v[80:81], v[78:79], v[118:119]
    v_pk_fma_f32 v[120:121], v[82:83], v[78:79], v[120:121]
    v_pk_fma_f32 v[122:123], v[84:85], v[78:79], v[122:123]
    v_pk_fma_f32 v[124:125], v[86:87], v[78:79], v[124:125]
    v_pk_fma_f32 v[126:127], v[88:89], v[78:79], v[126:127]
    v_pk_fma_f32 v[128:129], v[90:91], v[78:79], v[128:129]
    v_pk_fma_f32 v[130:131], v[92:93], v[78:79], v[130:131]
    v_pk_fma_f32 v[132:133], v[94:95], v[78:79], v[132:133]
    v_pk_mul_f32 v[118:119], v[118:119], v[102:103]
    v_pk_mul_f32 v[120:121], v[120:121], v[104:105]
    v_pk_mul_f32 v[122:123], v[122:123], v[106:107]
    v_pk_mul_f32 v[124:125], v[124:125], v[108:109]
    v_pk_mul_f32 v[126:127], v[126:127], v[110:111]
    v_pk_mul_f32 v[128:129], v[128:129], v[112:113]
    v_pk_mul_f32 v[130:131], v[130:131], v[114:115]
    v_pk_mul_f32 v[132:133], v[132:133], v[116:117]
    v_cvt_pk_bf16_f32 v44, v132, v130
    v_cvt_pk_bf16_f32 v45, v128, v126
    v_cvt_pk_bf16_f32 v46, v124, v122
    v_cvt_pk_bf16_f32 v47, v120, v118
    v_cvt_pk_bf16_f32 v48, v133, v131
    v_cvt_pk_bf16_f32 v49, v129, v127
    v_cvt_pk_bf16_f32 v50, v125, v123
    v_cvt_pk_bf16_f32 v51, v121, v119
    s_lshl_b32 s56, s46, 7
    s_sub_u32 s56, 32768, s56
    buffer_store_dwordx4 v[44:47], v34, s[32:35], s56 offen sc1
    v_add_u32 v8, 4224, v34
    buffer_store_dwordx4 v[48:51], v8, s[32:35], s56 offen sc1
    s_nop 1
    s_waitcnt vmcnt(3)
    v_readfirstlane_b32 s52, v35
    s_nop 3
    s_add_u32 s52, s52, 0x9e3779b9
    s_waitcnt vmcnt(0)
    s_barrier
    s_cmp_eq_u32 s44, 0
    s_cbranch_scc0 Lifl_2
    s_lshl_b32 s101, s45, 6
    s_add_u32 s101, s101, s46
    s_lshl_b32 s101, s101, 2
    s_add_u32 s101, s101, 1024
    v_mov_b32 v9, s101
    s_lshr_b32 s101, s92, 4
    s_lshl_b32 s101, s101, 6
    s_and_b32 s62, s92, 15
    s_add_u32 s101, s101, s62
    s_lshl_b32 s101, s101, 2
    s_add_u32 s101, s101, 4096
    v_writelane_b32 v9, s101, 1
    v_mov_b32 v10, s52
    s_mov_b64 exec, 3
    buffer_store_dword v10, v9, s[32:35], 0 offen sc1
    s_mov_b64 exec, -1
Lifl_2:
    s_mul_i32 s53, s44, 14
    s_add_u32 s60, s53, s63
    s_add_u32 s61, s53, 14
    s_lshl_b32 s64, s60, 15
    s_add_u32 s64, s64, s94
    s_lshl_b32 s78, s60, 10
    s_add_u32 s78, s78, 4456448
    s_add_u32 s60, s60, 1
    s_cmp_eq_u32 s60, s61
    s_cselect_b32 s60, s53, s60
    s_lshl_b32 s65, s60, 15
    s_add_u32 s65, s65, s94
    s_lshl_b32 s79, s60, 10
    s_add_u32 s79, s79, 4456448
    s_add_u32 s60, s60, 1
    s_cmp_eq_u32 s60, s61
    s_cselect_b32 s60, s53, s60
    s_lshl_b32 s66, s60, 15
    s_add_u32 s66, s66, s94
    s_lshl_b32 s80, s60, 10
    s_add_u32 s80, s80, 4456448
    s_add_u32 s60, s60, 1
    s_cmp_eq_u32 s60, s61
    s_cselect_b32 s60, s53, s60
    s_lshl_b32 s67, s60, 15
    s_add_u32 s67, s67, s94
    s_lshl_b32 s81, s60, 10
    s_add_u32 s81, s81, 4456448
    s_add_u32 s60, s60, 1
    s_cmp_eq_u32 s60, s61
    s_cselect_b32 s60, s53, s60
    s_lshl_b32 s68, s60, 15
    s_add_u32 s68, s68, s94
    s_lshl_b32 s82, s60, 10
    s_add_u32 s82, s82, 4456448
    s_add_u32 s60, s60, 1
    s_cmp_eq_u32 s60, s61
    s_cselect_b32 s60, s53, s60
    s_lshl_b32 s69, s60, 15
    s_add_u32 s69, s69, s94
    s_lshl_b32 s83, s60, 10
    s_add_u32 s83, s83, 4456448
    s_add_u32 s60, s60, 1
    s_cmp_eq_u32 s60, s61
    s_cselect_b32 s60, s53, s60
    s_lshl_b32 s70, s60, 15
    s_add_u32 s70, s70, s94
    s_lshl_b32 s84, s60, 10
    s_add_u32 s84, s84, 4456448
    s_add_u32 s60, s60, 1
    s_cmp_eq_u32 s60, s61
    s_cselect_b32 s60, s53, s60
    s_lshl_b32 s71, s60, 15
    s_add_u32 s71, s71, s94
    s_lshl_b32 s85, s60, 10
    s_add_u32 s85, s85, 4456448
    s_add_u32 s60, s60, 1
    s_cmp_eq_u32 s60, s61
    s_cselect_b32 s60, s53, s60
    s_lshl_b32 s72, s60, 15
    s_add_u32 s72, s72, s94
    s_lshl_b32 s86, s60, 10
    s_add_u32 s86, s86, 4456448
    s_add_u32 s60, s60, 1
    s_cmp_eq_u32 s60, s61
    s_cselect_b32 s60, s53, s60
    s_lshl_b32 s73, s60, 15
    s_add_u32 s73, s73, s94
    s_lshl_b32 s87, s60, 10
    s_add_u32 s87, s87, 4456448
    s_add_u32 s60, s60, 1
    s_cmp_eq_u32 s60, s61
    s_cselect_b32 s60, s53, s60
    s_lshl_b32 s74, s60, 15
    s_add_u32 s74, s74, s94
    s_lshl_b32 s88, s60, 10
    s_add_u32 s88, s88, 4456448
    s_add_u32 s60, s60, 1
    s_cmp_eq_u32 s60, s61
    s_cselect_b32 s60, s53, s60
    s_lshl_b32 s75, s60, 15
    s_add_u32 s75, s75, s94
    s_lshl_b32 s89, s60, 10
    s_add_u32 s89, s89, 4456448
    s_add_u32 s60, s60, 1
    s_cmp_eq_u32 s60, s61
    s_cselect_b32 s60, s53, s60
    s_lshl_b32 s76, s60, 15
    s_add_u32 s76, s76, s94
    s_lshl_b32 s90, s60, 10
    s_add_u32 s90, s90, 4456448
    s_add_u32 s60, s60, 1
    s_cmp_eq_u32 s60, s61
    s_cselect_b32 s60, s53, s60
    s_lshl_b32 s77, s60, 15
    s_add_u32 s77, s77, s94
    s_lshl_b32 s91, s60, 10
    s_add_u32 s91, s91, 4456448
    v_lshlrev_b32 v7, 1, v4
    v_xor_b32 v6, v24, v7
    v_lshlrev_b32 v5, 10, v23
    v_lshl_add_u32 v11, v6, 4, v5
    v_add_u32 v12, 7168, v11
    v_add_u32 v13, 14336, v11
    v_add_u32 v14, 21504, v11
    v_lshrrev_b32 v5, 2, v1
    v_lshrrev_b32 v6, 1, v5
    v_and_b32 v6, 3, v6
    v_lshlrev_b32 v5, 7, v5
    v_and_b32 v7, 3, v1
    v_lshl_add_u32 v5, v7, 3, v5
    v_add_u32 v5, s93, v5
    v_xor_b32 v7, 0, v6
    v_lshl_add_u32 v15, v7, 5, v5
    v_add_u32 v19, 67584, v15
    v_xor_b32 v7, 1, v6
    v_lshl_add_u32 v16, v7, 5, v5
    v_add_u32 v20, 67584, v16
    v_xor_b32 v7, 2, v6
    v_lshl_add_u32 v17, v7, 5, v5
    v_add_u32 v21, 67584, v17
    v_xor_b32 v7, 3, v6
    v_lshl_add_u32 v18, v7, 5, v5
    v_add_u32 v22, 67584, v18
    s_lshr_b32 s99, s44, 1
    s_mul_i32 s99, s99, 4224
    s_and_b32 s100, s44, 1
    s_lshl_b32 s100, s100, 11
    s_add_u32 s99, s99, s100
    s_add_u32 m0, s99, 135296
    s_lshl_b32 s99, s3, 12
    s_add_u32 s99, s99, s100
    buffer_load_dwordx4 v2, s[16:19], s99 offen lds
    buffer_load_dwordx4 v2, s[16:19], s99 offen offset:1024 lds
    s_lshl_b32 s99, s3, 12
    v_mov_b32 v38, s99
    buffer_load_ushort v38, v38, s[16:19], 0 offen
    s_lshl_b32 s99, s3, 1
    v_mov_b32 v39, s99
    global_load_ushort v39, v39, s[38:39]
    s_mul_i32 s99, s92, 7
    s_add_u32 s99, s99, s44
    s_add_u32 s99, s99, 0
    s_lshl_b32 s99, s99, 10
    buffer_load_dwordx4 v[52:55], v2, s[24:27], s99 offen
    s_mul_i32 s99, s92, 7
    s_add_u32 s99, s99, s44
    s_add_u32 s99, s99, 4
    s_lshl_b32 s99, s99, 10
    buffer_load_dwordx4 v[56:59], v2, s[24:27], s99 offen
    s_add_u32 m0, s93, 0
    s_nop 0
    buffer_load_dwordx4 v11, s[24:27], s64 offen lds
    buffer_load_dwordx4 v12, s[24:27], s64 offen offset:1024 lds
    buffer_load_dwordx4 v13, s[24:27], s64 offen offset:2048 lds
    buffer_load_dwordx4 v14, s[24:27], s64 offen offset:3072 lds
    s_add_u32 m0, s93, 16384
    s_nop 0
    buffer_load_dwordx4 v11, s[24:27], s65 offen lds
    buffer_load_dwordx4 v12, s[24:27], s65 offen offset:1024 lds
    buffer_load_dwordx4 v13, s[24:27], s65 offen offset:2048 lds
    buffer_load_dwordx4 v14, s[24:27], s65 offen offset:3072 lds
    s_add_u32 m0, s93, 33792
    s_nop 0
    buffer_load_dwordx4 v11, s[24:27], s66 offen lds
    buffer_load_dwordx4 v12, s[24:27], s66 offen offset:1024 lds
    buffer_load_dwordx4 v13, s[24:27], s66 offen offset:2048 lds
    buffer_load_dwordx4 v14, s[24:27], s66 offen offset:3072 lds
    s_add_u32 m0, s93, 50176
    s_nop 0
    buffer_load_dwordx4 v11, s[24:27], s67 offen lds
    buffer_load_dwordx4 v12, s[24:27], s67 offen offset:1024 lds
    buffer_load_dwordx4 v13, s[24:27], s67 offen offset:2048 lds
    buffer_load_dwordx4 v14, s[24:27], s67 offen offset:3072 lds
    s_add_u32 m0, s93, 67584
    s_nop 0
    buffer_load_dwordx4 v11, s[24:27], s68 offen lds
    buffer_load_dwordx4 v12, s[24:27], s68 offen offset:1024 lds
    buffer_load_dwordx4 v13, s[24:27], s68 offen offset:2048 lds
    buffer_load_dwordx4 v14, s[24:27], s68 offen offset:3072 lds
    s_add_u32 m0, s93, 83968
    s_nop 0
    buffer_load_dwordx4 v11, s[24:27], s69 offen lds
    buffer_load_dwordx4 v12, s[24:27], s69 offen offset:1024 lds
    buffer_load_dwordx4 v13, s[24:27], s69 offen offset:2048 lds
    buffer_load_dwordx4 v14, s[24:27], s69 offen offset:3072 lds
    s_add_u32 m0, s93, 101376
    s_nop 0
    buffer_load_dwordx4 v11, s[24:27], s70 offen lds
    buffer_load_dwordx4 v12, s[24:27], s70 offen offset:1024 lds
    buffer_load_dwordx4 v13, s[24:27], s70 offen offset:2048 lds
    buffer_load_dwordx4 v14, s[24:27], s70 offen offset:3072 lds
    s_add_u32 m0, s93, 117760
    s_nop 0
    buffer_load_dwordx4 v11, s[24:27], s71 offen lds
    buffer_load_dwordx4 v12, s[24:27], s71 offen offset:1024 lds
    buffer_load_dwordx4 v13, s[24:27], s71 offen offset:2048 lds
    buffer_load_dwordx4 v14, s[24:27], s71 offen offset:3072 lds
    s_lshl_b32 s54, s45, 8
    s_add_u32 s54, s54, 1024
    v_lshl_add_u32 v5, v1, 2, s54
    s_lshl_b32 s54, s47, 8
    s_add_u32 s54, s54, 4096
    v_lshl_add_u32 v6, v3, 2, s54
    v_cmp_gt_u32 vcc, 32, v1
    s_nop 1
    v_cndmask_b32 v25, v6, v5, vcc
    s_waitcnt vmcnt(35)
    v_lshlrev_b32 v38, 16, v38
    s_waitcnt vmcnt(34)
    v_lshlrev_b32 v39, 16, v39
    v_add_f32 v38, v38, v39
    v_cvt_pk_bf16_f32 v38, v38, v38
    s_lshr_b32 s54, s44, 1
    s_mul_i32 s54, s54, 4224
    s_add_u32 s54, s54, 135296
    v_mov_b32 v39, s54
    ds_write_b16 v39, v38
    s_waitcnt vmcnt(32)
    s_sleep 48
    s_cmp_eq_u32 s44, 0
    s_cbranch_scc0 Lipi_3
    buffer_load_dword v26, v25, s[32:35], 0 offen sc1
Lipi_3:
    s_cmp_eq_u32 s44, 0
    s_cbranch_scc0 Lipok_4
    s_waitcnt vmcnt(0)
    v_cmp_eq_u32 vcc, s52, v26
    s_nop 3
    s_cmp_eq_u64 vcc, exec
    s_cbranch_scc1 Lipok_4
    s_mov_b32 s62, 0x20000
Liprt_5:
    s_sleep 24
    buffer_load_dword v26, v25, s[32:35], 0 offen sc1
    s_waitcnt vmcnt(0)
    v_cmp_eq_u32 vcc, s52, v26
    s_nop 3
    s_cmp_eq_u64 vcc, exec
    s_cbranch_scc1 Lipok_4
    s_sub_u32 s62, s62, 1
    s_cmp_lg_u32 s62, 0
    s_cbranch_scc1 Liprt_5
Lipok_4:
    s_xor_b32 s54, s92, 56
    s_or_b32 s54, s54, s44
    s_cmp_eq_u32 s54, 0
    s_cbranch_scc0 Liep_6
    v_lshlrev_b32 v5, 8, v23
    v_lshl_add_u32 v5, v24, 4, v5
    v_add_u32 v5, 1024, v5
    s_mov_b32 s62, 0x20000
Lieprt_7:
    buffer_load_dwordx4 v[28:31], v5, s[32:35], 0 offen sc1
    s_waitcnt vmcnt(0)
    v_xor_b32 v28, s52, v28
    v_xor_b32 v29, s52, v29
    v_xor_b32 v30, s52, v30
    v_xor_b32 v31, s52, v31
    v_or_b32 v28, v28, v29
    v_or3_b32 v28, v28, v30, v31
    v_cmp_eq_u32 vcc, 0, v28
    s_nop 3
    s_cmp_eq_u64 vcc, exec
    s_cbranch_scc1 Liepok_8
    s_sleep 16
    s_sub_u32 s62, s62, 1
    s_cmp_lg_u32 s62, 0
    s_cbranch_scc1 Lieprt_7
    s_branch Liep_6
Liepok_8:
    v_mov_b32 v5, 0
    v_mov_b32 v6, s52
    s_mov_b64 exec, 1
    buffer_store_dword v6, v5, s[32:35], 0 offen sc1
    s_mov_b64 exec, -1
Liep_6:
    s_waitcnt lgkmcnt(0)
    s_barrier
    s_mul_i32 s60, s3, 4224
    s_and_b32 s61, s44, 1
    s_lshl_b32 s61, s61, 11
    s_add_u32 s60, s60, s61
    s_add_u32 s60, s60, 32768
    buffer_load_dwordx4 v[28:31], v2, s[32:35], s60 offen sc1
    buffer_load_dwordx4 v[32:35], v2, s[32:35], s60 offen offset:1024 sc1
    s_lshr_b32 s54, s44, 1
    s_mul_i32 s54, s54, 4224
    s_add_u32 s54, s54, 143616
    s_and_b32 s55, s44, 1
    s_lshl_b32 s56, s55, 11
    s_add_u32 s56, s56, s54
    v_add_u32 v5, s56, v2
    s_waitcnt vmcnt(1)
    ds_write_b128 v5, v[28:31]
    s_waitcnt vmcnt(0)
    ds_write_b128 v5, v[32:35] offset:1024
    v_mov_b32 v36, 0
    v_mov_b32 v37, 0
    v_mov_b32 v38, 0
    v_mov_b32 v39, 0
    v_mov_b32 v6, s54
    ds_write_b128 v6, v[36:39] offset:4096
    s_waitcnt lgkmcnt(0)
    s_barrier
    s_lshr_b32 s54, s44, 1
    s_mul_i32 s54, s54, 4224
    s_and_b32 s55, s44, 1
    s_lshl_b32 s55, s55, 6
    s_add_u32 s54, s54, s55
    s_add_u32 s54, s54, 146688
    v_lshrrev_b32 v25, 2, v3
    v_lshlrev_b32 v25, 10, v25
    v_lshlrev_b32 v26, 4, v4
    v_sub_u32 v25, v26, v25
    v_add_u32 v25, s54, v25
    v_and_b32 v26, 2, v1
    v_cmp_eq_u32 s[60:61], 0, v26
    v_and_b32 v26, 1, v1
    v_xor_b32 v26, 1, v26
    v_lshlrev_b32 v26, 4, v26
    ds_read_b128 v[60:63], v25 offset:0
    ds_read_b64 v[64:65], v25 offset:16
    ds_read_b128 v[68:71], v25 offset:128
    ds_read_b64 v[72:73], v25 offset:144
    s_waitcnt lgkmcnt(3)
    v_cndmask_b32 v60, v60, v61, s[60:61]
    v_cndmask_b32 v61, v61, v62, s[60:61]
    v_cndmask_b32 v62, v62, v63, s[60:61]
    s_waitcnt lgkmcnt(2)
    v_cndmask_b32 v63, v63, v64, s[60:61]
    v_cndmask_b32 v64, v64, v65, s[60:61]
    v_alignbit_b32 v28, v61, v60, v26
    v_alignbit_b32 v29, v62, v61, v26
    v_alignbit_b32 v30, v63, v62, v26
    v_alignbit_b32 v31, v64, v63, v26
    s_lshr_b32 s54, s44, 1
    s_mul_i32 s54, s54, 4224
    s_and_b32 s55, s44, 1
    s_lshl_b32 s55, s55, 6
    s_add_u32 s54, s54, s55
    s_add_u32 s54, s54, 135176
    v_lshlrev_b32 v5, 3, v3
    v_lshl_add_u32 v5, v4, 4, v5
    v_add_u32 v27, s54, v5
    ds_read_b64 v[108:109], v27 offset:0
    ds_read_b64 v[110:111], v27 offset:8
    ds_read_b64 v[112:113], v27 offset:128
    ds_read_b64 v[114:115], v27 offset:136
    s_waitcnt lgkmcnt(2)
    v_mfma_f32_16x16x32_bf16 v[104:107], v[28:31], v[108:111], 0
    v_cndmask_b32 v68, v68, v69, s[60:61]
    v_cndmask_b32 v69, v69, v70, s[60:61]
    v_cndmask_b32 v70, v70, v71, s[60:61]
    v_cndmask_b32 v71, v71, v72, s[60:61]
    v_cndmask_b32 v72, v72, v73, s[60:61]
    v_alignbit_b32 v32, v69, v68, v26
    v_alignbit_b32 v33, v70, v69, v26
    v_alignbit_b32 v34, v71, v70, v26
    v_alignbit_b32 v35, v72, v71, v26
    ds_read_b128 v[60:63], v25 offset:256
    ds_read_b64 v[64:65], v25 offset:272
    s_waitcnt lgkmcnt(2)
    v_mfma_f32_16x16x32_bf16 v[104:107], v[32:35], v[112:115], v[104:107]
    s_waitcnt lgkmcnt(1)
    v_cndmask_b32 v60, v60, v61, s[60:61]
    v_cndmask_b32 v61, v61, v62, s[60:61]
    v_mfma_f32_16x16x32_bf16 v[100:103], v[32:35], v[108:111], 0
    v_cndmask_b32 v62, v62, v63, s[60:61]
    s_waitcnt lgkmcnt(0)
    v_cndmask_b32 v63, v63, v64, s[60:61]
    v_cndmask_b32 v64, v64, v65, s[60:61]
    v_alignbit_b32 v36, v61, v60, v26
    v_alignbit_b32 v37, v62, v61, v26
    v_alignbit_b32 v38, v63, v62, v26
    v_alignbit_b32 v39, v64, v63, v26
    ds_read_b128 v[68:71], v25 offset:384
    ds_read_b64 v[72:73], v25 offset:400
    s_waitcnt lgkmcnt(1)
    v_cndmask_b32 v68, v68, v69, s[60:61]
    v_cndmask_b32 v69, v69, v70, s[60:61]
    v_cndmask_b32 v70, v70, v71, s[60:61]
    s_waitcnt lgkmcnt(0)
    v_cndmask_b32 v71, v71, v72, s[60:61]
    v_cndmask_b32 v72, v72, v73, s[60:61]
    v_alignbit_b32 v40, v69, v68, v26
    v_alignbit_b32 v41, v70, v69, v26
    v_alignbit_b32 v42, v71, v70, v26
    v_alignbit_b32 v43, v72, v71, v26
    ds_read_b128 v[60:63], v25 offset:512
    ds_read_b64 v[64:65], v25 offset:528
    ds_read_b64 v[116:117], v27 offset:256
    ds_read_b64 v[118:119], v27 offset:264
    s_waitcnt lgkmcnt(0)
    v_mfma_f32_16x16x32_bf16 v[104:107], v[36:39], v[116:119], v[104:107]
    ds_read_b64 v[120:121], v27 offset:384
    ds_read_b64 v[122:123], v27 offset:392
    v_mfma_f32_16x16x32_bf16 v[100:103], v[36:39], v[112:115], v[100:103]
    v_mov_b32_dpp v28, v28 row_shr:4 row_mask:0xf bank_mask:0xf bound_ctrl:0
    v_mov_b32_dpp v29, v29 row_shr:4 row_mask:0xf bank_mask:0xf bound_ctrl:0
    v_mfma_f32_16x16x32_bf16 v[96:99], v[36:39], v[108:111], 0
    v_mov_b32_dpp v30, v30 row_shr:4 row_mask:0xf bank_mask:0xf bound_ctrl:0
    v_mov_b32_dpp v31, v31 row_shr:4 row_mask:0xf bank_mask:0xf bound_ctrl:0
    s_waitcnt lgkmcnt(0)
    v_mfma_f32_16x16x32_bf16 v[104:107], v[40:43], v[120:123], v[104:107]
    v_cndmask_b32 v60, v60, v61, s[60:61]
    v_cndmask_b32 v61, v61, v62, s[60:61]
    v_mfma_f32_16x16x32_bf16 v[100:103], v[40:43], v[116:119], v[100:103]
    v_cndmask_b32 v62, v62, v63, s[60:61]
    v_cndmask_b32 v63, v63, v64, s[60:61]
    v_mfma_f32_16x16x32_bf16 v[96:99], v[40:43], v[112:115], v[96:99]
    v_cndmask_b32 v64, v64, v65, s[60:61]
    v_alignbit_b32 v44, v61, v60, v26
    v_mfma_f32_16x16x32_bf16 v[92:95], v[40:43], v[108:111], 0
    v_alignbit_b32 v45, v62, v61, v26
    v_alignbit_b32 v46, v63, v62, v26
    v_alignbit_b32 v47, v64, v63, v26
    ds_read_b128 v[68:71], v25 offset:640
    ds_read_b64 v[72:73], v25 offset:656
    s_waitcnt lgkmcnt(1)
    v_cndmask_b32 v68, v68, v69, s[60:61]
    v_cndmask_b32 v69, v69, v70, s[60:61]
    v_cndmask_b32 v70, v70, v71, s[60:61]
    s_waitcnt lgkmcnt(0)
    v_cndmask_b32 v71, v71, v72, s[60:61]
    v_cndmask_b32 v72, v72, v73, s[60:61]
    v_alignbit_b32 v48, v69, v68, v26
    v_alignbit_b32 v49, v70, v69, v26
    v_alignbit_b32 v50, v71, v70, v26
    v_alignbit_b32 v51, v72, v71, v26
    ds_read_b128 v[60:63], v25 offset:768
    ds_read_b64 v[64:65], v25 offset:784
    ds_read_b64 v[124:125], v27 offset:512
    ds_read_b64 v[126:127], v27 offset:520
    s_waitcnt lgkmcnt(0)
    v_mfma_f32_16x16x32_bf16 v[104:107], v[44:47], v[124:127], v[104:107]
    v_mov_b32_dpp v32, v32 row_shr:4 row_mask:0xf bank_mask:0xf bound_ctrl:0
    v_mov_b32_dpp v33, v33 row_shr:4 row_mask:0xf bank_mask:0xf bound_ctrl:0
    v_mfma_f32_16x16x32_bf16 v[100:103], v[44:47], v[120:123], v[100:103]
    v_mov_b32_dpp v34, v34 row_shr:4 row_mask:0xf bank_mask:0xf bound_ctrl:0
    v_mov_b32_dpp v35, v35 row_shr:4 row_mask:0xf bank_mask:0xf bound_ctrl:0
    v_mfma_f32_16x16x32_bf16 v[96:99], v[44:47], v[116:119], v[96:99]
    ds_read_b64_tr_b16 a[0:1], v15 offset:0
    v_mfma_f32_16x16x32_bf16 v[92:95], v[44:47], v[112:115], v[92:95]
    ds_read_b64_tr_b16 a[2:3], v15 offset:2048
    ds_read_b64_tr_b16 a[4:5], v16 offset:0
    v_mfma_f32_16x16x32_bf16 v[88:91], v[44:47], v[108:111], 0
    ds_read_b64_tr_b16 a[6:7], v16 offset:2048
    ds_read_b64_tr_b16 a[8:9], v17 offset:0
    v_cndmask_b32 v60, v60, v61, s[60:61]
    v_cndmask_b32 v61, v61, v62, s[60:61]
    v_cndmask_b32 v62, v62, v63, s[60:61]
    v_cndmask_b32 v63, v63, v64, s[60:61]
    v_cndmask_b32 v64, v64, v65, s[60:61]
    v_alignbit_b32 v52, v61, v60, v26
    v_alignbit_b32 v53, v62, v61, v26
    v_alignbit_b32 v54, v63, v62, v26
    v_alignbit_b32 v55, v64, v63, v26
    ds_read_b128 v[68:71], v25 offset:896
    ds_read_b64 v[72:73], v25 offset:912
    ds_read_b64_tr_b16 a[10:11], v17 offset:2048
    ds_read_b64_tr_b16 a[12:13], v18 offset:0
    ds_read_b64_tr_b16 a[14:15], v18 offset:2048
    ds_read_b64 v[128:129], v27 offset:640
    ds_read_b64 v[130:131], v27 offset:648
    s_waitcnt lgkmcnt(0)
    v_mfma_f32_16x16x32_bf16 v[104:107], v[48:51], v[128:131], v[104:107]
    s_add_u32 m0, s93, 0
    s_nop 0
    buffer_load_dwordx4 v11, s[24:27], s72 offen lds
    v_mov_b32_dpp v36, v36 row_shr:4 row_mask:0xf bank_mask:0xf bound_ctrl:0
    v_mov_b32_dpp v37, v37 row_shr:4 row_mask:0xf bank_mask:0xf bound_ctrl:0
    v_mfma_f32_16x16x32_bf16 v[100:103], v[48:51], v[124:127], v[100:103]
    v_mov_b32_dpp v38, v38 row_shr:4 row_mask:0xf bank_mask:0xf bound_ctrl:0
    v_mov_b32_dpp v39, v39 row_shr:4 row_mask:0xf bank_mask:0xf bound_ctrl:0
    v_mfma_f32_16x16x32_bf16 v[96:99], v[48:51], v[120:123], v[96:99]
    ds_read_b64 v[132:133], v27 offset:768
    ds_read_b64 v[134:135], v27 offset:776
    v_mfma_f32_16x16x32_bf16 v[92:95], v[48:51], v[116:119], v[92:95]
    v_mov_b32_dpp v40, v40 row_shr:4 row_mask:0xf bank_mask:0xf bound_ctrl:0
    v_mov_b32_dpp v41, v41 row_shr:4 row_mask:0xf bank_mask:0xf bound_ctrl:0
    v_mfma_f32_16x16x32_bf16 v[88:91], v[48:51], v[112:115], v[88:91]
    buffer_load_dwordx4 v12, s[24:27], s72 offen offset:1024 lds
    v_mov_b32_dpp v42, v42 row_shr:4 row_mask:0xf bank_mask:0xf bound_ctrl:0
    v_mov_b32_dpp v43, v43 row_shr:4 row_mask:0xf bank_mask:0xf bound_ctrl:0
    v_mfma_f32_16x16x32_bf16 v[84:87], v[48:51], v[108:111], 0
    ds_read_b64 v[136:137], v27 offset:896
    ds_read_b64 v[138:139], v27 offset:904
    s_waitcnt lgkmcnt(2)
    v_mfma_f32_16x16x32_bf16 v[104:107], v[52:55], v[132:135], v[104:107]
    v_cndmask_b32 v68, v68, v69, s[60:61]
    v_cndmask_b32 v69, v69, v70, s[60:61]
    v_mfma_f32_16x16x32_bf16 v[100:103], v[52:55], v[128:131], v[100:103]
    v_cndmask_b32 v70, v70, v71, s[60:61]
    v_cndmask_b32 v71, v71, v72, s[60:61]
    v_mfma_f32_16x16x32_bf16 v[96:99], v[52:55], v[124:127], v[96:99]
    buffer_load_dwordx4 v13, s[24:27], s72 offen offset:2048 lds
    v_cndmask_b32 v72, v72, v73, s[60:61]
    v_alignbit_b32 v56, v69, v68, v26
    v_mfma_f32_16x16x32_bf16 v[92:95], v[52:55], v[120:123], v[92:95]
    v_alignbit_b32 v57, v70, v69, v26
    v_alignbit_b32 v58, v71, v70, v26
    v_mfma_f32_16x16x32_bf16 v[88:91], v[52:55], v[116:119], v[88:91]
    v_alignbit_b32 v59, v72, v71, v26
    v_mov_b32_dpp v44, v44 row_shr:4 row_mask:0xf bank_mask:0xf bound_ctrl:0
    v_mfma_f32_16x16x32_bf16 v[84:87], v[52:55], v[112:115], v[84:87]
    v_mov_b32_dpp v45, v45 row_shr:4 row_mask:0xf bank_mask:0xf bound_ctrl:0
    v_mov_b32_dpp v46, v46 row_shr:4 row_mask:0xf bank_mask:0xf bound_ctrl:0
    v_mfma_f32_16x16x32_bf16 v[80:83], v[52:55], v[108:111], 0
    buffer_load_dwordx4 v14, s[24:27], s72 offen offset:3072 lds
    v_mov_b32_dpp v47, v47 row_shr:4 row_mask:0xf bank_mask:0xf bound_ctrl:0
    s_waitcnt lgkmcnt(0)
    v_mfma_f32_16x16x32_bf16 v[104:107], v[56:59], v[136:139], v[104:107]
    ds_read_b64_tr_b16 a[16:17], v15 offset:16384
    ds_read_b64_tr_b16 a[18:19], v15 offset:18432
    v_mfma_f32_16x16x32_bf16 v[100:103], v[56:59], v[132:135], v[100:103]
    ds_read_b64_tr_b16 a[20:21], v16 offset:16384
    ds_read_b64_tr_b16 a[22:23], v16 offset:18432
    v_mfma_f32_16x16x32_bf16 v[96:99], v[56:59], v[128:131], v[96:99]
    ds_read_b64_tr_b16 a[24:25], v17 offset:16384
    ds_read_b64_tr_b16 a[26:27], v17 offset:18432
    v_mfma_f32_16x16x32_bf16 v[92:95], v[56:59], v[124:127], v[92:95]
    ds_read_b64_tr_b16 a[28:29], v18 offset:16384
    ds_read_b64_tr_b16 a[30:31], v18 offset:18432
    v_mfma_f32_16x16x32_bf16 v[88:91], v[56:59], v[120:123], v[88:91]
    s_waitcnt lgkmcnt(0)
    s_add_u32 m0, s93, 16384
    s_nop 0
    buffer_load_dwordx4 v11, s[24:27], s73 offen lds
    ds_read_b64 v[140:141], v27 offset:1024
    ds_read_b64 v[142:143], v27 offset:1032
    v_mfma_f32_16x16x32_bf16 v[84:87], v[56:59], v[116:119], v[84:87]
    v_mov_b32_dpp v48, v48 row_shr:4 row_mask:0xf bank_mask:0xf bound_ctrl:0
    v_mov_b32_dpp v49, v49 row_shr:4 row_mask:0xf bank_mask:0xf bound_ctrl:0
    v_mfma_f32_16x16x32_bf16 v[80:83], v[56:59], v[112:115], v[80:83]
    v_mov_b32_dpp v50, v50 row_shr:4 row_mask:0xf bank_mask:0xf bound_ctrl:0
    v_mov_b32_dpp v51, v51 row_shr:4 row_mask:0xf bank_mask:0xf bound_ctrl:0
    v_mfma_f32_16x16x32_bf16 v[76:79], v[56:59], v[108:111], 0
    ds_read_b64 v[144:145], v27 offset:1152
    ds_read_b64 v[146:147], v27 offset:1160
    s_waitcnt lgkmcnt(2)
    v_mfma_f32_16x16x32_bf16 v[104:107], v[28:31], v[140:143], v[104:107]
    buffer_load_dwordx4 v12, s[24:27], s73 offen offset:1024 lds
    v_mov_b32_dpp v52, v52 row_shr:4 row_mask:0xf bank_mask:0xf bound_ctrl:0
    v_mov_b32_dpp v53, v53 row_shr:4 row_mask:0xf bank_mask:0xf bound_ctrl:0
    v_mfma_f32_16x16x32_bf16 v[100:103], v[28:31], v[136:139], v[100:103]
    v_mov_b32_dpp v54, v54 row_shr:4 row_mask:0xf bank_mask:0xf bound_ctrl:0
    v_mov_b32_dpp v55, v55 row_shr:4 row_mask:0xf bank_mask:0xf bound_ctrl:0
    v_mfma_f32_16x16x32_bf16 v[96:99], v[28:31], v[132:135], v[96:99]
    ds_read_b64_tr_b16 a[32:33], v15 offset:33792
    v_mfma_f32_16x16x32_bf16 v[92:95], v[28:31], v[128:131], v[92:95]
    ds_read_b64_tr_b16 a[34:35], v15 offset:35840
    ds_read_b64_tr_b16 a[36:37], v16 offset:33792
    v_mfma_f32_16x16x32_bf16 v[88:91], v[28:31], v[124:127], v[88:91]
    buffer_load_dwordx4 v13, s[24:27], s73 offen offset:2048 lds
    ds_read_b64_tr_b16 a[38:39], v16 offset:35840
    ds_read_b64_tr_b16 a[40:41], v17 offset:33792
    v_mfma_f32_16x16x32_bf16 v[84:87], v[28:31], v[120:123], v[84:87]
    ds_read_b64_tr_b16 a[42:43], v17 offset:35840
    ds_read_b64_tr_b16 a[44:45], v18 offset:33792
    v_mfma_f32_16x16x32_bf16 v[80:83], v[28:31], v[116:119], v[80:83]
    ds_read_b64_tr_b16 a[46:47], v18 offset:35840
    ds_read_b64 v[108:109], v27 offset:1280
    v_mfma_f32_16x16x32_bf16 v[76:79], v[28:31], v[112:115], v[76:79]
    ds_read_b64 v[110:111], v27 offset:1288
    v_mov_b32_dpp v56, v56 row_shr:4 row_mask:0xf bank_mask:0xf bound_ctrl:0
    s_waitcnt lgkmcnt(10)
    v_mfma_f32_16x16x32_bf16 v[104:107], v[32:35], v[144:147], v[104:107]
    buffer_load_dwordx4 v14, s[24:27], s73 offen offset:3072 lds
    v_mov_b32_dpp v57, v57 row_shr:4 row_mask:0xf bank_mask:0xf bound_ctrl:0
    v_mov_b32_dpp v58, v58 row_shr:4 row_mask:0xf bank_mask:0xf bound_ctrl:0
    v_mfma_f32_16x16x32_bf16 v[100:103], v[32:35], v[140:143], v[100:103]
    v_mov_b32_dpp v59, v59 row_shr:4 row_mask:0xf bank_mask:0xf bound_ctrl:0
    ds_read_b64 v[112:113], v27 offset:1408
    v_mfma_f32_16x16x32_bf16 v[96:99], v[32:35], v[136:139], v[96:99]
    ds_read_b64 v[114:115], v27 offset:1416
    v_mov_b32_dpp v28, v28 row_shr:4 row_mask:0xf bank_mask:0xf bound_ctrl:0
    v_mfma_f32_16x16x32_bf16 v[92:95], v[32:35], v[132:135], v[92:95]
    v_mov_b32_dpp v29, v29 row_shr:4 row_mask:0xf bank_mask:0xf bound_ctrl:0
    v_mov_b32_dpp v30, v30 row_shr:4 row_mask:0xf bank_mask:0xf bound_ctrl:0
    v_mfma_f32_16x16x32_bf16 v[88:91], v[32:35], v[128:131], v[88:91]
    s_waitcnt lgkmcnt(4)
    s_add_u32 m0, s93, 33792
    s_nop 0
    buffer_load_dwordx4 v11, s[24:27], s74 offen lds
    v_mov_b32_dpp v31, v31 row_shr:4 row_mask:0xf bank_mask:0xf bound_ctrl:0
    v_mfma_f32_16x16x32_bf16 v[84:87], v[32:35], v[124:127], v[84:87]
    ds_read_b64_tr_b16 a[48:49], v15 offset:50176
    ds_read_b64_tr_b16 a[50:51], v15 offset:52224
    v_mfma_f32_16x16x32_bf16 v[80:83], v[32:35], v[120:123], v[80:83]
    ds_read_b64_tr_b16 a[52:53], v16 offset:50176
    ds_read_b64_tr_b16 a[54:55], v16 offset:52224
    v_mfma_f32_16x16x32_bf16 v[76:79], v[32:35], v[116:119], v[76:79]
    ds_read_b64_tr_b16 a[56:57], v17 offset:50176
    ds_read_b64_tr_b16 a[58:59], v17 offset:52224
    s_waitcnt lgkmcnt(8)
    v_mfma_f32_16x16x32_bf16 v[104:107], v[36:39], v[108:111], v[104:107]
    buffer_load_dwordx4 v12, s[24:27], s74 offen offset:1024 lds
    ds_read_b64_tr_b16 a[60:61], v18 offset:50176
    ds_read_b64_tr_b16 a[62:63], v18 offset:52224
    v_mfma_f32_16x16x32_bf16 v[100:103], v[36:39], v[144:147], v[100:103]
    ds_read_b64 v[116:117], v27 offset:1536
    ds_read_b64 v[118:119], v27 offset:1544
    v_mfma_f32_16x16x32_bf16 v[96:99], v[36:39], v[140:143], v[96:99]
    v_mov_b32_dpp v32, v32 row_shr:4 row_mask:0xf bank_mask:0xf bound_ctrl:0
    v_mov_b32_dpp v33, v33 row_shr:4 row_mask:0xf bank_mask:0xf bound_ctrl:0
    v_mfma_f32_16x16x32_bf16 v[92:95], v[36:39], v[136:139], v[92:95]
    v_mov_b32_dpp v34, v34 row_shr:4 row_mask:0xf bank_mask:0xf bound_ctrl:0
    v_mov_b32_dpp v35, v35 row_shr:4 row_mask:0xf bank_mask:0xf bound_ctrl:0
    v_mfma_f32_16x16x32_bf16 v[88:91], v[36:39], v[132:135], v[88:91]
    buffer_load_dwordx4 v13, s[24:27], s74 offen offset:2048 lds
    v_mfma_f32_16x16x32_bf16 v[84:87], v[36:39], v[128:131], v[84:87]
    v_mfma_f32_16x16x32_bf16 v[80:83], v[36:39], v[124:127], v[80:83]
    v_mfma_f32_16x16x32_bf16 v[76:79], v[36:39], v[120:123], v[76:79]
    s_waitcnt lgkmcnt(10)
    v_mfma_f32_16x16x32_bf16 v[104:107], v[40:43], v[112:115], v[104:107]
    buffer_load_dwordx4 v14, s[24:27], s74 offen offset:3072 lds
    ds_read_b64 v[120:121], v27 offset:1664
    ds_read_b64 v[122:123], v27 offset:1672
    v_mfma_f32_16x16x32_bf16 v[100:103], v[40:43], v[108:111], v[100:103]
    v_mov_b32_dpp v36, v36 row_shr:4 row_mask:0xf bank_mask:0xf bound_ctrl:0
    v_mov_b32_dpp v37, v37 row_shr:4 row_mask:0xf bank_mask:0xf bound_ctrl:0
    v_mfma_f32_16x16x32_bf16 v[96:99], v[40:43], v[144:147], v[96:99]
    v_mov_b32_dpp v38, v38 row_shr:4 row_mask:0xf bank_mask:0xf bound_ctrl:0
    v_mov_b32_dpp v39, v39 row_shr:4 row_mask:0xf bank_mask:0xf bound_ctrl:0
    v_mfma_f32_16x16x32_bf16 v[92:95], v[40:43], v[140:143], v[92:95]
    ds_read_b64_tr_b16 a[64:65], v19 offset:0
    v_mfma_f32_16x16x32_bf16 v[88:91], v[40:43], v[136:139], v[88:91]
    s_waitcnt lgkmcnt(5)
    s_add_u32 m0, s93, 50176
    s_nop 0
    buffer_load_dwordx4 v11, s[24:27], s75 offen lds
    ds_read_b64_tr_b16 a[66:67], v19 offset:2048
    ds_read_b64_tr_b16 a[68:69], v20 offset:0
    v_mfma_f32_16x16x32_bf16 v[84:87], v[40:43], v[132:135], v[84:87]
    ds_read_b64_tr_b16 a[70:71], v20 offset:2048
    ds_read_b64_tr_b16 a[72:73], v21 offset:0
    v_mfma_f32_16x16x32_bf16 v[80:83], v[40:43], v[128:131], v[80:83]
    ds_read_b64_tr_b16 a[74:75], v21 offset:2048
    ds_read_b64_tr_b16 a[76:77], v22 offset:0
    v_mfma_f32_16x16x32_bf16 v[76:79], v[40:43], v[124:127], v[76:79]
    ds_read_b64_tr_b16 a[78:79], v22 offset:2048
    s_waitcnt lgkmcnt(10)
    v_mfma_f32_16x16x32_bf16 v[104:107], v[44:47], v[116:119], v[104:107]
    buffer_load_dwordx4 v12, s[24:27], s75 offen offset:1024 lds
    ds_read_b64 v[124:125], v27 offset:1792
    ds_read_b64 v[126:127], v27 offset:1800
    v_mfma_f32_16x16x32_bf16 v[100:103], v[44:47], v[112:115], v[100:103]
    v_mov_b32_dpp v40, v40 row_shr:4 row_mask:0xf bank_mask:0xf bound_ctrl:0
    v_mov_b32_dpp v41, v41 row_shr:4 row_mask:0xf bank_mask:0xf bound_ctrl:0
    v_mfma_f32_16x16x32_bf16 v[96:99], v[44:47], v[108:111], v[96:99]
    v_mov_b32_dpp v42, v42 row_shr:4 row_mask:0xf bank_mask:0xf bound_ctrl:0
    v_mov_b32_dpp v43, v43 row_shr:4 row_mask:0xf bank_mask:0xf bound_ctrl:0
    v_mfma_f32_16x16x32_bf16 v[92:95], v[44:47], v[144:147], v[92:95]
    ds_read_b64_tr_b16 a[80:81], v19 offset:16384
    v_mfma_f32_16x16x32_bf16 v[88:91], v[44:47], v[140:143], v[88:91]
    buffer_load_dwordx4 v13, s[24:27], s75 offen offset:2048 lds
    ds_read_b64_tr_b16 a[82:83], v19 offset:18432
    ds_read_b64_tr_b16 a[84:85], v20 offset:16384
    v_mfma_f32_16x16x32_bf16 v[84:87], v[44:47], v[136:139], v[84:87]
    ds_read_b64_tr_b16 a[86:87], v20 offset:18432
    ds_read_b64_tr_b16 a[88:89], v21 offset:16384
    v_mfma_f32_16x16x32_bf16 v[80:83], v[44:47], v[132:135], v[80:83]
    ds_read_b64_tr_b16 a[90:91], v21 offset:18432
    ds_read_b64_tr_b16 a[92:93], v22 offset:16384
    v_mfma_f32_16x16x32_bf16 v[76:79], v[44:47], v[128:131], v[76:79]
    ds_read_b64_tr_b16 a[94:95], v22 offset:18432
    s_waitcnt lgkmcnt(15)
    v_mfma_f32_16x16x32_bf16 v[104:107], v[48:51], v[120:123], v[104:107]
    buffer_load_dwordx4 v14, s[24:27], s75 offen offset:3072 lds
    ds_read_b64 v[128:129], v27 offset:1920
    ds_read_b64 v[130:131], v27 offset:1928
    v_mfma_f32_16x16x32_bf16 v[100:103], v[48:51], v[116:119], v[100:103]
    v_mov_b32_dpp v44, v44 row_shr:4 row_mask:0xf bank_mask:0xf bound_ctrl:0
    v_mov_b32_dpp v45, v45 row_shr:4 row_mask:0xf bank_mask:0xf bound_ctrl:0
    v_mfma_f32_16x16x32_bf16 v[96:99], v[48:51], v[112:115], v[96:99]
    v_mov_b32_dpp v46, v46 row_shr:4 row_mask:0xf bank_mask:0xf bound_ctrl:0
    v_mov_b32_dpp v47, v47 row_shr:4 row_mask:0xf bank_mask:0xf bound_ctrl:0
    v_mfma_f32_16x16x32_bf16 v[92:95], v[48:51], v[108:111], v[92:95]
    v_mfma_f32_16x16x32_bf16 v[88:91], v[48:51], v[144:147], v[88:91]
    s_waitcnt lgkmcnt(12)
    s_add_u32 m0, s93, 67584
    s_nop 0
    buffer_load_dwordx4 v11, s[24:27], s76 offen lds
    v_mfma_f32_16x16x32_bf16 v[84:87], v[48:51], v[140:143], v[84:87]
    v_mfma_f32_16x16x32_bf16 v[80:83], v[48:51], v[136:139], v[80:83]
    v_mfma_f32_16x16x32_bf16 v[76:79], v[48:51], v[132:135], v[76:79]
    s_waitcnt lgkmcnt(10)
    v_mfma_f32_16x16x32_bf16 v[104:107], v[52:55], v[124:127], v[104:107]
    buffer_load_dwordx4 v12, s[24:27], s76 offen offset:1024 lds
    ds_read_b64 v[132:133], v27 offset:2048
    ds_read_b64 v[134:135], v27 offset:2056
    v_mfma_f32_16x16x32_bf16 v[100:103], v[52:55], v[120:123], v[100:103]
    v_mov_b32_dpp v48, v48 row_shr:4 row_mask:0xf bank_mask:0xf bound_ctrl:0
    v_mov_b32_dpp v49, v49 row_shr:4 row_mask:0xf bank_mask:0xf bound_ctrl:0
    v_mfma_f32_16x16x32_bf16 v[96:99], v[52:55], v[116:119], v[96:99]
    v_mov_b32_dpp v50, v50 row_shr:4 row_mask:0xf bank_mask:0xf bound_ctrl:0
    v_mov_b32_dpp v51, v51 row_shr:4 row_mask:0xf bank_mask:0xf bound_ctrl:0
    v_mfma_f32_16x16x32_bf16 v[92:95], v[52:55], v[112:115], v[92:95]
    ds_read_b64_tr_b16 a[96:97], v19 offset:33792
    v_mfma_f32_16x16x32_bf16 v[88:91], v[52:55], v[108:111], v[88:91]
    buffer_load_dwordx4 v13, s[24:27], s76 offen offset:2048 lds
    ds_read_b64_tr_b16 a[98:99], v19 offset:35840
    ds_read_b64_tr_b16 a[100:101], v20 offset:33792
    v_mfma_f32_16x16x32_bf16 v[84:87], v[52:55], v[144:147], v[84:87]
    ds_read_b64_tr_b16 a[102:103], v20 offset:35840
    ds_read_b64_tr_b16 a[104:105], v21 offset:33792
    v_mfma_f32_16x16x32_bf16 v[80:83], v[52:55], v[140:143], v[80:83]
    ds_read_b64_tr_b16 a[106:107], v21 offset:35840
    ds_read_b64_tr_b16 a[108:109], v22 offset:33792
    v_mfma_f32_16x16x32_bf16 v[76:79], v[52:55], v[136:139], v[76:79]
    ds_read_b64_tr_b16 a[110:111], v22 offset:35840
    s_waitcnt lgkmcnt(10)
    v_mfma_f32_16x16x32_bf16 v[104:107], v[56:59], v[128:131], v[104:107]
    buffer_load_dwordx4 v14, s[24:27], s76 offen offset:3072 lds
    ds_read_b64 v[136:137], v27 offset:2176
    ds_read_b64 v[138:139], v27 offset:2184
    v_mfma_f32_16x16x32_bf16 v[100:103], v[56:59], v[124:127], v[100:103]
    v_mov_b32_dpp v52, v52 row_shr:4 row_mask:0xf bank_mask:0xf bound_ctrl:0
    v_mov_b32_dpp v53, v53 row_shr:4 row_mask:0xf bank_mask:0xf bound_ctrl:0
    v_mfma_f32_16x16x32_bf16 v[96:99], v[56:59], v[120:123], v[96:99]
    v_mov_b32_dpp v54, v54 row_shr:4 row_mask:0xf bank_mask:0xf bound_ctrl:0
    v_mov_b32_dpp v55, v55 row_shr:4 row_mask:0xf bank_mask:0xf bound_ctrl:0
    v_mfma_f32_16x16x32_bf16 v[92:95], v[56:59], v[116:119], v[92:95]
    v_min_u32 v5, 13, v3
    s_lshl_b32 s54, s47, 8
    s_add_u32 s54, s54, 8192
    v_lshl_add_u32 v152, v5, 2, s54
    s_add_u32 s54, s44, 0
    s_and_b32 s54, s54, 3
    s_lshl_b32 s55, s50, 2
    s_add_u32 s54, s54, s55
    s_mul_i32 s54, s54, 57344
    v_add_u32 v148, s54, v2
    s_add_u32 s54, s44, 1
    s_and_b32 s54, s54, 3
    s_lshl_b32 s55, s50, 2
    s_add_u32 s54, s54, s55
    s_mul_i32 s54, s54, 57344
    v_add_u32 v149, s54, v2
    s_add_u32 s54, s44, 2
    s_and_b32 s54, s54, 3
    s_lshl_b32 s55, s50, 2
    s_add_u32 s54, s54, s55
    s_mul_i32 s54, s54, 57344
    v_add_u32 v150, s54, v2
    s_add_u32 s54, s44, 3
    s_and_b32 s54, s54, 3
    s_lshl_b32 s55, s50, 2
    s_add_u32 s54, s54, s55
    s_mul_i32 s54, s54, 57344
    v_add_u32 v151, s54, v2
    v_mfma_f32_16x16x32_bf16 v[88:91], v[56:59], v[112:115], v[88:91]
    s_add_u32 m0, s93, 83968
    s_nop 0
    buffer_load_dwordx4 v11, s[24:27], s77 offen lds
    v_mfma_f32_16x16x32_bf16 v[84:87], v[56:59], v[108:111], v[84:87]
    v_mfma_f32_16x16x32_bf16 v[80:83], v[56:59], v[144:147], v[80:83]
    v_mfma_f32_16x16x32_bf16 v[76:79], v[56:59], v[140:143], v[76:79]
    s_waitcnt lgkmcnt(10)
    v_mfma_f32_16x16x32_bf16 v[104:107], v[28:31], v[132:135], v[104:107]
    buffer_load_dwordx4 v12, s[24:27], s77 offen offset:1024 lds
    ds_read_b64 v[140:141], v27 offset:2304
    ds_read_b64 v[142:143], v27 offset:2312
    v_mfma_f32_16x16x32_bf16 v[100:103], v[28:31], v[128:131], v[100:103]
    v_mov_b32_dpp v56, v56 row_shr:4 row_mask:0xf bank_mask:0xf bound_ctrl:0
    v_mov_b32_dpp v57, v57 row_shr:4 row_mask:0xf bank_mask:0xf bound_ctrl:0
    v_mfma_f32_16x16x32_bf16 v[96:99], v[28:31], v[124:127], v[96:99]
    v_mov_b32_dpp v58, v58 row_shr:4 row_mask:0xf bank_mask:0xf bound_ctrl:0
    v_mov_b32_dpp v59, v59 row_shr:4 row_mask:0xf bank_mask:0xf bound_ctrl:0
    v_mfma_f32_16x16x32_bf16 v[92:95], v[28:31], v[120:123], v[92:95]
    ds_read_b64_tr_b16 a[112:113], v19 offset:50176
    v_mfma_f32_16x16x32_bf16 v[88:91], v[28:31], v[116:119], v[88:91]
    buffer_load_dwordx4 v13, s[24:27], s77 offen offset:2048 lds
    ds_read_b64_tr_b16 a[114:115], v19 offset:52224
    ds_read_b64_tr_b16 a[116:117], v20 offset:50176
    v_mfma_f32_16x16x32_bf16 v[84:87], v[28:31], v[112:115], v[84:87]
    ds_read_b64_tr_b16 a[118:119], v20 offset:52224
    ds_read_b64_tr_b16 a[120:121], v21 offset:50176
    v_mfma_f32_16x16x32_bf16 v[80:83], v[28:31], v[108:111], v[80:83]
    ds_read_b64_tr_b16 a[122:123], v21 offset:52224
    ds_read_b64_tr_b16 a[124:125], v22 offset:50176
    v_mfma_f32_16x16x32_bf16 v[76:79], v[28:31], v[144:147], v[76:79]
    ds_read_b64_tr_b16 a[126:127], v22 offset:52224
    s_waitcnt lgkmcnt(10)
    v_mfma_f32_16x16x32_bf16 v[104:107], v[32:35], v[136:139], v[104:107]
    buffer_load_dwordx4 v14, s[24:27], s77 offen offset:3072 lds
    ds_read_b64 v[144:145], v27 offset:2432
    ds_read_b64 v[146:147], v27 offset:2440
    v_mfma_f32_16x16x32_bf16 v[100:103], v[32:35], v[132:135], v[100:103]
    v_mov_b32_dpp v28, v28 row_shr:4 row_mask:0xf bank_mask:0xf bound_ctrl:0
    v_mov_b32_dpp v29, v29 row_shr:4 row_mask:0xf bank_mask:0xf bound_ctrl:0
    v_mfma_f32_16x16x32_bf16 v[96:99], v[32:35], v[128:131], v[96:99]
    v_mov_b32_dpp v30, v30 row_shr:4 row_mask:0xf bank_mask:0xf bound_ctrl:0
    v_mov_b32_dpp v31, v31 row_shr:4 row_mask:0xf bank_mask:0xf bound_ctrl:0
    v_mfma_f32_16x16x32_bf16 v[92:95], v[32:35], v[124:127], v[92:95]
    s_waitcnt vmcnt(20)
    ds_read_b64_tr_b16 a[128:129], v15 offset:0
    v_mfma_f32_16x16x32_bf16 v[88:91], v[32:35], v[120:123], v[88:91]
    s_cmp_eq_u32 s44, 0
    s_cbranch_scc0 Lipi_9
    buffer_load_dword v153, v152, s[32:35], 0 offen sc1
Lipi_9:
    ds_read_b64_tr_b16 a[130:131], v15 offset:2048
    ds_read_b64_tr_b16 a[132:133], v16 offset:0
    v_mfma_f32_16x16x32_bf16 v[84:87], v[32:35], v[116:119], v[84:87]
    ds_read_b64_tr_b16 a[134:135], v16 offset:2048
    ds_read_b64_tr_b16 a[136:137], v17 offset:0
    v_mfma_f32_16x16x32_bf16 v[80:83], v[32:35], v[112:115], v[80:83]
    ds_read_b64_tr_b16 a[138:139], v17 offset:2048
    ds_read_b64_tr_b16 a[140:141], v18 offset:0
    v_mfma_f32_16x16x32_bf16 v[76:79], v[32:35], v[108:111], v[76:79]
    ds_read_b64_tr_b16 a[142:143], v18 offset:2048
    s_waitcnt lgkmcnt(15)
    v_mfma_f32_16x16x32_bf16 v[104:107], v[36:39], v[140:143], v[104:107]
    ds_read_b64 v[108:109], v27 offset:2560
    ds_read_b64 v[110:111], v27 offset:2568
    v_mfma_f32_16x16x32_bf16 v[100:103], v[36:39], v[136:139], v[100:103]
    v_mov_b32_dpp v32, v32 row_shr:4 row_mask:0xf bank_mask:0xf bound_ctrl:0
    v_mov_b32_dpp v33, v33 row_shr:4 row_mask:0xf bank_mask:0xf bound_ctrl:0
    v_mfma_f32_16x16x32_bf16 v[96:99], v[36:39], v[132:135], v[96:99]
    v_mov_b32_dpp v34, v34 row_shr:4 row_mask:0xf bank_mask:0xf bound_ctrl:0
    v_mov_b32_dpp v35, v35 row_shr:4 row_mask:0xf bank_mask:0xf bound_ctrl:0
    v_mfma_f32_16x16x32_bf16 v[92:95], v[36:39], v[128:131], v[92:95]
    v_mfma_f32_16x16x32_bf16 v[88:91], v[36:39], v[124:127], v[88:91]
    v_mfma_f32_16x16x32_bf16 v[84:87], v[36:39], v[120:123], v[84:87]
    v_mfma_f32_16x16x32_bf16 v[80:83], v[36:39], v[116:119], v[80:83]
    v_mfma_f32_16x16x32_bf16 v[76:79], v[36:39], v[112:115], v[76:79]
    s_waitcnt lgkmcnt(10)
    v_mfma_f32_16x16x32_bf16 v[104:107], v[40:43], v[144:147], v[104:107]
    ds_read_b64 v[112:113], v27 offset:2688
    ds_read_b64 v[114:115], v27 offset:2696
    v_mfma_f32_16x16x32_bf16 v[100:103], v[40:43], v[140:143], v[100:103]
    v_mov_b32_dpp v36, v36 row_shr:4 row_mask:0xf bank_mask:0xf bound_ctrl:0
    v_mov_b32_dpp v37, v37 row_shr:4 row_mask:0xf bank_mask:0xf bound_ctrl:0
    v_mfma_f32_16x16x32_bf16 v[96:99], v[40:43], v[136:139], v[96:99]
    v_mov_b32_dpp v38, v38 row_shr:4 row_mask:0xf bank_mask:0xf bound_ctrl:0
    v_mov_b32_dpp v39, v39 row_shr:4 row_mask:0xf bank_mask:0xf bound_ctrl:0
    v_mfma_f32_16x16x32_bf16 v[92:95], v[40:43], v[132:135], v[92:95]
    s_waitcnt vmcnt(16)
    ds_read_b64_tr_b16 a[144:145], v15 offset:16384
    v_mfma_f32_16x16x32_bf16 v[88:91], v[40:43], v[128:131], v[88:91]
    ds_read_b64_tr_b16 a[146:147], v15 offset:18432
    ds_read_b64_tr_b16 a[148:149], v16 offset:16384
    v_mfma_f32_16x16x32_bf16 v[84:87], v[40:43], v[124:127], v[84:87]
    ds_read_b64_tr_b16 a[150:151], v16 offset:18432
    ds_read_b64_tr_b16 a[152:153], v17 offset:16384
    v_mfma_f32_16x16x32_bf16 v[80:83], v[40:43], v[120:123], v[80:83]
    ds_read_b64_tr_b16 a[154:155], v17 offset:18432
    ds_read_b64_tr_b16 a[156:157], v18 offset:16384
    v_mfma_f32_16x16x32_bf16 v[76:79], v[40:43], v[116:119], v[76:79]
    ds_read_b64_tr_b16 a[158:159], v18 offset:18432
    s_waitcnt lgkmcnt(10)
    v_mfma_f32_16x16x32_bf16 v[104:107], v[44:47], v[108:111], v[104:107]
    ds_read_b64 v[116:117], v27 offset:2816
    ds_read_b64 v[118:119], v27 offset:2824
    v_mfma_f32_16x16x32_bf16 v[100:103], v[44:47], v[144:147], v[100:103]
    v_mov_b32_dpp v40, v40 row_shr:4 row_mask:0xf bank_mask:0xf bound_ctrl:0
    v_mov_b32_dpp v41, v41 row_shr:4 row_mask:0xf bank_mask:0xf bound_ctrl:0
    v_mfma_f32_16x16x32_bf16 v[96:99], v[44:47], v[140:143], v[96:99]
    v_mov_b32_dpp v42, v42 row_shr:4 row_mask:0xf bank_mask:0xf bound_ctrl:0
    v_mov_b32_dpp v43, v43 row_shr:4 row_mask:0xf bank_mask:0xf bound_ctrl:0
    v_mfma_f32_16x16x32_bf16 v[92:95], v[44:47], v[136:139], v[92:95]
    s_waitcnt vmcnt(12)
    ds_read_b64_tr_b16 a[160:161], v15 offset:33792
    v_mfma_f32_16x16x32_bf16 v[88:91], v[44:47], v[132:135], v[88:91]
    ds_read_b64_tr_b16 a[162:163], v15 offset:35840
    ds_read_b64_tr_b16 a[164:165], v16 offset:33792
    v_mfma_f32_16x16x32_bf16 v[84:87], v[44:47], v[128:131], v[84:87]
    ds_read_b64_tr_b16 a[166:167], v16 offset:35840
    ds_read_b64_tr_b16 a[168:169], v17 offset:33792
    v_mfma_f32_16x16x32_bf16 v[80:83], v[44:47], v[124:127], v[80:83]
    ds_read_b64_tr_b16 a[170:171], v17 offset:35840
    ds_read_b64_tr_b16 a[172:173], v18 offset:33792
    v_mfma_f32_16x16x32_bf16 v[76:79], v[44:47], v[120:123], v[76:79]
    ds_read_b64_tr_b16 a[174:175], v18 offset:35840
    s_waitcnt lgkmcnt(15)
    v_mfma_f32_16x16x32_bf16 v[104:107], v[48:51], v[112:115], v[104:107]
    ds_read_b64 v[120:121], v27 offset:2944
    ds_read_b64 v[122:123], v27 offset:2952
    v_mfma_f32_16x16x32_bf16 v[100:103], v[48:51], v[108:111], v[100:103]
    v_mov_b32_dpp v44, v44 row_shr:4 row_mask:0xf bank_mask:0xf bound_ctrl:0
    v_mov_b32_dpp v45, v45 row_shr:4 row_mask:0xf bank_mask:0xf bound_ctrl:0
    v_mfma_f32_16x16x32_bf16 v[96:99], v[48:51], v[144:147], v[96:99]
    v_mov_b32_dpp v46, v46 row_shr:4 row_mask:0xf bank_mask:0xf bound_ctrl:0
    v_mov_b32_dpp v47, v47 row_shr:4 row_mask:0xf bank_mask:0xf bound_ctrl:0
    v_mfma_f32_16x16x32_bf16 v[92:95], v[48:51], v[140:143], v[92:95]
    v_mfma_f32_16x16x32_bf16 v[88:91], v[48:51], v[136:139], v[88:91]
    v_mfma_f32_16x16x32_bf16 v[84:87], v[48:51], v[132:135], v[84:87]
    v_mfma_f32_16x16x32_bf16 v[80:83], v[48:51], v[128:131], v[80:83]
    v_mfma_f32_16x16x32_bf16 v[76:79], v[48:51], v[124:127], v[76:79]
    s_waitcnt lgkmcnt(10)
    v_mfma_f32_16x16x32_bf16 v[104:107], v[52:55], v[116:119], v[104:107]
    ds_read_b64 v[124:125], v27 offset:3072
    ds_read_b64 v[126:127], v27 offset:3080
    v_mfma_f32_16x16x32_bf16 v[100:103], v[52:55], v[112:115], v[100:103]
    v_mov_b32_dpp v48, v48 row_shr:4 row_mask:0xf bank_mask:0xf bound_ctrl:0
    v_mov_b32_dpp v49, v49 row_shr:4 row_mask:0xf bank_mask:0xf bound_ctrl:0
    v_mfma_f32_16x16x32_bf16 v[96:99], v[52:55], v[108:111], v[96:99]
    v_mov_b32_dpp v50, v50 row_shr:4 row_mask:0xf bank_mask:0xf bound_ctrl:0
    v_mov_b32_dpp v51, v51 row_shr:4 row_mask:0xf bank_mask:0xf bound_ctrl:0
    v_mfma_f32_16x16x32_bf16 v[92:95], v[52:55], v[144:147], v[92:95]
    s_waitcnt vmcnt(8)
    ds_read_b64_tr_b16 a[176:177], v15 offset:50176
    v_mfma_f32_16x16x32_bf16 v[88:91], v[52:55], v[140:143], v[88:91]
    ds_read_b64_tr_b16 a[178:179], v15 offset:52224
    ds_read_b64_tr_b16 a[180:181], v16 offset:50176
    v_mfma_f32_16x16x32_bf16 v[84:87], v[52:55], v[136:139], v[84:87]
    ds_read_b64_tr_b16 a[182:183], v16 offset:52224
    ds_read_b64_tr_b16 a[184:185], v17 offset:50176
    v_mfma_f32_16x16x32_bf16 v[80:83], v[52:55], v[132:135], v[80:83]
    ds_read_b64_tr_b16 a[186:187], v17 offset:52224
    ds_read_b64_tr_b16 a[188:189], v18 offset:50176
    v_mfma_f32_16x16x32_bf16 v[76:79], v[52:55], v[128:131], v[76:79]
    ds_read_b64_tr_b16 a[190:191], v18 offset:52224
    s_waitcnt lgkmcnt(10)
    v_mfma_f32_16x16x32_bf16 v[104:107], v[56:59], v[120:123], v[104:107]
    ds_read_b64 v[128:129], v27 offset:3200
    ds_read_b64 v[130:131], v27 offset:3208
    v_mfma_f32_16x16x32_bf16 v[100:103], v[56:59], v[116:119], v[100:103]
    v_mov_b32_dpp v52, v52 row_shr:4 row_mask:0xf bank_mask:0xf bound_ctrl:0
    v_mov_b32_dpp v53, v53 row_shr:4 row_mask:0xf bank_mask:0xf bound_ctrl:0
    v_mfma_f32_16x16x32_bf16 v[96:99], v[56:59], v[112:115], v[96:99]
    v_mov_b32_dpp v54, v54 row_shr:4 row_mask:0xf bank_mask:0xf bound_ctrl:0
    v_mov_b32_dpp v55, v55 row_shr:4 row_mask:0xf bank_mask:0xf bound_ctrl:0
    v_mfma_f32_16x16x32_bf16 v[92:95], v[56:59], v[108:111], v[92:95]
    v_mfma_f32_16x16x32_bf16 v[88:91], v[56:59], v[144:147], v[88:91]
    v_mfma_f32_16x16x32_bf16 v[84:87], v[56:59], v[140:143], v[84:87]
    v_mfma_f32_16x16x32_bf16 v[80:83], v[56:59], v[136:139], v[80:83]
    v_mfma_f32_16x16x32_bf16 v[76:79], v[56:59], v[132:135], v[76:79]
    s_waitcnt lgkmcnt(10)
    v_mfma_f32_16x16x32_bf16 v[104:107], v[28:31], v[124:127], v[104:107]
    ds_read_b64 v[132:133], v27 offset:3328
    ds_read_b64 v[134:135], v27 offset:3336
    v_mfma_f32_16x16x32_bf16 v[100:103], v[28:31], v[120:123], v[100:103]
    v_mov_b32_dpp v56, v56 row_shr:4 row_mask:0xf bank_mask:0xf bound_ctrl:0
    v_mov_b32_dpp v57, v57 row_shr:4 row_mask:0xf bank_mask:0xf bound_ctrl:0
    v_mfma_f32_16x16x32_bf16 v[96:99], v[28:31], v[116:119], v[96:99]
    v_mov_b32_dpp v58, v58 row_shr:4 row_mask:0xf bank_mask:0xf bound_ctrl:0
    v_mov_b32_dpp v59, v59 row_shr:4 row_mask:0xf bank_mask:0xf bound_ctrl:0
    v_mfma_f32_16x16x32_bf16 v[92:95], v[28:31], v[112:115], v[92:95]
    s_waitcnt vmcnt(4)
    ds_read_b64_tr_b16 a[192:193], v19 offset:0
    v_mfma_f32_16x16x32_bf16 v[88:91], v[28:31], v[108:111], v[88:91]
    ds_read_b64_tr_b16 a[194:195], v19 offset:2048
    ds_read_b64_tr_b16 a[196:197], v20 offset:0
    v_mfma_f32_16x16x32_bf16 v[84:87], v[28:31], v[144:147], v[84:87]
    ds_read_b64_tr_b16 a[198:199], v20 offset:2048
    ds_read_b64_tr_b16 a[200:201], v21 offset:0
    v_mfma_f32_16x16x32_bf16 v[80:83], v[28:31], v[140:143], v[80:83]
    ds_read_b64_tr_b16 a[202:203], v21 offset:2048
    ds_read_b64_tr_b16 a[204:205], v22 offset:0
    v_mfma_f32_16x16x32_bf16 v[76:79], v[28:31], v[136:139], v[76:79]
    ds_read_b64_tr_b16 a[206:207], v22 offset:2048
    s_waitcnt lgkmcnt(10)
    v_mfma_f32_16x16x32_bf16 v[104:107], v[32:35], v[128:131], v[104:107]
    ds_read_b64 v[136:137], v27 offset:3456
    ds_read_b64 v[138:139], v27 offset:3464
    v_mfma_f32_16x16x32_bf16 v[100:103], v[32:35], v[124:127], v[100:103]
    s_waitcnt vmcnt(0)
    ds_read_b64_tr_b16 a[208:209], v19 offset:16384
    v_mfma_f32_16x16x32_bf16 v[96:99], v[32:35], v[120:123], v[96:99]
    ds_read_b64_tr_b16 a[210:211], v19 offset:18432
    ds_read_b64_tr_b16 a[212:213], v20 offset:16384
    v_mfma_f32_16x16x32_bf16 v[92:95], v[32:35], v[116:119], v[92:95]
    ds_read_b64_tr_b16 a[214:215], v20 offset:18432
    ds_read_b64_tr_b16 a[216:217], v21 offset:16384
    v_mfma_f32_16x16x32_bf16 v[88:91], v[32:35], v[112:115], v[88:91]
    ds_read_b64_tr_b16 a[218:219], v21 offset:18432
    ds_read_b64_tr_b16 a[220:221], v22 offset:16384
    v_mfma_f32_16x16x32_bf16 v[84:87], v[32:35], v[108:111], v[84:87]
    ds_read_b64_tr_b16 a[222:223], v22 offset:18432
    s_cmp_eq_u32 s44, 0
    s_cbranch_scc0 Lipok_10
    v_cmp_eq_u32 vcc, s52, v153
    s_nop 3
    s_cmp_eq_u64 vcc, exec
    s_cbranch_scc1 Lipok_10
    s_mov_b32 s62, 0x20000
Liprt_11:
    s_sleep 8
    buffer_load_dword v153, v152, s[32:35], 0 offen sc1
    s_waitcnt vmcnt(0)
    v_cmp_eq_u32 vcc, s52, v153
    s_nop 3
    s_cmp_eq_u64 vcc, exec
    s_cbranch_scc1 Lipok_10
    s_sub_u32 s62, s62, 1
    s_cmp_lg_u32 s62, 0
    s_cbranch_scc1 Liprt_11
Lipok_10:
    s_barrier
    v_mfma_f32_16x16x32_bf16 v[80:83], v[32:35], v[144:147], v[80:83]
    buffer_load_dwordx4 v[60:63], v148, s[32:35], s78 offen sc1
    v_mfma_f32_16x16x32_bf16 v[76:79], v[32:35], v[140:143], v[76:79]
    s_waitcnt lgkmcnt(15)
    v_mfma_f32_16x16x32_bf16 v[104:107], v[36:39], v[132:135], v[104:107]
    ds_read_b64 v[140:141], v27 offset:3584
    ds_read_b64 v[142:143], v27 offset:3592
    v_mfma_f32_16x16x32_bf16 v[100:103], v[36:39], v[128:131], v[100:103]
    v_mfma_f32_16x16x32_bf16 v[96:99], v[36:39], v[124:127], v[96:99]
    buffer_load_dwordx4 v[64:67], v149, s[32:35], s78 offen sc1
    v_mfma_f32_16x16x32_bf16 v[92:95], v[36:39], v[120:123], v[92:95]
    v_mfma_f32_16x16x32_bf16 v[88:91], v[36:39], v[116:119], v[88:91]
    v_mfma_f32_16x16x32_bf16 v[84:87], v[36:39], v[112:115], v[84:87]
    v_mfma_f32_16x16x32_bf16 v[80:83], v[36:39], v[108:111], v[80:83]
    buffer_load_dwordx4 v[68:71], v150, s[32:35], s78 offen sc1
    v_mfma_f32_16x16x32_bf16 v[76:79], v[36:39], v[144:147], v[76:79]
    s_waitcnt lgkmcnt(10)
    v_mfma_f32_16x16x32_bf16 v[104:107], v[40:43], v[136:139], v[104:107]
    ds_read_b64 v[144:145], v27 offset:3712
    ds_read_b64 v[146:147], v27 offset:3720
    v_mfma_f32_16x16x32_bf16 v[100:103], v[40:43], v[132:135], v[100:103]
    v_mfma_f32_16x16x32_bf16 v[96:99], v[40:43], v[128:131], v[96:99]
    buffer_load_dwordx4 v[72:75], v151, s[32:35], s78 offen sc1
    v_mfma_f32_16x16x32_bf16 v[92:95], v[40:43], v[124:127], v[92:95]
    v_mfma_f32_16x16x32_bf16 v[88:91], v[40:43], v[120:123], v[88:91]
    v_mfma_f32_16x16x32_bf16 v[84:87], v[40:43], v[116:119], v[84:87]
    v_mfma_f32_16x16x32_bf16 v[80:83], v[40:43], v[112:115], v[80:83]
    buffer_load_dwordx4 v[156:159], v148, s[32:35], s79 offen sc1
    v_mfma_f32_16x16x32_bf16 v[76:79], v[40:43], v[108:111], v[76:79]
    s_waitcnt lgkmcnt(2)
    v_mfma_f32_16x16x32_bf16 v[104:107], v[44:47], v[140:143], v[104:107]
    ds_read_b64 v[108:109], v27 offset:3840
    ds_read_b64 v[110:111], v27 offset:3848
    v_mfma_f32_16x16x32_bf16 v[100:103], v[44:47], v[136:139], v[100:103]
    v_mfma_f32_16x16x32_bf16 v[96:99], v[44:47], v[132:135], v[96:99]
    buffer_load_dwordx4 v[160:163], v149, s[32:35], s79 offen sc1
    v_mfma_f32_16x16x32_bf16 v[92:95], v[44:47], v[128:131], v[92:95]
    v_mfma_f32_16x16x32_bf16 v[88:91], v[44:47], v[124:127], v[88:91]
    v_mfma_f32_16x16x32_bf16 v[84:87], v[44:47], v[120:123], v[84:87]
    v_mfma_f32_16x16x32_bf16 v[80:83], v[44:47], v[116:119], v[80:83]
    buffer_load_dwordx4 v[164:167], v150, s[32:35], s79 offen sc1
    v_mfma_f32_16x16x32_bf16 v[76:79], v[44:47], v[112:115], v[76:79]
    s_waitcnt lgkmcnt(2)
    v_mfma_f32_16x16x32_bf16 v[104:107], v[48:51], v[144:147], v[104:107]
    ds_read_b64 v[112:113], v27 offset:3968
    ds_read_b64 v[114:115], v27 offset:3976
    v_mfma_f32_16x16x32_bf16 v[100:103], v[48:51], v[140:143], v[100:103]
    v_mfma_f32_16x16x32_bf16 v[96:99], v[48:51], v[136:139], v[96:99]
    buffer_load_dwordx4 v[168:171], v151, s[32:35], s79 offen sc1
    v_mfma_f32_16x16x32_bf16 v[92:95], v[48:51], v[132:135], v[92:95]
    v_mfma_f32_16x16x32_bf16 v[88:91], v[48:51], v[128:131], v[88:91]
    v_mfma_f32_16x16x32_bf16 v[84:87], v[48:51], v[124:127], v[84:87]
    v_mfma_f32_16x16x32_bf16 v[80:83], v[48:51], v[120:123], v[80:83]
    buffer_load_dwordx4 v[172:175], v148, s[32:35], s80 offen sc1
    v_mfma_f32_16x16x32_bf16 v[76:79], v[48:51], v[116:119], v[76:79]
    s_waitcnt lgkmcnt(2)
    v_mfma_f32_16x16x32_bf16 v[104:107], v[52:55], v[108:111], v[104:107]
    v_mfma_f32_16x16x32_bf16 v[100:103], v[52:55], v[144:147], v[100:103]
    v_mfma_f32_16x16x32_bf16 v[96:99], v[52:55], v[140:143], v[96:99]
    buffer_load_dwordx4 v[176:179], v149, s[32:35], s80 offen sc1
    v_mfma_f32_16x16x32_bf16 v[92:95], v[52:55], v[136:139], v[92:95]
    v_mfma_f32_16x16x32_bf16 v[88:91], v[52:55], v[132:135], v[88:91]
    v_mfma_f32_16x16x32_bf16 v[84:87], v[52:55], v[128:131], v[84:87]
    v_mfma_f32_16x16x32_bf16 v[80:83], v[52:55], v[124:127], v[80:83]
    buffer_load_dwordx4 v[180:183], v150, s[32:35], s80 offen sc1
    v_mfma_f32_16x16x32_bf16 v[76:79], v[52:55], v[120:123], v[76:79]
    s_waitcnt lgkmcnt(0)
    v_mfma_f32_16x16x32_bf16 v[104:107], v[56:59], v[112:115], v[104:107]
    v_mfma_f32_16x16x32_bf16 v[100:103], v[56:59], v[108:111], v[100:103]
    v_mfma_f32_16x16x32_bf16 v[96:99], v[56:59], v[144:147], v[96:99]
    buffer_load_dwordx4 v[184:187], v151, s[32:35], s80 offen sc1
    v_mfma_f32_16x16x32_bf16 v[92:95], v[56:59], v[140:143], v[92:95]
    v_mfma_f32_16x16x32_bf16 v[88:91], v[56:59], v[136:139], v[88:91]
    v_mfma_f32_16x16x32_bf16 v[84:87], v[56:59], v[132:135], v[84:87]
    v_mfma_f32_16x16x32_bf16 v[80:83], v[56:59], v[128:131], v[80:83]
    buffer_load_dwordx4 v[188:191], v148, s[32:35], s81 offen sc1
    v_mfma_f32_16x16x32_bf16 v[76:79], v[56:59], v[124:127], v[76:79]
    s_add_u32 s54, s93, 143616
    v_add_u32 v5, s54, v2
    s_xor_b32 s55, s93, 4096
    s_add_u32 s55, s55, 143616
    v_add_u32 v6, s55, v2
    v_lshlrev_b32 v7, 3, v3
    v_lshl_add_u32 v7, v4, 10, v7
    s_lshl_b32 s56, s3, 12
    s_add_u32 s56, s56, 2228224
    s_and_b32 s57, s44, 1
    s_cmp_eq_u32 s57, 0
    s_cbranch_scc0 Licvo_12
    ds_write_b128 v5, v[92:95] offset:0
    ds_write_b128 v5, v[96:99] offset:1024
    ds_write_b128 v5, v[100:103] offset:2048
    ds_write_b128 v5, v[104:107] offset:3072
    s_waitcnt lgkmcnt(0)
    s_barrier
    ds_read_b128 v[28:31], v6 offset:0
    ds_read_b128 v[32:35], v6 offset:1024
    ds_read_b128 v[36:39], v6 offset:2048
    ds_read_b128 v[40:43], v6 offset:3072
    s_waitcnt lgkmcnt(3)
    v_add_f32 v28, v28, v76
    v_add_f32 v29, v29, v77
    v_add_f32 v30, v30, v78
    v_add_f32 v31, v31, v79
    v_cvt_pk_bf16_f32 v12, v28, v29
    v_cvt_pk_bf16_f32 v13, v30, v31
    buffer_store_dwordx2 v[12:13], v7, s[32:35], s56 offen offset:0 sc1
    s_waitcnt lgkmcnt(2)
    v_add_f32 v32, v32, v80
    v_add_f32 v33, v33, v81
    v_add_f32 v34, v34, v82
    v_add_f32 v35, v35, v83
    v_cvt_pk_bf16_f32 v14, v32, v33
    v_cvt_pk_bf16_f32 v15, v34, v35
    buffer_store_dwordx2 v[14:15], v7, s[32:35], s56 offen offset:128 sc1
    s_waitcnt lgkmcnt(1)
    v_add_f32 v36, v36, v84
    v_add_f32 v37, v37, v85
    v_add_f32 v38, v38, v86
    v_add_f32 v39, v39, v87
    v_cvt_pk_bf16_f32 v16, v36, v37
    v_cvt_pk_bf16_f32 v17, v38, v39
    buffer_store_dwordx2 v[16:17], v7, s[32:35], s56 offen offset:256 sc1
    s_waitcnt lgkmcnt(0)
    v_add_f32 v40, v40, v88
    v_add_f32 v41, v41, v89
    v_add_f32 v42, v42, v90
    v_add_f32 v43, v43, v91
    v_cvt_pk_bf16_f32 v18, v40, v41
    v_cvt_pk_bf16_f32 v19, v42, v43
    buffer_store_dwordx2 v[18:19], v7, s[32:35], s56 offen offset:384 sc1
    s_branch Licve_13
Licvo_12:
    ds_write_b128 v5, v[76:79] offset:0
    ds_write_b128 v5, v[80:83] offset:1024
    ds_write_b128 v5, v[84:87] offset:2048
    ds_write_b128 v5, v[88:91] offset:3072
    s_waitcnt lgkmcnt(0)
    s_barrier
    ds_read_b128 v[28:31], v6 offset:0
    ds_read_b128 v[32:35], v6 offset:1024
    ds_read_b128 v[36:39], v6 offset:2048
    ds_read_b128 v[40:43], v6 offset:3072
    s_waitcnt lgkmcnt(3)
    v_add_f32 v28, v28, v92
    v_add_f32 v29, v29, v93
    v_add_f32 v30, v30, v94
    v_add_f32 v31, v31, v95
    v_cvt_pk_bf16_f32 v12, v28, v29
    v_cvt_pk_bf16_f32 v13, v30, v31
    buffer_store_dwordx2 v[12:13], v7, s[32:35], s56 offen offset:512 sc1
    s_waitcnt lgkmcnt(2)
    v_add_f32 v32, v32, v96
    v_add_f32 v33, v33, v97
    v_add_f32 v34, v34, v98
    v_add_f32 v35, v35, v99
    v_cvt_pk_bf16_f32 v14, v32, v33
    v_cvt_pk_bf16_f32 v15, v34, v35
    buffer_store_dwordx2 v[14:15], v7, s[32:35], s56 offen offset:640 sc1
    s_waitcnt lgkmcnt(1)
    v_add_f32 v36, v36, v100
    v_add_f32 v37, v37, v101
    v_add_f32 v38, v38, v102
    v_add_f32 v39, v39, v103
    v_cvt_pk_bf16_f32 v16, v36, v37
    v_cvt_pk_bf16_f32 v17, v38, v39
    buffer_store_dwordx2 v[16:17], v7, s[32:35], s56 offen offset:768 sc1
    s_waitcnt lgkmcnt(0)
    v_add_f32 v40, v40, v104
    v_add_f32 v41, v41, v105
    v_add_f32 v42, v42, v106
    v_add_f32 v43, v43, v107
    v_cvt_pk_bf16_f32 v18, v40, v41
    v_cvt_pk_bf16_f32 v19, v42, v43
    buffer_store_dwordx2 v[18:19], v7, s[32:35], s56 offen offset:896 sc1
Licve_13:
    s_waitcnt vmcnt(16)
    v_mfma_f32_16x16x32_bf16 v[76:79], a[0:3], v[60:63], 0
    s_lshl_b32 s54, s50, 6
    s_lshl_b32 s55, s44, 4
    s_add_u32 s54, s54, s55
    v_add_u32 v5, s54, v3
    v_lshlrev_b32 v8, 3, v5
    v_lshrrev_b32 v6, 1, v23
    v_xor_b32 v6, v6, v24
    v_add_u32 v5, s54, v23
    v_lshlrev_b32 v5, 10, v5
    v_lshl_add_u32 v5, v6, 4, v5
    v_add_u32 v13, s94, v5
    v_xor_b32 v7, 64, v13
    v_add_u32 v7, 7168, v7
    v_and_b32 v5, 31, v1
    s_lshl_b32 s55, s51, 8
    s_add_u32 s55, s55, 12288
    v_lshl_add_u32 v11, v5, 2, s55
    v_lshlrev_b32 v6, 3, v4
    v_add_u32 v6, s94, v6
    s_lshl_b32 s55, s44, 11
    s_add_u32 s59, s55, 101376
    s_mov_b32 s58, 16384
    v_mfma_f32_16x16x32_bf16 v[92:95], a[4:7], v[60:63], 0
    v_mfma_f32_16x16x32_bf16 v[108:111], a[8:11], v[60:63], 0
    buffer_load_dwordx4 v[192:195], v149, s[32:35], s81 offen sc1
    v_mfma_f32_16x16x32_bf16 v[124:127], a[12:15], v[60:63], 0
    s_waitcnt vmcnt(16)
    v_mfma_f32_16x16x32_bf16 v[80:83], a[0:3], v[64:67], 0
    v_mfma_f32_16x16x32_bf16 v[96:99], a[4:7], v[64:67], 0
    v_mfma_f32_16x16x32_bf16 v[112:115], a[8:11], v[64:67], 0
    buffer_load_dwordx4 v[196:199], v150, s[32:35], s81 offen sc1
    v_mfma_f32_16x16x32_bf16 v[128:131], a[12:15], v[64:67], 0
    s_waitcnt vmcnt(16)
    v_mfma_f32_16x16x32_bf16 v[84:87], a[0:3], v[68:71], 0
    v_mfma_f32_16x16x32_bf16 v[100:103], a[4:7], v[68:71], 0
    v_mfma_f32_16x16x32_bf16 v[116:119], a[8:11], v[68:71], 0
    buffer_load_dwordx4 v[200:203], v151, s[32:35], s81 offen sc1
    v_mfma_f32_16x16x32_bf16 v[132:135], a[12:15], v[68:71], 0
    s_waitcnt vmcnt(16)
    v_mfma_f32_16x16x32_bf16 v[88:91], a[0:3], v[72:75], 0
    v_mfma_f32_16x16x32_bf16 v[104:107], a[4:7], v[72:75], 0
    v_mfma_f32_16x16x32_bf16 v[120:123], a[8:11], v[72:75], 0
    buffer_load_dwordx4 v[204:207], v148, s[32:35], s82 offen sc1
    v_mfma_f32_16x16x32_bf16 v[136:139], a[12:15], v[72:75], 0
    s_waitcnt vmcnt(16)
    v_mfma_f32_16x16x32_bf16 v[76:79], a[16:19], v[156:159], v[76:79]
    v_mfma_f32_16x16x32_bf16 v[92:95], a[20:23], v[156:159], v[92:95]
    v_mfma_f32_16x16x32_bf16 v[108:111], a[24:27], v[156:159], v[108:111]
    buffer_load_dwordx4 v[208:211], v149, s[32:35], s82 offen sc1
    v_mfma_f32_16x16x32_bf16 v[124:127], a[28:31], v[156:159], v[124:127]
    s_waitcnt vmcnt(16)
    v_mfma_f32_16x16x32_bf16 v[80:83], a[16:19], v[160:163], v[80:83]
    v_mfma_f32_16x16x32_bf16 v[96:99], a[20:23], v[160:163], v[96:99]
    v_mfma_f32_16x16x32_bf16 v[112:115], a[24:27], v[160:163], v[112:115]
    buffer_load_dwordx4 v[212:215], v150, s[32:35], s82 offen sc1
    v_mfma_f32_16x16x32_bf16 v[128:131], a[28:31], v[160:163], v[128:131]
    s_waitcnt vmcnt(16)
    v_mfma_f32_16x16x32_bf16 v[84:87], a[16:19], v[164:167], v[84:87]
    v_mfma_f32_16x16x32_bf16 v[100:103], a[20:23], v[164:167], v[100:103]
    v_mfma_f32_16x16x32_bf16 v[116:119], a[24:27], v[164:167], v[116:119]
    buffer_load_dwordx4 v[216:219], v151, s[32:35], s82 offen sc1
    v_mfma_f32_16x16x32_bf16 v[132:135], a[28:31], v[164:167], v[132:135]
    s_waitcnt vmcnt(16)
    v_mfma_f32_16x16x32_bf16 v[88:91], a[16:19], v[168:171], v[88:91]
    v_mfma_f32_16x16x32_bf16 v[104:107], a[20:23], v[168:171], v[104:107]
    v_mfma_f32_16x16x32_bf16 v[120:123], a[24:27], v[168:171], v[120:123]
    buffer_load_dwordx2 v[26:27], v8, s[32:35], s58 offen sc1
    v_mfma_f32_16x16x32_bf16 v[136:139], a[28:31], v[168:171], v[136:139]
    s_waitcnt vmcnt(16)
    v_mfma_f32_16x16x32_bf16 v[76:79], a[32:35], v[172:175], v[76:79]
    v_mfma_f32_16x16x32_bf16 v[92:95], a[36:39], v[172:175], v[92:95]
    v_mfma_f32_16x16x32_bf16 v[108:111], a[40:43], v[172:175], v[108:111]
    s_mov_b32 m0, s59
    s_nop 0
    buffer_load_dwordx4 v13, s[4:7], 0 offen lds
    v_mfma_f32_16x16x32_bf16 v[124:127], a[44:47], v[172:175], v[124:127]
    s_waitcnt vmcnt(16)
    v_mfma_f32_16x16x32_bf16 v[80:83], a[32:35], v[176:179], v[80:83]
    v_mfma_f32_16x16x32_bf16 v[96:99], a[36:39], v[176:179], v[96:99]
    v_mfma_f32_16x16x32_bf16 v[112:115], a[40:43], v[176:179], v[112:115]
    s_mov_b32 m0, s59
    s_nop 0
    buffer_load_dwordx4 v7, s[4:7], 0 offen offset:1024 lds
    v_mfma_f32_16x16x32_bf16 v[128:131], a[44:47], v[176:179], v[128:131]
    s_waitcnt vmcnt(16)
    v_mfma_f32_16x16x32_bf16 v[84:87], a[32:35], v[180:183], v[84:87]
    v_mfma_f32_16x16x32_bf16 v[100:103], a[36:39], v[180:183], v[100:103]
    v_mfma_f32_16x16x32_bf16 v[116:119], a[40:43], v[180:183], v[116:119]
    global_load_dwordx2 v[36:37], v6, s[42:43] offset:0
    global_load_dwordx2 v[38:39], v6, s[42:43] offset:32
    global_load_dwordx2 v[40:41], v6, s[42:43] offset:64
    global_load_dwordx2 v[42:43], v6, s[42:43] offset:96
    v_mfma_f32_16x16x32_bf16 v[132:135], a[44:47], v[180:183], v[132:135]
    s_waitcnt vmcnt(19)
    v_mfma_f32_16x16x32_bf16 v[88:91], a[32:35], v[184:187], v[88:91]
    v_mfma_f32_16x16x32_bf16 v[104:107], a[36:39], v[184:187], v[104:107]
    v_mfma_f32_16x16x32_bf16 v[120:123], a[40:43], v[184:187], v[120:123]
    buffer_load_dwordx4 v[60:63], v148, s[32:35], s83 offen sc1
    v_mfma_f32_16x16x32_bf16 v[136:139], a[44:47], v[184:187], v[136:139]
    s_waitcnt vmcnt(19)
    v_mfma_f32_16x16x32_bf16 v[76:79], a[48:51], v[188:191], v[76:79]
    v_mfma_f32_16x16x32_bf16 v[92:95], a[52:55], v[188:191], v[92:95]
    v_mfma_f32_16x16x32_bf16 v[108:111], a[56:59], v[188:191], v[108:111]
    buffer_load_dwordx4 v[64:67], v149, s[32:35], s83 offen sc1
    v_mfma_f32_16x16x32_bf16 v[124:127], a[60:63], v[188:191], v[124:127]
    s_waitcnt vmcnt(15)
    v_mfma_f32_16x16x32_bf16 v[80:83], a[48:51], v[192:195], v[80:83]
    v_mfma_f32_16x16x32_bf16 v[96:99], a[52:55], v[192:195], v[96:99]
    v_mfma_f32_16x16x32_bf16 v[112:115], a[56:59], v[192:195], v[112:115]
    buffer_load_dwordx4 v[68:71], v150, s[32:35], s83 offen sc1
    v_mfma_f32_16x16x32_bf16 v[128:131], a[60:63], v[192:195], v[128:131]
    s_waitcnt vmcnt(15)
    v_mfma_f32_16x16x32_bf16 v[84:87], a[48:51], v[196:199], v[84:87]
    v_mfma_f32_16x16x32_bf16 v[100:103], a[52:55], v[196:199], v[100:103]
    v_mfma_f32_16x16x32_bf16 v[116:119], a[56:59], v[196:199], v[116:119]
    buffer_load_dwordx4 v[72:75], v151, s[32:35], s83 offen sc1
    v_mfma_f32_16x16x32_bf16 v[132:135], a[60:63], v[196:199], v[132:135]
    s_waitcnt vmcnt(15)
    v_mfma_f32_16x16x32_bf16 v[88:91], a[48:51], v[200:203], v[88:91]
    v_mfma_f32_16x16x32_bf16 v[104:107], a[52:55], v[200:203], v[104:107]
    v_mfma_f32_16x16x32_bf16 v[120:123], a[56:59], v[200:203], v[120:123]
    buffer_load_dwordx4 v[156:159], v148, s[32:35], s84 offen sc1
    v_mfma_f32_16x16x32_bf16 v[136:139], a[60:63], v[200:203], v[136:139]
    s_waitcnt vmcnt(15)
    v_mfma_f32_16x16x32_bf16 v[76:79], a[64:67], v[204:207], v[76:79]
    s_barrier
    s_cmp_eq_u32 s44, 0
    s_cbranch_scc0 Lifl_14
    s_lshl_b32 s101, s45, 6
    s_add_u32 s101, s101, s46
    s_lshl_b32 s101, s101, 2
    s_add_u32 s101, s101, 12288
    v_mov_b32 v9, s101
    v_mov_b32 v10, s52
    s_mov_b64 exec, 1
    buffer_store_dword v10, v9, s[32:35], 0 offen sc1
    s_mov_b64 exec, -1
Lifl_14:
    v_mfma_f32_16x16x32_bf16 v[92:95], a[68:71], v[204:207], v[92:95]
    v_mfma_f32_16x16x32_bf16 v[108:111], a[72:75], v[204:207], v[108:111]
    buffer_load_dwordx4 v[160:163], v149, s[32:35], s84 offen sc1
    v_mfma_f32_16x16x32_bf16 v[124:127], a[76:79], v[204:207], v[124:127]
    s_waitcnt vmcnt(15)
    v_mfma_f32_16x16x32_bf16 v[80:83], a[64:67], v[208:211], v[80:83]
    v_mfma_f32_16x16x32_bf16 v[96:99], a[68:71], v[208:211], v[96:99]
    v_mfma_f32_16x16x32_bf16 v[112:115], a[72:75], v[208:211], v[112:115]
    buffer_load_dwordx4 v[164:167], v150, s[32:35], s84 offen sc1
    v_mfma_f32_16x16x32_bf16 v[128:131], a[76:79], v[208:211], v[128:131]
    s_waitcnt vmcnt(15)
    v_mfma_f32_16x16x32_bf16 v[84:87], a[64:67], v[212:215], v[84:87]
    v_mfma_f32_16x16x32_bf16 v[100:103], a[68:71], v[212:215], v[100:103]
    v_mfma_f32_16x16x32_bf16 v[116:119], a[72:75], v[212:215], v[116:119]
    buffer_load_dwordx4 v[168:171], v151, s[32:35], s84 offen sc1
    v_mfma_f32_16x16x32_bf16 v[132:135], a[76:79], v[212:215], v[132:135]
    s_waitcnt vmcnt(15)
    v_mfma_f32_16x16x32_bf16 v[88:91], a[64:67], v[216:219], v[88:91]
    v_mfma_f32_16x16x32_bf16 v[104:107], a[68:71], v[216:219], v[104:107]
    v_mfma_f32_16x16x32_bf16 v[120:123], a[72:75], v[216:219], v[120:123]
    buffer_load_dwordx4 v[172:175], v148, s[32:35], s85 offen sc1
    v_mfma_f32_16x16x32_bf16 v[136:139], a[76:79], v[216:219], v[136:139]
    s_waitcnt vmcnt(8)
    v_mfma_f32_16x16x32_bf16 v[76:79], a[80:83], v[60:63], v[76:79]
    v_mfma_f32_16x16x32_bf16 v[92:95], a[84:87], v[60:63], v[92:95]
    v_mfma_f32_16x16x32_bf16 v[108:111], a[88:91], v[60:63], v[108:111]
    buffer_load_dwordx4 v[176:179], v149, s[32:35], s85 offen sc1
    v_mfma_f32_16x16x32_bf16 v[124:127], a[92:95], v[60:63], v[124:127]
    s_waitcnt vmcnt(8)
    v_mfma_f32_16x16x32_bf16 v[80:83], a[80:83], v[64:67], v[80:83]
    v_mfma_f32_16x16x32_bf16 v[96:99], a[84:87], v[64:67], v[96:99]
    v_mfma_f32_16x16x32_bf16 v[112:115], a[88:91], v[64:67], v[112:115]
    buffer_load_dwordx4 v[180:183], v150, s[32:35], s85 offen sc1
    v_mfma_f32_16x16x32_bf16 v[128:131], a[92:95], v[64:67], v[128:131]
    s_waitcnt vmcnt(8)
    v_mfma_f32_16x16x32_bf16 v[84:87], a[80:83], v[68:71], v[84:87]
    v_mfma_f32_16x16x32_bf16 v[100:103], a[84:87], v[68:71], v[100:103]
    v_mfma_f32_16x16x32_bf16 v[116:119], a[88:91], v[68:71], v[116:119]
    buffer_load_dwordx4 v[184:187], v151, s[32:35], s85 offen sc1
    v_mfma_f32_16x16x32_bf16 v[132:135], a[92:95], v[68:71], v[132:135]
    s_waitcnt vmcnt(8)
    v_mfma_f32_16x16x32_bf16 v[88:91], a[80:83], v[72:75], v[88:91]
    v_mfma_f32_16x16x32_bf16 v[104:107], a[84:87], v[72:75], v[104:107]
    v_mfma_f32_16x16x32_bf16 v[120:123], a[88:91], v[72:75], v[120:123]
    buffer_load_dwordx4 v[188:191], v148, s[32:35], s86 offen sc1
    v_mfma_f32_16x16x32_bf16 v[136:139], a[92:95], v[72:75], v[136:139]
    s_waitcnt vmcnt(8)
    v_mfma_f32_16x16x32_bf16 v[76:79], a[96:99], v[156:159], v[76:79]
    v_mfma_f32_16x16x32_bf16 v[92:95], a[100:103], v[156:159], v[92:95]
    v_mfma_f32_16x16x32_bf16 v[108:111], a[104:107], v[156:159], v[108:111]
    buffer_load_dwordx4 v[192:195], v149, s[32:35], s86 offen sc1
    v_mfma_f32_16x16x32_bf16 v[124:127], a[108:111], v[156:159], v[124:127]
    s_waitcnt vmcnt(8)
    v_mfma_f32_16x16x32_bf16 v[80:83], a[96:99], v[160:163], v[80:83]
    v_mfma_f32_16x16x32_bf16 v[96:99], a[100:103], v[160:163], v[96:99]
    v_mfma_f32_16x16x32_bf16 v[112:115], a[104:107], v[160:163], v[112:115]
    buffer_load_dwordx4 v[196:199], v150, s[32:35], s86 offen sc1
    v_mfma_f32_16x16x32_bf16 v[128:131], a[108:111], v[160:163], v[128:131]
    s_waitcnt vmcnt(8)
    v_mfma_f32_16x16x32_bf16 v[84:87], a[96:99], v[164:167], v[84:87]
    v_mfma_f32_16x16x32_bf16 v[100:103], a[100:103], v[164:167], v[100:103]
    v_mfma_f32_16x16x32_bf16 v[116:119], a[104:107], v[164:167], v[116:119]
    buffer_load_dwordx4 v[200:203], v151, s[32:35], s86 offen sc1
    v_mfma_f32_16x16x32_bf16 v[132:135], a[108:111], v[164:167], v[132:135]
    s_waitcnt vmcnt(8)
    v_mfma_f32_16x16x32_bf16 v[88:91], a[96:99], v[168:171], v[88:91]
    v_mfma_f32_16x16x32_bf16 v[104:107], a[100:103], v[168:171], v[104:107]
    v_mfma_f32_16x16x32_bf16 v[120:123], a[104:107], v[168:171], v[120:123]
    buffer_load_dwordx4 v[204:207], v148, s[32:35], s87 offen sc1
    v_mfma_f32_16x16x32_bf16 v[136:139], a[108:111], v[168:171], v[136:139]
    s_waitcnt vmcnt(8)
    v_mfma_f32_16x16x32_bf16 v[76:79], a[112:115], v[172:175], v[76:79]
    v_mfma_f32_16x16x32_bf16 v[92:95], a[116:119], v[172:175], v[92:95]
    v_mfma_f32_16x16x32_bf16 v[108:111], a[120:123], v[172:175], v[108:111]
    buffer_load_dwordx4 v[208:211], v149, s[32:35], s87 offen sc1
    v_mfma_f32_16x16x32_bf16 v[124:127], a[124:127], v[172:175], v[124:127]
    s_waitcnt vmcnt(8)
    v_mfma_f32_16x16x32_bf16 v[80:83], a[112:115], v[176:179], v[80:83]
    v_mfma_f32_16x16x32_bf16 v[96:99], a[116:119], v[176:179], v[96:99]
    v_mfma_f32_16x16x32_bf16 v[112:115], a[120:123], v[176:179], v[112:115]
    buffer_load_dwordx4 v[212:215], v150, s[32:35], s87 offen sc1
    v_mfma_f32_16x16x32_bf16 v[128:131], a[124:127], v[176:179], v[128:131]
    s_waitcnt vmcnt(8)
    v_mfma_f32_16x16x32_bf16 v[84:87], a[112:115], v[180:183], v[84:87]
    v_mfma_f32_16x16x32_bf16 v[100:103], a[116:119], v[180:183], v[100:103]
    v_mfma_f32_16x16x32_bf16 v[116:119], a[120:123], v[180:183], v[116:119]
    buffer_load_dwordx4 v[216:219], v151, s[32:35], s87 offen sc1
    v_mfma_f32_16x16x32_bf16 v[132:135], a[124:127], v[180:183], v[132:135]
    s_waitcnt vmcnt(8)
    v_mfma_f32_16x16x32_bf16 v[88:91], a[112:115], v[184:187], v[88:91]
    v_mfma_f32_16x16x32_bf16 v[104:107], a[116:119], v[184:187], v[104:107]
    v_mfma_f32_16x16x32_bf16 v[120:123], a[120:123], v[184:187], v[120:123]
    buffer_load_dwordx4 v[60:63], v148, s[32:35], s88 offen sc1
    v_mfma_f32_16x16x32_bf16 v[136:139], a[124:127], v[184:187], v[136:139]
    s_waitcnt vmcnt(8)
    v_mfma_f32_16x16x32_bf16 v[76:79], a[128:131], v[188:191], v[76:79]
    v_lshrrev_b32 v7, 1, v3
    v_lshrrev_b32 v8, 1, v4
    v_xor_b32 v7, v7, v8
    v_lshlrev_b32 v7, 4, v7
    v_and_b32 v8, 1, v4
    v_lshl_add_u32 v7, v8, 3, v7
    v_lshl_add_u32 v22, v3, 7, v7
    v_xor_b32 v7, 0, v22
    v_add_u32 v7, s59, v7
    ds_read_b64 v[14:15], v7
    v_xor_b32 v7, 32, v22
    v_add_u32 v7, s59, v7
    ds_read_b64 v[16:17], v7
    v_xor_b32 v7, 64, v22
    v_add_u32 v7, s59, v7
    ds_read_b64 v[18:19], v7
    v_xor_b32 v7, 96, v22
    v_add_u32 v7, s59, v7
    ds_read_b64 v[20:21], v7
    s_waitcnt lgkmcnt(3)
    v_lshlrev_b32 v44, 16, v14
    v_mfma_f32_16x16x32_bf16 v[92:95], a[132:135], v[188:191], v[92:95]
    v_and_b32 v45, 0xffff0000, v14
    v_lshlrev_b32 v140, 16, v36
    v_mfma_f32_16x16x32_bf16 v[108:111], a[136:139], v[188:191], v[108:111]
    buffer_load_dwordx4 v[64:67], v149, s[32:35], s88 offen sc1
    v_and_b32 v141, 0xffff0000, v36
    v_lshlrev_b32 v46, 16, v15
    v_mfma_f32_16x16x32_bf16 v[124:127], a[140:143], v[188:191], v[124:127]
    v_and_b32 v47, 0xffff0000, v15
    v_lshlrev_b32 v142, 16, v37
    s_waitcnt vmcnt(8)
    v_mfma_f32_16x16x32_bf16 v[80:83], a[128:131], v[192:195], v[80:83]
    v_and_b32 v143, 0xffff0000, v37
    s_waitcnt lgkmcnt(2)
    v_lshlrev_b32 v48, 16, v16
    v_mfma_f32_16x16x32_bf16 v[96:99], a[132:135], v[192:195], v[96:99]
    v_and_b32 v49, 0xffff0000, v16
    v_lshlrev_b32 v144, 16, v38
    v_mfma_f32_16x16x32_bf16 v[112:115], a[136:139], v[192:195], v[112:115]
    buffer_load_dwordx4 v[68:71], v150, s[32:35], s88 offen sc1
    v_and_b32 v145, 0xffff0000, v38
    v_lshlrev_b32 v50, 16, v17
    v_mfma_f32_16x16x32_bf16 v[128:131], a[140:143], v[192:195], v[128:131]
    v_and_b32 v51, 0xffff0000, v17
    v_lshlrev_b32 v146, 16, v39
    s_waitcnt vmcnt(8)
    v_mfma_f32_16x16x32_bf16 v[84:87], a[128:131], v[196:199], v[84:87]
    v_and_b32 v147, 0xffff0000, v39
    s_waitcnt lgkmcnt(1)
    v_lshlrev_b32 v52, 16, v18
    v_mfma_f32_16x16x32_bf16 v[100:103], a[132:135], v[196:199], v[100:103]
    v_and_b32 v53, 0xffff0000, v18
    v_lshlrev_b32 v152, 16, v40
    v_mfma_f32_16x16x32_bf16 v[116:119], a[136:139], v[196:199], v[116:119]
    buffer_load_dwordx4 v[72:75], v151, s[32:35], s88 offen sc1
    v_and_b32 v153, 0xffff0000, v40
    v_lshlrev_b32 v54, 16, v19
    v_mfma_f32_16x16x32_bf16 v[132:135], a[140:143], v[196:199], v[132:135]
    v_and_b32 v55, 0xffff0000, v19
    v_lshlrev_b32 v154, 16, v41
    s_waitcnt vmcnt(8)
    v_mfma_f32_16x16x32_bf16 v[88:91], a[128:131], v[200:203], v[88:91]
    v_and_b32 v155, 0xffff0000, v41
    s_waitcnt lgkmcnt(0)
    v_lshlrev_b32 v56, 16, v20
    v_mfma_f32_16x16x32_bf16 v[104:107], a[132:135], v[200:203], v[104:107]
    v_and_b32 v57, 0xffff0000, v20
    v_lshlrev_b32 v236, 16, v42
    v_mfma_f32_16x16x32_bf16 v[120:123], a[136:139], v[200:203], v[120:123]
    buffer_load_dwordx4 v[156:159], v148, s[32:35], s89 offen sc1
    v_and_b32 v237, 0xffff0000, v42
    v_lshlrev_b32 v58, 16, v21
    v_mfma_f32_16x16x32_bf16 v[136:139], a[140:143], v[200:203], v[136:139]
    v_and_b32 v59, 0xffff0000, v21
    v_lshlrev_b32 v238, 16, v43
    s_waitcnt vmcnt(8)
    v_mfma_f32_16x16x32_bf16 v[76:79], a[144:147], v[204:207], v[76:79]
    v_and_b32 v239, 0xffff0000, v43
    v_sub_f32 v220, v44, v26
    v_mfma_f32_16x16x32_bf16 v[92:95], a[148:151], v[204:207], v[92:95]
    v_mul_f32 v220, v220, v27
    v_sub_f32 v221, v45, v26
    v_mfma_f32_16x16x32_bf16 v[108:111], a[152:155], v[204:207], v[108:111]
    buffer_load_dwordx4 v[160:163], v149, s[32:35], s89 offen sc1
    v_mul_f32 v221, v221, v27
    v_sub_f32 v222, v46, v26
    v_mfma_f32_16x16x32_bf16 v[124:127], a[156:159], v[204:207], v[124:127]
    v_mul_f32 v222, v222, v27
    v_sub_f32 v223, v47, v26
    s_waitcnt vmcnt(8)
    v_mfma_f32_16x16x32_bf16 v[80:83], a[144:147], v[208:211], v[80:83]
    v_mul_f32 v223, v223, v27
    v_sub_f32 v224, v48, v26
    v_mfma_f32_16x16x32_bf16 v[96:99], a[148:151], v[208:211], v[96:99]
    v_mul_f32 v224, v224, v27
    v_sub_f32 v225, v49, v26
    v_mfma_f32_16x16x32_bf16 v[112:115], a[152:155], v[208:211], v[112:115]
    buffer_load_dwordx4 v[164:167], v150, s[32:35], s89 offen sc1
    v_mul_f32 v225, v225, v27
    v_sub_f32 v226, v50, v26
    v_mfma_f32_16x16x32_bf16 v[128:131], a[156:159], v[208:211], v[128:131]
    v_mul_f32 v226, v226, v27
    v_sub_f32 v227, v51, v26
    s_waitcnt vmcnt(8)
    v_mfma_f32_16x16x32_bf16 v[84:87], a[144:147], v[212:215], v[84:87]
    v_mul_f32 v227, v227, v27
    v_sub_f32 v228, v52, v26
    v_mfma_f32_16x16x32_bf16 v[100:103], a[148:151], v[212:215], v[100:103]
    v_mul_f32 v228, v228, v27
    v_sub_f32 v229, v53, v26
    v_mfma_f32_16x16x32_bf16 v[116:119], a[152:155], v[212:215], v[116:119]
    buffer_load_dwordx4 v[168:171], v151, s[32:35], s89 offen sc1
    v_mul_f32 v229, v229, v27
    v_sub_f32 v230, v54, v26
    v_mfma_f32_16x16x32_bf16 v[132:135], a[156:159], v[212:215], v[132:135]
    v_mul_f32 v230, v230, v27
    v_sub_f32 v231, v55, v26
    s_waitcnt vmcnt(8)
    v_mfma_f32_16x16x32_bf16 v[88:91], a[144:147], v[216:219], v[88:91]
    v_mul_f32 v231, v231, v27
    v_sub_f32 v232, v56, v26
    v_mfma_f32_16x16x32_bf16 v[104:107], a[148:151], v[216:219], v[104:107]
    v_mul_f32 v232, v232, v27
    v_sub_f32 v233, v57, v26
    v_mfma_f32_16x16x32_bf16 v[120:123], a[152:155], v[216:219], v[120:123]
    buffer_load_dwordx4 v[172:175], v148, s[32:35], s90 offen sc1
    v_mul_f32 v233, v233, v27
    v_sub_f32 v234, v58, v26
    v_mfma_f32_16x16x32_bf16 v[136:139], a[156:159], v[216:219], v[136:139]
    v_mul_f32 v234, v234, v27
    v_sub_f32 v235, v59, v26
    s_waitcnt vmcnt(8)
    v_mfma_f32_16x16x32_bf16 v[76:79], a[160:163], v[60:63], v[76:79]
    v_mul_f32 v235, v235, v27
    s_lshl_b32 s54, s51, 6
    s_lshl_b32 s55, s44, 4
    s_add_u32 s54, s54, s55
    v_add_u32 v248, s54, v23
    v_lshlrev_b32 v248, 12, v248
    v_lshl_add_u32 v248, v24, 4, v248
    v_add_u32 v249, 0x8000, v248
    s_lshl_b32 s55, s50, 7
    s_add_u32 s58, s55, 2228224
    s_lshl_b32 s55, s44, 4
    v_add_u32 v250, s55, v23
    v_mul_u32_u24 v250, 144, v250
    v_lshl_add_u32 v250, v24, 4, v250
    v_add_u32 v250, 143616, v250
    v_lshrrev_b32 v5, 2, v1
    v_mul_u32_u24 v5, 144, v5
    v_and_b32 v6, 3, v1
    v_lshl_add_u32 v5, v6, 3, v5
    s_lshl_b32 s55, s44, 5
    s_add_u32 s55, s55, 143616
    v_add_u32 v251, s55, v5
    v_mfma_f32_16x16x32_bf16 v[92:95], a[164:167], v[60:63], v[92:95]
    v_mfma_f32_16x16x32_bf16 v[108:111], a[168:171], v[60:63], v[108:111]
    buffer_load_dwordx4 v[176:179], v149, s[32:35], s90 offen sc1
    v_mfma_f32_16x16x32_bf16 v[124:127], a[172:175], v[60:63], v[124:127]
    s_waitcnt vmcnt(8)
    v_mfma_f32_16x16x32_bf16 v[80:83], a[160:163], v[64:67], v[80:83]
    v_mfma_f32_16x16x32_bf16 v[96:99], a[164:167], v[64:67], v[96:99]
    v_mfma_f32_16x16x32_bf16 v[112:115], a[168:171], v[64:67], v[112:115]
    buffer_load_dwordx4 v[180:183], v150, s[32:35], s90 offen sc1
    v_mfma_f32_16x16x32_bf16 v[128:131], a[172:175], v[64:67], v[128:131]
    s_waitcnt vmcnt(8)
    v_mfma_f32_16x16x32_bf16 v[84:87], a[160:163], v[68:71], v[84:87]
    v_mfma_f32_16x16x32_bf16 v[100:103], a[164:167], v[68:71], v[100:103]
    v_mfma_f32_16x16x32_bf16 v[116:119], a[168:171], v[68:71], v[116:119]
    buffer_load_dwordx4 v[184:187], v151, s[32:35], s90 offen sc1
    v_mfma_f32_16x16x32_bf16 v[132:135], a[172:175], v[68:71], v[132:135]
    s_waitcnt vmcnt(8)
    v_mfma_f32_16x16x32_bf16 v[88:91], a[160:163], v[72:75], v[88:91]
    v_mfma_f32_16x16x32_bf16 v[104:107], a[164:167], v[72:75], v[104:107]
    v_mfma_f32_16x16x32_bf16 v[120:123], a[168:171], v[72:75], v[120:123]
    buffer_load_dwordx4 v[188:191], v148, s[32:35], s91 offen sc1
    v_mfma_f32_16x16x32_bf16 v[136:139], a[172:175], v[72:75], v[136:139]
    s_waitcnt vmcnt(8)
    v_mfma_f32_16x16x32_bf16 v[76:79], a[176:179], v[156:159], v[76:79]
    v_mfma_f32_16x16x32_bf16 v[92:95], a[180:183], v[156:159], v[92:95]
    v_mfma_f32_16x16x32_bf16 v[108:111], a[184:187], v[156:159], v[108:111]
    buffer_load_dwordx4 v[192:195], v149, s[32:35], s91 offen sc1
    v_mfma_f32_16x16x32_bf16 v[124:127], a[188:191], v[156:159], v[124:127]
    s_waitcnt vmcnt(8)
    v_mfma_f32_16x16x32_bf16 v[80:83], a[176:179], v[160:163], v[80:83]
    v_mfma_f32_16x16x32_bf16 v[96:99], a[180:183], v[160:163], v[96:99]
    v_mfma_f32_16x16x32_bf16 v[112:115], a[184:187], v[160:163], v[112:115]
    buffer_load_dwordx4 v[196:199], v150, s[32:35], s91 offen sc1
    v_mfma_f32_16x16x32_bf16 v[128:131], a[188:191], v[160:163], v[128:131]
    s_waitcnt vmcnt(8)
    v_mfma_f32_16x16x32_bf16 v[84:87], a[176:179], v[164:167], v[84:87]
    v_mfma_f32_16x16x32_bf16 v[100:103], a[180:183], v[164:167], v[100:103]
    v_mfma_f32_16x16x32_bf16 v[116:119], a[184:187], v[164:167], v[116:119]
    buffer_load_dwordx4 v[200:203], v151, s[32:35], s91 offen sc1
    v_mfma_f32_16x16x32_bf16 v[132:135], a[188:191], v[164:167], v[132:135]
    s_waitcnt vmcnt(8)
    v_mfma_f32_16x16x32_bf16 v[88:91], a[176:179], v[168:171], v[88:91]
    v_mfma_f32_16x16x32_bf16 v[104:107], a[180:183], v[168:171], v[104:107]
    v_mfma_f32_16x16x32_bf16 v[120:123], a[184:187], v[168:171], v[120:123]
    s_cmp_eq_u32 s44, 0
    s_cbranch_scc0 Lipi_15
    buffer_load_dword v12, v11, s[32:35], 0 offen sc1
Lipi_15:
    v_mfma_f32_16x16x32_bf16 v[136:139], a[188:191], v[168:171], v[136:139]
    s_waitcnt vmcnt(7)
    v_mfma_f32_16x16x32_bf16 v[76:79], a[192:195], v[172:175], v[76:79]
    v_mfma_f32_16x16x32_bf16 v[92:95], a[196:199], v[172:175], v[92:95]
    v_mfma_f32_16x16x32_bf16 v[108:111], a[200:203], v[172:175], v[108:111]
    v_mfma_f32_16x16x32_bf16 v[124:127], a[204:207], v[172:175], v[124:127]
    s_waitcnt vmcnt(6)
    v_mfma_f32_16x16x32_bf16 v[80:83], a[192:195], v[176:179], v[80:83]
    v_mfma_f32_16x16x32_bf16 v[96:99], a[196:199], v[176:179], v[96:99]
    v_mfma_f32_16x16x32_bf16 v[112:115], a[200:203], v[176:179], v[112:115]
    v_mfma_f32_16x16x32_bf16 v[128:131], a[204:207], v[176:179], v[128:131]
    s_waitcnt vmcnt(5)
    v_mfma_f32_16x16x32_bf16 v[84:87], a[192:195], v[180:183], v[84:87]
    v_mfma_f32_16x16x32_bf16 v[100:103], a[196:199], v[180:183], v[100:103]
    v_mfma_f32_16x16x32_bf16 v[116:119], a[200:203], v[180:183], v[116:119]
    v_mfma_f32_16x16x32_bf16 v[132:135], a[204:207], v[180:183], v[132:135]
    s_waitcnt vmcnt(4)
    v_mfma_f32_16x16x32_bf16 v[88:91], a[192:195], v[184:187], v[88:91]
    v_mfma_f32_16x16x32_bf16 v[104:107], a[196:199], v[184:187], v[104:107]
    v_mfma_f32_16x16x32_bf16 v[120:123], a[200:203], v[184:187], v[120:123]
    v_mfma_f32_16x16x32_bf16 v[136:139], a[204:207], v[184:187], v[136:139]
    s_waitcnt vmcnt(3)
    v_mfma_f32_16x16x32_bf16 v[76:79], a[208:211], v[188:191], v[76:79]
    v_mfma_f32_16x16x32_bf16 v[92:95], a[212:215], v[188:191], v[92:95]
    v_mfma_f32_16x16x32_bf16 v[108:111], a[216:219], v[188:191], v[108:111]
    v_mfma_f32_16x16x32_bf16 v[124:127], a[220:223], v[188:191], v[124:127]
    s_waitcnt vmcnt(2)
    v_mfma_f32_16x16x32_bf16 v[80:83], a[208:211], v[192:195], v[80:83]
    v_mfma_f32_16x16x32_bf16 v[96:99], a[212:215], v[192:195], v[96:99]
    v_mfma_f32_16x16x32_bf16 v[112:115], a[216:219], v[192:195], v[112:115]
    v_mfma_f32_16x16x32_bf16 v[128:131], a[220:223], v[192:195], v[128:131]
    s_waitcnt vmcnt(1)
    v_mfma_f32_16x16x32_bf16 v[84:87], a[208:211], v[196:199], v[84:87]
    v_mfma_f32_16x16x32_bf16 v[100:103], a[212:215], v[196:199], v[100:103]
    v_mfma_f32_16x16x32_bf16 v[116:119], a[216:219], v[196:199], v[116:119]
    v_mfma_f32_16x16x32_bf16 v[132:135], a[220:223], v[196:199], v[132:135]
    s_waitcnt vmcnt(0)
    v_mfma_f32_16x16x32_bf16 v[88:91], a[208:211], v[200:203], v[88:91]
    v_mfma_f32_16x16x32_bf16 v[104:107], a[212:215], v[200:203], v[104:107]
    v_mfma_f32_16x16x32_bf16 v[120:123], a[216:219], v[200:203], v[120:123]
    v_mfma_f32_16x16x32_bf16 v[136:139], a[220:223], v[200:203], v[136:139]
    s_add_u32 s54, s44, 1
    s_and_b32 s54, s54, 3
    s_mul_i32 s54, s54, 12288
    s_add_u32 s54, s54, 0
    v_add_u32 v14, s54, v2
    s_add_u32 s54, s44, 2
    s_and_b32 s54, s54, 3
    s_mul_i32 s54, s54, 12288
    s_add_u32 s54, s54, 4096
    v_add_u32 v15, s54, v2
    s_add_u32 s54, s44, 3
    s_and_b32 s54, s54, 3
    s_mul_i32 s54, s54, 12288
    s_add_u32 s54, s54, 8192
    v_add_u32 v16, s54, v2
    ds_write_b128 v14, v[80:83] offset:0
    ds_write_b128 v14, v[96:99] offset:1024
    ds_write_b128 v14, v[112:115] offset:2048
    ds_write_b128 v14, v[128:131] offset:3072
    ds_write_b128 v15, v[84:87] offset:0
    ds_write_b128 v15, v[100:103] offset:1024
    ds_write_b128 v15, v[116:119] offset:2048
    ds_write_b128 v15, v[132:135] offset:3072
    ds_write_b128 v16, v[88:91] offset:0
    ds_write_b128 v16, v[104:107] offset:1024
    ds_write_b128 v16, v[120:123] offset:2048
    ds_write_b128 v16, v[136:139] offset:3072
    s_mul_i32 s54, s44, 12288
    v_add_u32 v5, s54, v2
    v_add_f32 v60, v76, v140
    v_add_f32 v61, v77, v141
    v_add_f32 v62, v78, v142
    v_add_f32 v63, v79, v143
    v_add_f32 v64, v92, v144
    v_add_f32 v65, v93, v145
    v_add_f32 v66, v94, v146
    v_add_f32 v67, v95, v147
    v_add_f32 v68, v108, v152
    v_add_f32 v69, v109, v153
    v_add_f32 v70, v110, v154
    v_add_f32 v71, v111, v155
    v_add_f32 v72, v124, v236
    v_add_f32 v73, v125, v237
    v_add_f32 v74, v126, v238
    v_add_f32 v75, v127, v239
    s_cmp_eq_u32 s44, 0
    s_cbranch_scc0 Lipok_16
    v_cmp_eq_u32 vcc, s52, v12
    s_nop 3
    s_cmp_eq_u64 vcc, exec
    s_cbranch_scc1 Lipok_16
    s_mov_b32 s62, 0x20000
Liprt_17:
    s_sleep 8
    buffer_load_dword v12, v11, s[32:35], 0 offen sc1
    s_waitcnt vmcnt(0)
    v_cmp_eq_u32 vcc, s52, v12
    s_nop 3
    s_cmp_eq_u64 vcc, exec
    s_cbranch_scc1 Lipok_16
    s_sub_u32 s62, s62, 1
    s_cmp_lg_u32 s62, 0
    s_cbranch_scc1 Liprt_17
Lipok_16:
    s_waitcnt lgkmcnt(0)
    s_barrier
    buffer_load_dwordx4 v[28:31], v248, s[32:35], s58 offen sc1
    buffer_load_dwordx4 v[32:35], v249, s[32:35], s58 offen sc1
    ds_read_b128 v[80:83], v5 offset:0
    ds_read_b128 v[84:87], v5 offset:4096
    ds_read_b128 v[88:91], v5 offset:8192
    ds_read_b128 v[96:99], v5 offset:1024
    ds_read_b128 v[100:103], v5 offset:5120
    ds_read_b128 v[104:107], v5 offset:9216
    ds_read_b128 v[112:115], v5 offset:2048
    ds_read_b128 v[116:119], v5 offset:6144
    ds_read_b128 v[120:123], v5 offset:10240
    ds_read_b128 v[128:131], v5 offset:3072
    ds_read_b128 v[132:135], v5 offset:7168
    ds_read_b128 v[136:139], v5 offset:11264
    s_mov_b32 s56, 0xbfb8aa3b
    s_mov_b32 s57, 0xbfb8aa3b
    s_waitcnt lgkmcnt(10)
    v_pk_add_f32 v[80:81], v[80:81], v[84:85]
    s_waitcnt lgkmcnt(9)
    v_pk_add_f32 v[60:61], v[60:61], v[88:89]
    v_pk_add_f32 v[60:61], v[60:61], v[80:81]
    v_pk_add_f32 v[82:83], v[82:83], v[86:87]
    v_pk_add_f32 v[62:63], v[62:63], v[90:91]
    v_pk_add_f32 v[62:63], v[62:63], v[82:83]
    v_pk_mul_f32 v[156:157], v[60:61], s[56:57]
    v_pk_mul_f32 v[158:159], v[62:63], s[56:57]
    v_exp_f32 v156, v156
    v_exp_f32 v157, v157
    v_exp_f32 v158, v158
    v_exp_f32 v159, v159
    v_mul_f32 v60, v60, v220
    v_mul_f32 v61, v61, v221
    v_mul_f32 v62, v62, v222
    v_mul_f32 v63, v63, v223
    v_add_f32 v156, 1.0, v156
    v_add_f32 v157, 1.0, v157
    v_add_f32 v158, 1.0, v158
    v_add_f32 v159, 1.0, v159
    v_rcp_f32 v156, v156
    v_rcp_f32 v157, v157
    v_rcp_f32 v158, v158
    v_rcp_f32 v159, v159
    s_waitcnt lgkmcnt(7)
    v_pk_add_f32 v[96:97], v[96:97], v[100:101]
    s_waitcnt lgkmcnt(6)
    v_pk_add_f32 v[64:65], v[64:65], v[104:105]
    v_pk_add_f32 v[64:65], v[64:65], v[96:97]
    v_pk_add_f32 v[98:99], v[98:99], v[102:103]
    v_pk_add_f32 v[66:67], v[66:67], v[106:107]
    v_pk_add_f32 v[66:67], v[66:67], v[98:99]
    v_pk_mul_f32 v[160:161], v[64:65], s[56:57]
    v_pk_mul_f32 v[162:163], v[66:67], s[56:57]
    v_exp_f32 v160, v160
    v_exp_f32 v161, v161
    v_exp_f32 v162, v162
    v_exp_f32 v163, v163
    v_mul_f32 v64, v64, v224
    v_mul_f32 v65, v65, v225
    v_mul_f32 v66, v66, v226
    v_mul_f32 v67, v67, v227
    v_add_f32 v160, 1.0, v160
    v_add_f32 v161, 1.0, v161
    v_add_f32 v162, 1.0, v162
    v_add_f32 v163, 1.0, v163
    v_rcp_f32 v160, v160
    v_rcp_f32 v161, v161
    v_rcp_f32 v162, v162
    v_rcp_f32 v163, v163
    s_waitcnt lgkmcnt(4)
    v_pk_add_f32 v[112:113], v[112:113], v[116:117]
    s_waitcnt lgkmcnt(3)
    v_pk_add_f32 v[68:69], v[68:69], v[120:121]
    v_pk_add_f32 v[68:69], v[68:69], v[112:113]
    v_pk_add_f32 v[114:115], v[114:115], v[118:119]
    v_pk_add_f32 v[70:71], v[70:71], v[122:123]
    v_pk_add_f32 v[70:71], v[70:71], v[114:115]
    v_pk_mul_f32 v[164:165], v[68:69], s[56:57]
    v_pk_mul_f32 v[166:167], v[70:71], s[56:57]
    v_exp_f32 v164, v164
    v_exp_f32 v165, v165
    v_exp_f32 v166, v166
    v_exp_f32 v167, v167
    v_mul_f32 v68, v68, v228
    v_mul_f32 v69, v69, v229
    v_mul_f32 v70, v70, v230
    v_mul_f32 v71, v71, v231
    v_add_f32 v164, 1.0, v164
    v_add_f32 v165, 1.0, v165
    v_add_f32 v166, 1.0, v166
    v_add_f32 v167, 1.0, v167
    v_rcp_f32 v164, v164
    v_rcp_f32 v165, v165
    v_rcp_f32 v166, v166
    v_rcp_f32 v167, v167
    s_waitcnt lgkmcnt(1)
    v_pk_add_f32 v[128:129], v[128:129], v[132:133]
    s_waitcnt lgkmcnt(0)
    v_pk_add_f32 v[72:73], v[72:73], v[136:137]
    v_pk_add_f32 v[72:73], v[72:73], v[128:129]
    v_pk_add_f32 v[130:131], v[130:131], v[134:135]
    v_pk_add_f32 v[74:75], v[74:75], v[138:139]
    v_pk_add_f32 v[74:75], v[74:75], v[130:131]
    v_pk_mul_f32 v[168:169], v[72:73], s[56:57]
    v_pk_mul_f32 v[170:171], v[74:75], s[56:57]
    v_exp_f32 v168, v168
    v_exp_f32 v169, v169
    v_exp_f32 v170, v170
    v_exp_f32 v171, v171
    v_mul_f32 v72, v72, v232
    v_mul_f32 v73, v73, v233
    v_mul_f32 v74, v74, v234
    v_mul_f32 v75, v75, v235
    v_add_f32 v168, 1.0, v168
    v_add_f32 v169, 1.0, v169
    v_add_f32 v170, 1.0, v170
    v_add_f32 v171, 1.0, v171
    v_rcp_f32 v168, v168
    v_rcp_f32 v169, v169
    v_rcp_f32 v170, v170
    v_rcp_f32 v171, v171
    v_mul_f32 v60, v60, v156
    v_mul_f32 v61, v61, v157
    v_mul_f32 v62, v62, v158
    v_mul_f32 v63, v63, v159
    v_mul_f32 v64, v64, v160
    v_mul_f32 v65, v65, v161
    v_mul_f32 v66, v66, v162
    v_mul_f32 v67, v67, v163
    v_mul_f32 v68, v68, v164
    v_mul_f32 v69, v69, v165
    v_mul_f32 v70, v70, v166
    v_mul_f32 v71, v71, v167
    v_mul_f32 v72, v72, v168
    v_mul_f32 v73, v73, v169
    v_mul_f32 v74, v74, v170
    v_mul_f32 v75, v75, v171
    s_waitcnt vmcnt(1)
    ds_write_b128 v250, v[28:31]
    s_waitcnt vmcnt(0)
    ds_write_b128 v250, v[32:35] offset:1152
    s_waitcnt lgkmcnt(0)
    s_barrier
    ds_read_b64_tr_b16 v[240:241], v251 offset:0
    ds_read_b64_tr_b16 v[242:243], v251 offset:2304
    ds_read_b64_tr_b16 v[244:245], v251 offset:4608
    ds_read_b64_tr_b16 v[246:247], v251 offset:6912
    s_lshl_b32 s55, s44, 11
    s_add_u32 s56, s55, 135168
    s_waitcnt lgkmcnt(3)
    v_lshlrev_b32 v156, 16, v240
    v_and_b32 v157, 0xffff0000, v240
    v_lshlrev_b32 v158, 16, v241
    v_and_b32 v159, 0xffff0000, v241
    v_fma_f32 v60, v60, v156, v44
    v_fma_f32 v61, v61, v157, v45
    v_fma_f32 v62, v62, v158, v46
    v_fma_f32 v63, v63, v159, v47
    v_cvt_pk_bf16_f32 v36, v60, v61
    v_cvt_pk_bf16_f32 v37, v62, v63
    v_xor_b32 v5, 0, v22
    v_add_u32 v5, s56, v5
    ds_write_b64 v5, v[36:37]
    s_waitcnt lgkmcnt(3)
    v_lshlrev_b32 v160, 16, v242
    v_and_b32 v161, 0xffff0000, v242
    v_lshlrev_b32 v162, 16, v243
    v_and_b32 v163, 0xffff0000, v243
    v_fma_f32 v64, v64, v160, v48
    v_fma_f32 v65, v65, v161, v49
    v_fma_f32 v66, v66, v162, v50
    v_fma_f32 v67, v67, v163, v51
    v_cvt_pk_bf16_f32 v38, v64, v65
    v_cvt_pk_bf16_f32 v39, v66, v67
    v_xor_b32 v5, 32, v22
    v_add_u32 v5, s56, v5
    ds_write_b64 v5, v[38:39]
    s_waitcnt lgkmcnt(3)
    v_lshlrev_b32 v164, 16, v244
    v_and_b32 v165, 0xffff0000, v244
    v_lshlrev_b32 v166, 16, v245
    v_and_b32 v167, 0xffff0000, v245
    v_fma_f32 v68, v68, v164, v52
    v_fma_f32 v69, v69, v165, v53
    v_fma_f32 v70, v70, v166, v54
    v_fma_f32 v71, v71, v167, v55
    v_cvt_pk_bf16_f32 v40, v68, v69
    v_cvt_pk_bf16_f32 v41, v70, v71
    v_xor_b32 v5, 64, v22
    v_add_u32 v5, s56, v5
    ds_write_b64 v5, v[40:41]
    s_waitcnt lgkmcnt(3)
    v_lshlrev_b32 v168, 16, v246
    v_and_b32 v169, 0xffff0000, v246
    v_lshlrev_b32 v170, 16, v247
    v_and_b32 v171, 0xffff0000, v247
    v_fma_f32 v72, v72, v168, v56
    v_fma_f32 v73, v73, v169, v57
    v_fma_f32 v74, v74, v170, v58
    v_fma_f32 v75, v75, v171, v59
    v_cvt_pk_bf16_f32 v42, v72, v73
    v_cvt_pk_bf16_f32 v43, v74, v75
    v_xor_b32 v5, 96, v22
    v_add_u32 v5, s56, v5
    ds_write_b64 v5, v[42:43]
    v_add_u32 v6, s56, v2
    s_waitcnt lgkmcnt(0)
    ds_read_b128 v[156:159], v6
    ds_read_b128 v[160:163], v6 offset:1024
    s_waitcnt lgkmcnt(1)
    buffer_store_dwordx4 v[156:159], v13, s[28:31], 0 offen
    v_xor_b32 v5, 64, v13
    s_movk_i32 s57, 0x2000
    s_waitcnt lgkmcnt(0)
    buffer_store_dwordx4 v[160:163], v5, s[28:31], s57 offen
    s_endpgm
Lend:
    s_endpgm
.section .rodata,"a"
.p2align 6
.amdhsa_kernel recurrent_scan__ssm_conv_h3__dense_activation_squared_relu__prompt_kernel
  .amdhsa_next_free_vgpr 512
  .amdhsa_next_free_sgpr 102
  .amdhsa_accum_offset 256
  .amdhsa_group_segment_fixed_size 0
  .amdhsa_kernarg_size 112
  .amdhsa_user_sgpr_count 2
  .amdhsa_user_sgpr_kernarg_segment_ptr 1
  .amdhsa_system_sgpr_workgroup_id_x 1
  .amdhsa_float_denorm_mode_32 3
.end_amdhsa_kernel
```
